```python
import torch

def _softmax(x, axis=-1):
    return torch.softmax(x, dim=axis)

def _gelu(x):
    return torch.nn.functional.gelu(x, approximate='tanh')

def _silu(x):
    return torch.nn.functional.silu(x)

def _sigmoid(x):
    return torch.sigmoid(x)

def _layernorm(x, axis=-1, eps=1e-05):
    m = x.mean(dim=axis, keepdim=True)
    v = x.var(dim=axis, keepdim=True, unbiased=False)
    return (x - m) / torch.sqrt(v + eps)

def _scatter_add(tgt, idx, src, axis=0):
    return tgt.clone().index_add_(axis, idx, src)

def _segment_sum(src, seg, n):
    out = torch.zeros((n,) + src.shape[1:], dtype=src.dtype)
    return out.index_add_(0, seg, src)

def _pad(x, pw):
    flat = tuple((v for pair in reversed(pw) for v in pair))
    return torch.nn.functional.pad(x, flat)
kernel_name = 'parallel_sum__memory_aug_recurrent_mem_tr__glu_gated_geglu__prompt'

def setup_inputs():

    _w = lambda a: (lambda t: t.to(torch.bfloat16) if t.is_floating_point() else t)(torch.as_tensor(a))

    def _A_setup():
        B, S, Dm = (1, 2048, 576)
        H, Dh = (32, 128)
        M, seg = (8, 32)
        seg = min(seg, S)
        S = S // seg * seg
        return {'x': _w((lambda *s: torch.randn(*s, dtype=torch.bfloat16) * 0.05)(B, S, Dm)), 'mem0': _w((lambda *s: torch.randn(*s, dtype=torch.bfloat16) * 0.2)(B, M, Dm)), 'Wq': _w((lambda *s: torch.randn(*s, dtype=torch.bfloat16) * 1.6)(Dm, H, Dh) * Dm ** (-0.5)), 'Wk': _w((lambda *s: torch.randn(*s, dtype=torch.bfloat16) * 1.6)(Dm, H, Dh) * Dm ** (-0.5)), 'Wv': _w((lambda *s: torch.randn(*s, dtype=torch.bfloat16) * 0.2)(Dm, H, Dh) * Dm ** (-0.5)), 'Wo': _w((lambda *s: torch.randn(*s, dtype=torch.bfloat16) * 0.2)(H, Dh, Dm) * (H * Dh) ** (-0.5)), 'seg_len': seg}
    _A_in = _A_setup()

    def _B_setup():
        B, S, Dm, Df = (1, 2048, 576, 4608)
        return {'x': _w((lambda *s: torch.randn(*s, dtype=torch.bfloat16) * 0.05)(B, S, Dm)), 'w_gate': _w((lambda *s: torch.randn(*s, dtype=torch.bfloat16) * 0.4)(Dm, Df) * Dm ** (-0.5)), 'w_up': _w((lambda *s: torch.randn(*s, dtype=torch.bfloat16) * 0.4)(Dm, Df) * Dm ** (-0.5)), 'w_down': _w((lambda *s: torch.randn(*s, dtype=torch.bfloat16) * 0.4)(Df, Dm) * Df ** (-0.5))}
    _B_in = _B_setup()
    return {'A_x': _A_in['x'], 'A_mem0': _A_in['mem0'], 'A_Wq': _A_in['Wq'], 'A_Wk': _A_in['Wk'], 'A_Wv': _A_in['Wv'], 'A_Wo': _A_in['Wo'], 'A_seg_len': _A_in['seg_len'], 'B_x': _B_in['x'], 'B_w_gate': _B_in['w_gate'], 'B_w_up': _B_in['w_up'], 'B_w_down': _B_in['w_down']}

def reference(A_x, A_mem0, A_Wq, A_Wk, A_Wv, A_Wo, A_seg_len, B_x, B_w_gate, B_w_up, B_w_down):

    def _A_ref(x, mem0, Wq, Wk, Wv, Wo, seg_len):
        B, S, Dm = x.shape
        H, Dh = (Wq.shape[1], Wq.shape[2])
        M = mem0.shape[1]
        scale = Dh ** (-0.5)
        n_seg = S // seg_len
        L = M + seg_len
        idx = torch.arange(L)
        mask = (idx[:, None] < M) | (idx[:, None] >= idx[None, :])
        mem = mem0
        outs = []
        for s in range(n_seg):
            xs = x[:, s * seg_len:(s + 1) * seg_len, :].clone()
            h = torch.concatenate([mem, xs], axis=1)
            q = torch.einsum('btd,dhe->bhte', h, Wq)
            k = torch.einsum('btd,dhe->bhte', h, Wk)
            v = torch.einsum('btd,dhe->bhte', h, Wv)
            scores = torch.einsum('bhqe,bhke->bhqk', q, k) * scale
            scores = torch.where(mask[None, None], scores, -1000000000.0)
            p = _softmax(scores, axis=-1)
            o = torch.einsum('bhqk,bhke->bhqe', p, v)
            o = torch.einsum('bhte,hed->btd', o, Wo)
            mem = o[:, :M, :].clone()
            outs.append(o[:, M:, :])
        return torch.concatenate(outs, axis=1)

    def _B_ref(x, w_gate, w_up, w_down):
        g = torch.einsum('bsd,df->bsf', x, w_gate)
        u = torch.einsum('bsd,df->bsf', x, w_up)
        h = _gelu(g) * u
        return torch.einsum('bsf,fd->bsd', h, w_down)
    x = A_x
    xn = _layernorm(x, axis=-1)
    return x + _A_ref(xn, A_mem0, A_Wq, A_Wk, A_Wv, A_Wo, A_seg_len) + _B_ref(xn, B_w_gate, B_w_up, B_w_down)
```

```asm
; @launch grid=(256,1,1) block=(256,1,1) lds=163840
.amdgcn_target "amdgcn-amd-amdhsa--gfx950"
.text
.globl parallel_sum__memory_aug_recurrent_mem_tr__glu_gated_geglu__prompt_kernel
.p2align 8
.type parallel_sum__memory_aug_recurrent_mem_tr__glu_gated_geglu__prompt_kernel,@function
parallel_sum__memory_aug_recurrent_mem_tr__glu_gated_geglu__prompt_kernel:
    s_cmp_ge_u32 s2, 256
    s_cbranch_scc1 EXIT
    s_load_dwordx2 s[4:5], s[0:1], 104
    s_waitcnt lgkmcnt(0)
    s_and_b32 s5, s5, 0xffff
    s_mov_b32 s6, 268435456
    s_mov_b32 s7, 0x00020000
    s_load_dwordx2 s[8:9], s[0:1], 96
    s_waitcnt lgkmcnt(0)
    s_and_b32 s9, s9, 0xffff
    s_mov_b32 s10, 256
    s_mov_b32 s11, 0x00020000
    v_lshrrev_b32 v1, 6, v0
    s_nop 0
    v_readfirstlane_b32 s17, v1
    s_mov_b32 s19, 0x400000
    s_mov_b32 s96, 0
    s_mov_b32 s99, 0
    s_mov_b32 s98, 0
    s_getreg_b32 s97, hwreg(HW_REG_XCC_ID)
    s_and_b32 s97, s97, 7
    s_cmp_lg_u32 s97, 0
    s_cbranch_scc1 NEXT
    s_cmp_ge_u32 s2, 256
    s_cbranch_scc1 NEXT
    v_mov_b32 v250, 163832
    s_cmp_lg_u32 s17, 0
    s_cbranch_scc1 ROLE1
    v_mov_b32 v251, 164
    v_mov_b32 v252, 1
    s_mov_b64 exec, 1
    buffer_atomic_add v252, v251, s[8:11], 0 offen sc0
    s_waitcnt vmcnt(0)
    ds_write_b32 v250, v252
    s_waitcnt lgkmcnt(0)
    s_mov_b64 exec, -1
ROLE1:
    s_barrier
    ds_read_b32 v251, v250
    s_waitcnt vmcnt(0) lgkmcnt(0)
    v_readfirstlane_b32 s16, v251
    s_barrier
    s_cmp_ge_u32 s16, 32
    s_cbranch_scc1 NEXT
DO_CHAIN:
    v_mbcnt_lo_u32_b32 v30, -1, 0
    v_mbcnt_hi_u32_b32 v30, -1, v30
    v_mov_b32 v31, s17
    v_and_b32 v32, 15, v30
    v_lshrrev_b32 v33, 4, v30
    v_and_b32_e64 v34, 3, v30
    v_bfe_u32 v35, v30, 2, 2
    v_lshlrev_b32_e64 v0, 4, v30
    s_mov_b32 s44, 0x00ff00ff
    s_mov_b32 s45, 0x00ff00ff
    s_mov_b32 s78, 0x33333333
    s_mov_b32 s79, 0x33333333
    s_mov_b32 s52, 0x3e0293ee
    s_mov_b32 s82, 0x3e0293ee
    s_mov_b32 s83, 0x3e0293ee
    s_lshl_b32 s40, s17, 5
    s_add_u32 s48, s16, s40
    s_cmp_lt_u32 s48, 72
    s_cselect_b32 s48, s48, 255
    s_mul_i32 s49, s48, 4224
    s_add_u32 s49, s49, 58720256
    s_lshr_b32 s40, s48, 3
    s_lshr_b32 s41, s40, 2
    s_lshl_b32 s41, s41, 4
    s_and_b32 s42, s40, 3
    s_add_u32 s21, s41, s42
    s_lshl_b32 s50, s21, 8
    s_and_b32 s41, s48, 7
    s_lshl_b32 s41, s41, 5
    s_add_u32 s50, s50, s41
    s_add_u32 s50, s50, 63963136
    s_mul_i32 s51, s17, 33792
    s_lshl_b32 s40, s16, 7
    s_add_u32 s51, s51, s40
    s_add_u32 s51, s51, 58720256
    s_sub_u32 s40, 8, s17
    s_mul_i32 s22, s40, 33792
    s_lshl_b32 s40, s17, 2
    s_add_u32 s22, s22, s40
    s_lshl_b32 s53, s16, 7
    s_lshl_b32 s40, s17, 2
    s_add_u32 s53, s53, s40
    s_add_u32 s53, s53, 64569344
    s_lshl_b32 s55, s17, 10
    s_add_u32 s55, s55, 234881024
    s_lshl_b32 s56, s17, 10
    s_add_u32 s57, s56, 20971520
    s_lshr_b32 s56, s56, 1
    s_add_u32 s56, s56, 218103808
    s_lshl_b32 s59, s17, 11
    s_add_u32 s58, s59, 4194304
    s_add_u32 s59, s59, 6144
    s_and_b32 s40, s17, 1
    s_lshl_b32 s47, s40, 12
    s_mov_b32 s40, 4194304
    s_cmp_ge_u32 s17, 2
    s_cselect_b32 s40, 20971520, s40
    s_add_u32 s47, s47, s40
    s_cmp_lt_u32 s48, 64
    s_cselect_b32 s43, 10, 8
    v_bfe_u32 v36, v32, 1, 2
    v_lshlrev_b32 v10, s43, v36
    v_lshl_add_u32 v10, v33, 2, v10
    v_and_b32_e64 v36, 1, v32
    v_lshl_add_u32 v10, v36, 4, v10
    v_and_b32 v37, 1, v33
    v_lshlrev_b32 v36, 5, v37
    v_lshrrev_b32_e64 v38, 1, v35
    v_lshl_add_u32 v36, v38, 4, v36
    v_lshrrev_b32_e64 v38, 1, v33
    v_lshl_add_u32 v36, v38, 2, v36
    v_and_b32 v38, 1, v35
    v_add_u32 v36, v36, v38
    v_mul_u32_u24 v7, 1152, v36
    v_lshrrev_b32_e64 v36, 4, v36
    v_lshl_add_u32 v7, v36, 5, v7
    v_lshl_add_u32 v7, v31, 5, v7
    v_lshl_add_u32 v7, v34, 3, v7
    v_lshrrev_b32 v36, 1, v33
    v_lshlrev_b32 v36, 4, v36
    v_and_b32_e64 v1, 2, v35
    v_lshl_add_u32 v36, v1, 2, v36
    v_lshl_add_u32 v36, v37, 2, v36
    v_add_u32 v36, v36, v38
    v_add_u32 v1, v1, v37
    v_lshl_add_u32 v1, v1, 1, v38
    v_xor_b32 v1, v1, v31
    v_lshlrev_b32 v1, 5, v1
    v_lshl_add_u32 v1, v36, 8, v1
    v_lshl_add_u32 v1, v34, 3, v1
    v_lshl_add_u32 v36, v31, 1, v37
    v_lshrrev_b32 v40, 1, v32
    v_xor_b32 v36, v36, v40
    v_lshlrev_b32_e64 v40, 13, v33
    v_lshl_add_u32 v40, v36, 5, v40
    v_and_b32_e64 v36, 1, v32
    v_lshl_add_u32 v40, v36, 4, v40
    v_lshl_add_u32 v40, v31, 15, v40
    s_lshl_b32 s40, s16, 8
    v_add_u32 v40, s40, v40
    s_lshl_b32 s42, s17, 10
    s_add_u32 s42, s42, 16128
    s_load_dwordx2 s[60:61], s[0:1], 8
    s_waitcnt lgkmcnt(0)
    s_and_b32 s61, s61, 0xffff
    s_mov_b32 s62, 9216
    s_mov_b32 s63, 0x00020000
    s_sub_u32 s43, s43, 3
    v_and_b32 v36, 1, v32
    v_mul_u32_u24 v36, 1152, v36
    v_lshl_add_u32 v36, v33, 2, v36
    v_bfe_u32 v37, v32, 1, 2
    v_lshlrev_b32 v37, s43, v37
    v_add_u32 v36, v36, v37
    s_lshl_b32 s40, s21, 5
    s_bfe_u32 s41, s48, 0x20001
    s_mul_i32 s41, s41, 2304
    s_add_u32 s40, s40, s41
    s_and_b32 s41, s48, 1
    s_lshl_b32 s41, s41, 4
    s_add_u32 s40, s40, s41
    buffer_load_ushort v48, v36, s[60:63], s40 offen
    buffer_load_ushort v49, v36, s[60:63], s40 offen offset:2
    s_load_dwordx2 s[12:13], s[0:1], 16
    s_waitcnt lgkmcnt(0)
    s_and_b32 s13, s13, 0xffff
    s_mov_b32 s14, 4718592
    s_mov_b32 s15, 0x00020000
    s_add_u32 m0, s42, 0
    s_mov_b32 s40, 0
    buffer_load_dwordx4 v40, s[12:15], s40 offen lds
    s_add_u32 m0, s42, 4096
    s_mov_b32 s40, 131072
    buffer_load_dwordx4 v40, s[12:15], s40 offen lds
    s_add_u32 m0, s42, 8192
    s_mov_b32 s40, 262144
    buffer_load_dwordx4 v40, s[12:15], s40 offen lds
    s_add_u32 m0, s42, 12288
    s_mov_b32 s40, 393216
    buffer_load_dwordx4 v40, s[12:15], s40 offen lds
    s_add_u32 m0, s42, 16384
    s_mov_b32 s40, 524288
    buffer_load_dwordx4 v40, s[12:15], s40 offen lds
    s_add_u32 m0, s42, 20480
    s_mov_b32 s40, 655360
    buffer_load_dwordx4 v40, s[12:15], s40 offen lds
    s_add_u32 m0, s42, 24576
    s_mov_b32 s40, 786432
    buffer_load_dwordx4 v40, s[12:15], s40 offen lds
    s_add_u32 m0, s42, 28672
    s_mov_b32 s40, 917504
    buffer_load_dwordx4 v40, s[12:15], s40 offen lds
    s_add_u32 m0, s42, 32768
    s_mov_b32 s40, 1048576
    buffer_load_dwordx4 v40, s[12:15], s40 offen lds
    s_add_u32 m0, s42, 36864
    s_mov_b32 s40, 1179648
    buffer_load_dwordx4 v40, s[12:15], s40 offen lds
    s_add_u32 m0, s42, 40960
    s_mov_b32 s40, 1310720
    buffer_load_dwordx4 v40, s[12:15], s40 offen lds
    s_add_u32 m0, s42, 45056
    s_mov_b32 s40, 1441792
    buffer_load_dwordx4 v40, s[12:15], s40 offen lds
    s_add_u32 m0, s42, 49152
    s_mov_b32 s40, 1572864
    buffer_load_dwordx4 v40, s[12:15], s40 offen lds
    s_add_u32 m0, s42, 53248
    s_mov_b32 s40, 1703936
    buffer_load_dwordx4 v40, s[12:15], s40 offen lds
    s_add_u32 m0, s42, 57344
    s_mov_b32 s40, 1835008
    buffer_load_dwordx4 v40, s[12:15], s40 offen lds
    s_add_u32 m0, s42, 61440
    s_mov_b32 s40, 1966080
    buffer_load_dwordx4 v40, s[12:15], s40 offen lds
    s_add_u32 m0, s42, 65536
    s_mov_b32 s40, 2097152
    buffer_load_dwordx4 v40, s[12:15], s40 offen lds
    s_add_u32 m0, s42, 69632
    s_mov_b32 s40, 2228224
    buffer_load_dwordx4 v40, s[12:15], s40 offen lds
    s_add_u32 m0, s42, 73728
    s_mov_b32 s40, 2359296
    buffer_load_dwordx4 v40, s[12:15], s40 offen lds
    s_add_u32 m0, s42, 77824
    s_mov_b32 s40, 2490368
    buffer_load_dwordx4 v40, s[12:15], s40 offen lds
    s_add_u32 m0, s42, 81920
    s_mov_b32 s40, 2621440
    buffer_load_dwordx4 v40, s[12:15], s40 offen lds
    s_add_u32 m0, s42, 86016
    s_mov_b32 s40, 2752512
    buffer_load_dwordx4 v40, s[12:15], s40 offen lds
    s_add_u32 m0, s42, 90112
    s_mov_b32 s40, 2883584
    buffer_load_dwordx4 v40, s[12:15], s40 offen lds
    s_add_u32 m0, s42, 94208
    s_mov_b32 s40, 3014656
    buffer_load_dwordx4 v40, s[12:15], s40 offen lds
    s_add_u32 m0, s42, 98304
    s_mov_b32 s40, 3145728
    buffer_load_dwordx4 v40, s[12:15], s40 offen lds
    s_add_u32 m0, s42, 102400
    s_mov_b32 s40, 3276800
    buffer_load_dwordx4 v40, s[12:15], s40 offen lds
    s_add_u32 m0, s42, 106496
    s_mov_b32 s40, 3407872
    buffer_load_dwordx4 v40, s[12:15], s40 offen lds
    s_add_u32 m0, s42, 110592
    s_mov_b32 s40, 3538944
    buffer_load_dwordx4 v40, s[12:15], s40 offen lds
    s_add_u32 m0, s42, 114688
    s_mov_b32 s40, 3670016
    buffer_load_dwordx4 v40, s[12:15], s40 offen lds
    s_add_u32 m0, s42, 118784
    s_mov_b32 s40, 3801088
    buffer_load_dwordx4 v40, s[12:15], s40 offen lds
    s_add_u32 m0, s42, 122880
    s_mov_b32 s40, 3932160
    buffer_load_dwordx4 v40, s[12:15], s40 offen lds
    s_add_u32 m0, s42, 126976
    s_mov_b32 s40, 4063232
    buffer_load_dwordx4 v40, s[12:15], s40 offen lds
    s_add_u32 m0, s42, 131072
    s_mov_b32 s40, 4194304
    buffer_load_dwordx4 v40, s[12:15], s40 offen lds
    s_add_u32 m0, s42, 135168
    s_mov_b32 s40, 4325376
    buffer_load_dwordx4 v40, s[12:15], s40 offen lds
    s_add_u32 m0, s42, 139264
    s_mov_b32 s40, 4456448
    buffer_load_dwordx4 v40, s[12:15], s40 offen lds
    s_add_u32 m0, s42, 143360
    s_mov_b32 s40, 4587520
    buffer_load_dwordx4 v40, s[12:15], s40 offen lds
    v_mov_b32_e64 v36, 0
    buffer_store_dword v36, off, s[4:7], s53 sc1
    s_cmp_ge_u32 s48, 72
    s_cbranch_scc1 CH_noinit_1
    v_mov_b32 v44, -1
    v_mov_b32 v45, -1
    v_mov_b32 v46, -1
    v_mov_b32 v47, -1
    s_add_u32 s41, s49, 0
    buffer_store_dwordx4 v[44:47], v0, s[4:7], s41 offen offset:0 sc1
    buffer_store_dwordx4 v[44:47], v0, s[4:7], s41 offen offset:1024 sc1
    buffer_store_dwordx4 v[44:47], v0, s[4:7], s41 offen offset:2048 sc1
    buffer_store_dwordx4 v[44:47], v0, s[4:7], s41 offen offset:3072 sc1
    s_add_u32 s41, s49, 305152
    buffer_store_dwordx4 v[44:47], v0, s[4:7], s41 offen offset:0 sc1
    buffer_store_dwordx4 v[44:47], v0, s[4:7], s41 offen offset:1024 sc1
    buffer_store_dwordx4 v[44:47], v0, s[4:7], s41 offen offset:2048 sc1
    buffer_store_dwordx4 v[44:47], v0, s[4:7], s41 offen offset:3072 sc1
    s_mov_b64 exec, s[44:45]
    s_nop 0
    s_add_u32 s41, s50, 16384
    buffer_store_dword v44, v10, s[4:7], s41 offen sc1
    s_add_u32 s41, s50, 32768
    buffer_store_dword v44, v10, s[4:7], s41 offen sc1
    s_add_u32 s41, s50, 49152
    buffer_store_dword v44, v10, s[4:7], s41 offen sc1
    s_waitcnt vmcnt(48)
    v_lshl_or_b32 v38, v49, 16, v48
    v_min_u32 v38, -2, v38
    buffer_store_dword v38, v10, s[4:7], s50 offen sc1
    s_mov_b64 exec, -1
CH_noinit_1:
    s_waitcnt vmcnt(32)
    s_barrier
    s_nop 0
    v_add_u32 v6, 16128, v1
    v_xor_b32 v5, 0x80, v6
    ds_read_b64_tr_b16 a[0:1], v6 offset:0
    ds_read_b64_tr_b16 a[2:3], v6 offset:512
    ds_read_b64_tr_b16 a[4:5], v6 offset:8192
    ds_read_b64_tr_b16 a[6:7], v6 offset:8704
    ds_read_b64_tr_b16 a[8:9], v5 offset:0
    ds_read_b64_tr_b16 a[10:11], v5 offset:512
    ds_read_b64_tr_b16 a[12:13], v5 offset:8192
    ds_read_b64_tr_b16 a[14:15], v5 offset:8704
    s_waitcnt lgkmcnt(0)
    s_barrier
    s_load_dwordx2 s[12:13], s[0:1], 24
    s_waitcnt lgkmcnt(0)
    s_and_b32 s13, s13, 0xffff
    s_mov_b32 s14, 4718592
    s_mov_b32 s15, 0x00020000
    s_add_u32 m0, s42, 0
    s_mov_b32 s40, 0
    s_nop 0
    buffer_load_dwordx4 v40, s[12:15], s40 offen lds
    s_add_u32 m0, s42, 4096
    s_mov_b32 s40, 131072
    buffer_load_dwordx4 v40, s[12:15], s40 offen lds
    s_add_u32 m0, s42, 8192
    s_mov_b32 s40, 262144
    buffer_load_dwordx4 v40, s[12:15], s40 offen lds
    s_add_u32 m0, s42, 12288
    s_mov_b32 s40, 393216
    buffer_load_dwordx4 v40, s[12:15], s40 offen lds
    s_waitcnt vmcnt(32)
    s_barrier
    v_add_u32 v6, 32512, v1
    v_xor_b32 v5, 0x80, v6
    ds_read_b64_tr_b16 a[48:49], v6 offset:0
    ds_read_b64_tr_b16 a[50:51], v6 offset:512
    ds_read_b64_tr_b16 a[52:53], v6 offset:8192
    ds_read_b64_tr_b16 a[54:55], v6 offset:8704
    ds_read_b64_tr_b16 a[56:57], v5 offset:0
    ds_read_b64_tr_b16 a[58:59], v5 offset:512
    ds_read_b64_tr_b16 a[60:61], v5 offset:8192
    ds_read_b64_tr_b16 a[62:63], v5 offset:8704
    s_waitcnt lgkmcnt(0)
    s_barrier
    s_add_u32 m0, s42, 16384
    s_mov_b32 s40, 524288
    buffer_load_dwordx4 v40, s[12:15], s40 offen lds
    s_add_u32 m0, s42, 20480
    s_mov_b32 s40, 655360
    buffer_load_dwordx4 v40, s[12:15], s40 offen lds
    s_add_u32 m0, s42, 24576
    s_mov_b32 s40, 786432
    buffer_load_dwordx4 v40, s[12:15], s40 offen lds
    s_add_u32 m0, s42, 28672
    s_mov_b32 s40, 917504
    buffer_load_dwordx4 v40, s[12:15], s40 offen lds
    s_waitcnt vmcnt(32)
    s_barrier
    v_add_u32 v6, 48896, v1
    v_xor_b32 v5, 0x80, v6
    ds_read_b64_tr_b16 a[96:97], v6 offset:0
    ds_read_b64_tr_b16 a[98:99], v6 offset:512
    ds_read_b64_tr_b16 a[100:101], v6 offset:8192
    ds_read_b64_tr_b16 a[102:103], v6 offset:8704
    ds_read_b64_tr_b16 a[104:105], v5 offset:0
    ds_read_b64_tr_b16 a[106:107], v5 offset:512
    ds_read_b64_tr_b16 a[108:109], v5 offset:8192
    ds_read_b64_tr_b16 a[110:111], v5 offset:8704
    s_waitcnt lgkmcnt(0)
    s_barrier
    s_add_u32 m0, s42, 32768
    s_mov_b32 s40, 1048576
    buffer_load_dwordx4 v40, s[12:15], s40 offen lds
    s_add_u32 m0, s42, 36864
    s_mov_b32 s40, 1179648
    buffer_load_dwordx4 v40, s[12:15], s40 offen lds
    s_add_u32 m0, s42, 40960
    s_mov_b32 s40, 1310720
    buffer_load_dwordx4 v40, s[12:15], s40 offen lds
    s_add_u32 m0, s42, 45056
    s_mov_b32 s40, 1441792
    buffer_load_dwordx4 v40, s[12:15], s40 offen lds
    s_waitcnt vmcnt(32)
    s_barrier
    v_add_u32 v6, 65280, v1
    v_xor_b32 v5, 0x80, v6
    ds_read_b64_tr_b16 a[144:145], v6 offset:0
    ds_read_b64_tr_b16 a[146:147], v6 offset:512
    ds_read_b64_tr_b16 a[148:149], v6 offset:8192
    ds_read_b64_tr_b16 a[150:151], v6 offset:8704
    ds_read_b64_tr_b16 a[152:153], v5 offset:0
    ds_read_b64_tr_b16 a[154:155], v5 offset:512
    ds_read_b64_tr_b16 a[156:157], v5 offset:8192
    ds_read_b64_tr_b16 a[158:159], v5 offset:8704
    s_waitcnt lgkmcnt(0)
    s_barrier
    s_add_u32 m0, s42, 49152
    s_mov_b32 s40, 1572864
    buffer_load_dwordx4 v40, s[12:15], s40 offen lds
    s_add_u32 m0, s42, 53248
    s_mov_b32 s40, 1703936
    buffer_load_dwordx4 v40, s[12:15], s40 offen lds
    s_add_u32 m0, s42, 57344
    s_mov_b32 s40, 1835008
    buffer_load_dwordx4 v40, s[12:15], s40 offen lds
    s_add_u32 m0, s42, 61440
    s_mov_b32 s40, 1966080
    buffer_load_dwordx4 v40, s[12:15], s40 offen lds
    s_waitcnt vmcnt(32)
    s_barrier
    v_add_u32 v6, 81664, v1
    v_xor_b32 v5, 0x80, v6
    ds_read_b64_tr_b16 a[192:193], v6 offset:0
    ds_read_b64_tr_b16 a[194:195], v6 offset:512
    ds_read_b64_tr_b16 a[196:197], v6 offset:8192
    ds_read_b64_tr_b16 a[198:199], v6 offset:8704
    ds_read_b64_tr_b16 a[200:201], v5 offset:0
    ds_read_b64_tr_b16 a[202:203], v5 offset:512
    ds_read_b64_tr_b16 a[204:205], v5 offset:8192
    ds_read_b64_tr_b16 a[206:207], v5 offset:8704
    s_waitcnt lgkmcnt(0)
    s_barrier
    s_add_u32 m0, s42, 65536
    s_mov_b32 s40, 2097152
    buffer_load_dwordx4 v40, s[12:15], s40 offen lds
    s_add_u32 m0, s42, 69632
    s_mov_b32 s40, 2228224
    buffer_load_dwordx4 v40, s[12:15], s40 offen lds
    s_add_u32 m0, s42, 73728
    s_mov_b32 s40, 2359296
    buffer_load_dwordx4 v40, s[12:15], s40 offen lds
    s_add_u32 m0, s42, 77824
    s_mov_b32 s40, 2490368
    buffer_load_dwordx4 v40, s[12:15], s40 offen lds
    s_waitcnt vmcnt(32)
    s_barrier
    v_add_u32 v6, 98048, v1
    v_xor_b32 v5, 0x80, v6
    ds_read_b64_tr_b16 a[240:241], v6 offset:0
    ds_read_b64_tr_b16 a[242:243], v6 offset:512
    ds_read_b64_tr_b16 a[244:245], v6 offset:8192
    ds_read_b64_tr_b16 a[246:247], v6 offset:8704
    ds_read_b64_tr_b16 a[248:249], v5 offset:0
    ds_read_b64_tr_b16 a[250:251], v5 offset:512
    ds_read_b64_tr_b16 a[252:253], v5 offset:8192
    ds_read_b64_tr_b16 a[254:255], v5 offset:8704
    s_waitcnt lgkmcnt(0)
    s_barrier
    s_add_u32 m0, s42, 81920
    s_mov_b32 s40, 2621440
    buffer_load_dwordx4 v40, s[12:15], s40 offen lds
    s_add_u32 m0, s42, 86016
    s_mov_b32 s40, 2752512
    buffer_load_dwordx4 v40, s[12:15], s40 offen lds
    s_add_u32 m0, s42, 90112
    s_mov_b32 s40, 2883584
    buffer_load_dwordx4 v40, s[12:15], s40 offen lds
    s_add_u32 m0, s42, 94208
    s_mov_b32 s40, 3014656
    buffer_load_dwordx4 v40, s[12:15], s40 offen lds
    s_waitcnt vmcnt(32)
    s_barrier
    v_add_u32 v6, 114432, v1
    v_xor_b32 v5, 0x80, v6
    ds_read_b64_tr_b16 v[112:113], v6 offset:0
    ds_read_b64_tr_b16 v[114:115], v6 offset:512
    ds_read_b64_tr_b16 v[116:117], v6 offset:8192
    ds_read_b64_tr_b16 v[118:119], v6 offset:8704
    ds_read_b64_tr_b16 v[120:121], v5 offset:0
    ds_read_b64_tr_b16 v[122:123], v5 offset:512
    ds_read_b64_tr_b16 v[124:125], v5 offset:8192
    ds_read_b64_tr_b16 v[126:127], v5 offset:8704
    s_waitcnt lgkmcnt(0)
    s_barrier
    s_add_u32 m0, s42, 98304
    s_mov_b32 s40, 3145728
    buffer_load_dwordx4 v40, s[12:15], s40 offen lds
    s_add_u32 m0, s42, 102400
    s_mov_b32 s40, 3276800
    buffer_load_dwordx4 v40, s[12:15], s40 offen lds
    s_add_u32 m0, s42, 106496
    s_mov_b32 s40, 3407872
    buffer_load_dwordx4 v40, s[12:15], s40 offen lds
    s_add_u32 m0, s42, 110592
    s_mov_b32 s40, 3538944
    buffer_load_dwordx4 v40, s[12:15], s40 offen lds
    s_waitcnt vmcnt(32)
    s_barrier
    v_add_u32 v6, 130816, v1
    v_xor_b32 v5, 0x80, v6
    ds_read_b64_tr_b16 v[160:161], v6 offset:0
    ds_read_b64_tr_b16 v[162:163], v6 offset:512
    ds_read_b64_tr_b16 v[164:165], v6 offset:8192
    ds_read_b64_tr_b16 v[166:167], v6 offset:8704
    ds_read_b64_tr_b16 v[168:169], v5 offset:0
    ds_read_b64_tr_b16 v[170:171], v5 offset:512
    ds_read_b64_tr_b16 v[172:173], v5 offset:8192
    ds_read_b64_tr_b16 v[174:175], v5 offset:8704
    s_waitcnt lgkmcnt(0)
    s_barrier
    s_add_u32 m0, s42, 114688
    s_mov_b32 s40, 3670016
    buffer_load_dwordx4 v40, s[12:15], s40 offen lds
    s_add_u32 m0, s42, 118784
    s_mov_b32 s40, 3801088
    buffer_load_dwordx4 v40, s[12:15], s40 offen lds
    s_add_u32 m0, s42, 122880
    s_mov_b32 s40, 3932160
    buffer_load_dwordx4 v40, s[12:15], s40 offen lds
    s_add_u32 m0, s42, 126976
    s_mov_b32 s40, 4063232
    buffer_load_dwordx4 v40, s[12:15], s40 offen lds
    s_waitcnt vmcnt(32)
    s_barrier
    v_add_u32 v6, 147200, v1
    v_xor_b32 v5, 0x80, v6
    ds_read_b64_tr_b16 v[208:209], v6 offset:0
    ds_read_b64_tr_b16 v[210:211], v6 offset:512
    ds_read_b64_tr_b16 v[212:213], v6 offset:8192
    ds_read_b64_tr_b16 v[214:215], v6 offset:8704
    ds_read_b64_tr_b16 v[216:217], v5 offset:0
    ds_read_b64_tr_b16 v[218:219], v5 offset:512
    ds_read_b64_tr_b16 v[220:221], v5 offset:8192
    ds_read_b64_tr_b16 v[222:223], v5 offset:8704
    s_waitcnt lgkmcnt(0)
    s_barrier
    s_add_u32 m0, s42, 131072
    s_mov_b32 s40, 4194304
    buffer_load_dwordx4 v40, s[12:15], s40 offen lds
    s_add_u32 m0, s42, 135168
    s_mov_b32 s40, 4325376
    buffer_load_dwordx4 v40, s[12:15], s40 offen lds
    s_add_u32 m0, s42, 139264
    s_mov_b32 s40, 4456448
    buffer_load_dwordx4 v40, s[12:15], s40 offen lds
    s_add_u32 m0, s42, 143360
    s_mov_b32 s40, 4587520
    buffer_load_dwordx4 v40, s[12:15], s40 offen lds
    s_waitcnt vmcnt(32)
    s_barrier
    v_add_u32 v6, 16128, v1
    v_xor_b32 v5, 0x80, v6
    ds_read_b64_tr_b16 a[16:17], v6 offset:0
    ds_read_b64_tr_b16 a[18:19], v6 offset:512
    ds_read_b64_tr_b16 a[20:21], v6 offset:8192
    ds_read_b64_tr_b16 a[22:23], v6 offset:8704
    ds_read_b64_tr_b16 a[24:25], v5 offset:0
    ds_read_b64_tr_b16 a[26:27], v5 offset:512
    ds_read_b64_tr_b16 a[28:29], v5 offset:8192
    ds_read_b64_tr_b16 a[30:31], v5 offset:8704
    s_waitcnt lgkmcnt(0)
    s_barrier
    s_load_dwordx2 s[12:13], s[0:1], 32
    s_waitcnt lgkmcnt(0)
    s_and_b32 s13, s13, 0xffff
    s_mov_b32 s14, 4718592
    s_mov_b32 s15, 0x00020000
    s_add_u32 m0, s42, 0
    s_mov_b32 s40, 0
    s_nop 0
    buffer_load_dwordx4 v40, s[12:15], s40 offen lds
    s_add_u32 m0, s42, 4096
    s_mov_b32 s40, 131072
    buffer_load_dwordx4 v40, s[12:15], s40 offen lds
    s_add_u32 m0, s42, 8192
    s_mov_b32 s40, 262144
    buffer_load_dwordx4 v40, s[12:15], s40 offen lds
    s_add_u32 m0, s42, 12288
    s_mov_b32 s40, 393216
    buffer_load_dwordx4 v40, s[12:15], s40 offen lds
    s_waitcnt vmcnt(32)
    s_barrier
    v_add_u32 v6, 32512, v1
    v_xor_b32 v5, 0x80, v6
    ds_read_b64_tr_b16 a[64:65], v6 offset:0
    ds_read_b64_tr_b16 a[66:67], v6 offset:512
    ds_read_b64_tr_b16 a[68:69], v6 offset:8192
    ds_read_b64_tr_b16 a[70:71], v6 offset:8704
    ds_read_b64_tr_b16 a[72:73], v5 offset:0
    ds_read_b64_tr_b16 a[74:75], v5 offset:512
    ds_read_b64_tr_b16 a[76:77], v5 offset:8192
    ds_read_b64_tr_b16 a[78:79], v5 offset:8704
    s_waitcnt lgkmcnt(0)
    s_barrier
    s_cmp_lg_u32 s17, 0
    s_cbranch_scc1 CH_nosig_2
    v_mov_b32 v36, 36
    s_getreg_b32 s40, hwreg(HW_REG_XCC_ID)
    s_and_b32 s40, s40, 7
    s_mov_b32 s41, 0x10001
    s_cmp_eq_u32 s40, 0
    s_cselect_b32 s40, 1, s41
    v_mov_b32 v37, s40
    s_mov_b64 exec, 1
    buffer_atomic_add v37, v36, s[8:11], 0 offen
    s_mov_b64 exec, -1
CH_nosig_2:
    s_add_u32 m0, s42, 16384
    s_mov_b32 s40, 524288
    buffer_load_dwordx4 v40, s[12:15], s40 offen lds
    s_add_u32 m0, s42, 20480
    s_mov_b32 s40, 655360
    buffer_load_dwordx4 v40, s[12:15], s40 offen lds
    s_add_u32 m0, s42, 24576
    s_mov_b32 s40, 786432
    buffer_load_dwordx4 v40, s[12:15], s40 offen lds
    s_add_u32 m0, s42, 28672
    s_mov_b32 s40, 917504
    buffer_load_dwordx4 v40, s[12:15], s40 offen lds
    s_waitcnt vmcnt(32)
    s_barrier
    v_add_u32 v6, 48896, v1
    v_xor_b32 v5, 0x80, v6
    ds_read_b64_tr_b16 a[112:113], v6 offset:0
    ds_read_b64_tr_b16 a[114:115], v6 offset:512
    ds_read_b64_tr_b16 a[116:117], v6 offset:8192
    ds_read_b64_tr_b16 a[118:119], v6 offset:8704
    ds_read_b64_tr_b16 a[120:121], v5 offset:0
    ds_read_b64_tr_b16 a[122:123], v5 offset:512
    ds_read_b64_tr_b16 a[124:125], v5 offset:8192
    ds_read_b64_tr_b16 a[126:127], v5 offset:8704
    s_waitcnt lgkmcnt(0)
    s_barrier
    s_getpc_b64 s[62:63]
CH_PC:
    s_add_u32 s62, s62, CH_LOOP-CH_PC
    s_addc_u32 s63, s63, 0
    v_lshlrev_b32_e64 v50, 3, v0
    global_load_dword v51, v50, s[62:63]
    s_add_u32 m0, s42, 32768
    s_mov_b32 s40, 1048576
    buffer_load_dwordx4 v40, s[12:15], s40 offen lds
    s_add_u32 m0, s42, 36864
    s_mov_b32 s40, 1179648
    buffer_load_dwordx4 v40, s[12:15], s40 offen lds
    s_add_u32 m0, s42, 40960
    s_mov_b32 s40, 1310720
    buffer_load_dwordx4 v40, s[12:15], s40 offen lds
    s_add_u32 m0, s42, 45056
    s_mov_b32 s40, 1441792
    buffer_load_dwordx4 v40, s[12:15], s40 offen lds
    s_waitcnt vmcnt(32)
    s_barrier
    v_add_u32 v6, 65280, v1
    v_xor_b32 v5, 0x80, v6
    ds_read_b64_tr_b16 a[160:161], v6 offset:0
    ds_read_b64_tr_b16 a[162:163], v6 offset:512
    ds_read_b64_tr_b16 a[164:165], v6 offset:8192
    ds_read_b64_tr_b16 a[166:167], v6 offset:8704
    ds_read_b64_tr_b16 a[168:169], v5 offset:0
    ds_read_b64_tr_b16 a[170:171], v5 offset:512
    ds_read_b64_tr_b16 a[172:173], v5 offset:8192
    ds_read_b64_tr_b16 a[174:175], v5 offset:8704
    s_waitcnt lgkmcnt(0)
    s_barrier
    s_add_u32 m0, s42, 49152
    s_mov_b32 s40, 1572864
    buffer_load_dwordx4 v40, s[12:15], s40 offen lds
    s_add_u32 m0, s42, 53248
    s_mov_b32 s40, 1703936
    buffer_load_dwordx4 v40, s[12:15], s40 offen lds
    s_add_u32 m0, s42, 57344
    s_mov_b32 s40, 1835008
    buffer_load_dwordx4 v40, s[12:15], s40 offen lds
    s_add_u32 m0, s42, 61440
    s_mov_b32 s40, 1966080
    buffer_load_dwordx4 v40, s[12:15], s40 offen lds
    s_waitcnt vmcnt(32)
    s_barrier
    v_add_u32 v6, 81664, v1
    v_xor_b32 v5, 0x80, v6
    ds_read_b64_tr_b16 a[208:209], v6 offset:0
    ds_read_b64_tr_b16 a[210:211], v6 offset:512
    ds_read_b64_tr_b16 a[212:213], v6 offset:8192
    ds_read_b64_tr_b16 a[214:215], v6 offset:8704
    ds_read_b64_tr_b16 a[216:217], v5 offset:0
    ds_read_b64_tr_b16 a[218:219], v5 offset:512
    ds_read_b64_tr_b16 a[220:221], v5 offset:8192
    ds_read_b64_tr_b16 a[222:223], v5 offset:8704
    s_waitcnt lgkmcnt(0)
    s_barrier
    s_add_u32 m0, s42, 65536
    s_mov_b32 s40, 2097152
    buffer_load_dwordx4 v40, s[12:15], s40 offen lds
    s_add_u32 m0, s42, 69632
    s_mov_b32 s40, 2228224
    buffer_load_dwordx4 v40, s[12:15], s40 offen lds
    s_add_u32 m0, s42, 73728
    s_mov_b32 s40, 2359296
    buffer_load_dwordx4 v40, s[12:15], s40 offen lds
    s_add_u32 m0, s42, 77824
    s_mov_b32 s40, 2490368
    buffer_load_dwordx4 v40, s[12:15], s40 offen lds
    s_waitcnt vmcnt(32)
    s_barrier
    v_add_u32 v6, 98048, v1
    v_xor_b32 v5, 0x80, v6
    ds_read_b64_tr_b16 v[80:81], v6 offset:0
    ds_read_b64_tr_b16 v[82:83], v6 offset:512
    ds_read_b64_tr_b16 v[84:85], v6 offset:8192
    ds_read_b64_tr_b16 v[86:87], v6 offset:8704
    ds_read_b64_tr_b16 v[88:89], v5 offset:0
    ds_read_b64_tr_b16 v[90:91], v5 offset:512
    ds_read_b64_tr_b16 v[92:93], v5 offset:8192
    ds_read_b64_tr_b16 v[94:95], v5 offset:8704
    s_waitcnt lgkmcnt(0)
    s_barrier
    s_add_u32 m0, s42, 81920
    s_mov_b32 s40, 2621440
    buffer_load_dwordx4 v40, s[12:15], s40 offen lds
    s_add_u32 m0, s42, 86016
    s_mov_b32 s40, 2752512
    buffer_load_dwordx4 v40, s[12:15], s40 offen lds
    s_add_u32 m0, s42, 90112
    s_mov_b32 s40, 2883584
    buffer_load_dwordx4 v40, s[12:15], s40 offen lds
    s_add_u32 m0, s42, 94208
    s_mov_b32 s40, 3014656
    buffer_load_dwordx4 v40, s[12:15], s40 offen lds
    s_waitcnt vmcnt(32)
    s_barrier
    v_add_u32 v6, 114432, v1
    v_xor_b32 v5, 0x80, v6
    ds_read_b64_tr_b16 v[128:129], v6 offset:0
    ds_read_b64_tr_b16 v[130:131], v6 offset:512
    ds_read_b64_tr_b16 v[132:133], v6 offset:8192
    ds_read_b64_tr_b16 v[134:135], v6 offset:8704
    ds_read_b64_tr_b16 v[136:137], v5 offset:0
    ds_read_b64_tr_b16 v[138:139], v5 offset:512
    ds_read_b64_tr_b16 v[140:141], v5 offset:8192
    ds_read_b64_tr_b16 v[142:143], v5 offset:8704
    s_waitcnt lgkmcnt(0)
    s_barrier
    s_add_u32 m0, s42, 98304
    s_mov_b32 s40, 3145728
    buffer_load_dwordx4 v40, s[12:15], s40 offen lds
    s_add_u32 m0, s42, 102400
    s_mov_b32 s40, 3276800
    buffer_load_dwordx4 v40, s[12:15], s40 offen lds
    s_add_u32 m0, s42, 106496
    s_mov_b32 s40, 3407872
    buffer_load_dwordx4 v40, s[12:15], s40 offen lds
    s_add_u32 m0, s42, 110592
    s_mov_b32 s40, 3538944
    buffer_load_dwordx4 v40, s[12:15], s40 offen lds
    s_waitcnt vmcnt(32)
    s_barrier
    v_add_u32 v6, 130816, v1
    v_xor_b32 v5, 0x80, v6
    ds_read_b64_tr_b16 v[176:177], v6 offset:0
    ds_read_b64_tr_b16 v[178:179], v6 offset:512
    ds_read_b64_tr_b16 v[180:181], v6 offset:8192
    ds_read_b64_tr_b16 v[182:183], v6 offset:8704
    ds_read_b64_tr_b16 v[184:185], v5 offset:0
    ds_read_b64_tr_b16 v[186:187], v5 offset:512
    ds_read_b64_tr_b16 v[188:189], v5 offset:8192
    ds_read_b64_tr_b16 v[190:191], v5 offset:8704
    s_waitcnt lgkmcnt(0)
    s_barrier
    s_add_u32 m0, s42, 114688
    s_mov_b32 s40, 3670016
    buffer_load_dwordx4 v40, s[12:15], s40 offen lds
    s_add_u32 m0, s42, 118784
    s_mov_b32 s40, 3801088
    buffer_load_dwordx4 v40, s[12:15], s40 offen lds
    s_add_u32 m0, s42, 122880
    s_mov_b32 s40, 3932160
    buffer_load_dwordx4 v40, s[12:15], s40 offen lds
    s_add_u32 m0, s42, 126976
    s_mov_b32 s40, 4063232
    buffer_load_dwordx4 v40, s[12:15], s40 offen lds
    s_waitcnt vmcnt(32)
    s_barrier
    v_add_u32 v6, 147200, v1
    v_xor_b32 v5, 0x80, v6
    ds_read_b64_tr_b16 v[224:225], v6 offset:0
    ds_read_b64_tr_b16 v[226:227], v6 offset:512
    ds_read_b64_tr_b16 v[228:229], v6 offset:8192
    ds_read_b64_tr_b16 v[230:231], v6 offset:8704
    ds_read_b64_tr_b16 v[232:233], v5 offset:0
    ds_read_b64_tr_b16 v[234:235], v5 offset:512
    ds_read_b64_tr_b16 v[236:237], v5 offset:8192
    ds_read_b64_tr_b16 v[238:239], v5 offset:8704
    s_waitcnt lgkmcnt(0)
    s_barrier
    s_add_u32 m0, s42, 131072
    s_mov_b32 s40, 4194304
    buffer_load_dwordx4 v40, s[12:15], s40 offen lds
    s_add_u32 m0, s42, 135168
    s_mov_b32 s40, 4325376
    buffer_load_dwordx4 v40, s[12:15], s40 offen lds
    s_add_u32 m0, s42, 139264
    s_mov_b32 s40, 4456448
    buffer_load_dwordx4 v40, s[12:15], s40 offen lds
    s_add_u32 m0, s42, 143360
    s_mov_b32 s40, 4587520
    buffer_load_dwordx4 v40, s[12:15], s40 offen lds
    s_waitcnt vmcnt(32)
    s_barrier
    v_add_u32 v6, 16128, v1
    v_xor_b32 v5, 0x80, v6
    ds_read_b64_tr_b16 a[32:33], v6 offset:0
    ds_read_b64_tr_b16 a[34:35], v6 offset:512
    ds_read_b64_tr_b16 a[36:37], v6 offset:8192
    ds_read_b64_tr_b16 a[38:39], v6 offset:8704
    ds_read_b64_tr_b16 a[40:41], v5 offset:0
    ds_read_b64_tr_b16 a[42:43], v5 offset:512
    ds_read_b64_tr_b16 a[44:45], v5 offset:8192
    ds_read_b64_tr_b16 a[46:47], v5 offset:8704
    s_waitcnt lgkmcnt(0)
    s_barrier
    s_load_dwordx2 s[12:13], s[0:1], 40
    s_waitcnt lgkmcnt(0)
    s_and_b32 s13, s13, 0xffff
    s_mov_b32 s14, 4718592
    s_mov_b32 s15, 0x00020000
    s_lshl_b32 s40, s16, 7
    s_lshr_b32 s41, s17, 1
    s_lshl_b32 s41, s41, 6
    s_add_u32 s40, s40, s41
    s_and_b32 s41, s17, 1
    s_lshl_b32 s41, s41, 4
    s_add_u32 s40, s40, s41
    s_add_u32 s40, s40, 32
    s_mul_i32 s40, s40, 1152
    s_mul_i32 s42, s17, 18464
    s_add_u32 s42, s42, 89984
    s_add_u32 m0, s42, 0
    s_add_u32 s41, s40, 0
    s_nop 0
    buffer_load_dwordx4 v[8:11], v0, s[12:15], s41 offen offset:0
    buffer_load_dwordx4 v[12:15], v0, s[12:15], s41 offen offset:1024
    buffer_load_dwordx4 v[16:19], v0, s[12:15], s41 offen offset:2048
    buffer_load_dwordx4 v[20:23], v0, s[12:15], s41 offen offset:3072
    s_add_u32 m0, s42, 4096
    s_add_u32 s41, s40, 4096
    buffer_load_dwordx4 v[24:27], v0, s[12:15], s41 offen offset:0
    buffer_load_dwordx4 v[28:31], v0, s[12:15], s41 offen offset:1024
    buffer_load_dwordx4 v[32:35], v0, s[12:15], s41 offen offset:2048
    buffer_load_dwordx4 v[36:39], v0, s[12:15], s41 offen offset:3072
    s_add_u32 m0, s42, 8192
    s_add_u32 s41, s40, 8192
    buffer_load_dwordx4 v[40:43], v0, s[12:15], s41 offen offset:0
    buffer_load_dwordx4 v[44:47], v0, s[12:15], s41 offen offset:1024
    buffer_load_dwordx4 v[48:51], v0, s[12:15], s41 offen offset:2048
    buffer_load_dwordx4 v[52:55], v0, s[12:15], s41 offen offset:3072
    s_add_u32 m0, s42, 12288
    s_add_u32 s41, s40, 12288
    buffer_load_dwordx4 v[56:59], v0, s[12:15], s41 offen offset:0
    buffer_load_dwordx4 v[60:63], v0, s[12:15], s41 offen offset:1024
    buffer_load_dwordx4 v[64:67], v0, s[12:15], s41 offen offset:2048
    buffer_load_dwordx4 v[68:71], v0, s[12:15], s41 offen offset:3072
    s_add_u32 m0, s42, 16384
    s_add_u32 s41, s40, 16384
    buffer_load_dwordx4 v[72:75], v0, s[12:15], s41 offen offset:0
    buffer_load_dwordx4 v[76:79], v0, s[12:15], s41 offen offset:1024
    s_waitcnt vmcnt(46)
    s_barrier
    v_add_u32 v6, 32512, v1
    v_xor_b32 v5, 0x80, v6
    ds_read_b64_tr_b16 a[80:81], v6 offset:0
    ds_read_b64_tr_b16 a[82:83], v6 offset:512
    ds_read_b64_tr_b16 a[84:85], v6 offset:8192
    ds_read_b64_tr_b16 a[86:87], v6 offset:8704
    ds_read_b64_tr_b16 a[88:89], v5 offset:0
    ds_read_b64_tr_b16 a[90:91], v5 offset:512
    ds_read_b64_tr_b16 a[92:93], v5 offset:8192
    ds_read_b64_tr_b16 a[94:95], v5 offset:8704
    s_waitcnt lgkmcnt(0)
    s_barrier
    s_waitcnt vmcnt(42)
    s_barrier
    v_add_u32 v6, 48896, v1
    v_xor_b32 v5, 0x80, v6
    ds_read_b64_tr_b16 a[128:129], v6 offset:0
    ds_read_b64_tr_b16 a[130:131], v6 offset:512
    ds_read_b64_tr_b16 a[132:133], v6 offset:8192
    ds_read_b64_tr_b16 a[134:135], v6 offset:8704
    ds_read_b64_tr_b16 a[136:137], v5 offset:0
    ds_read_b64_tr_b16 a[138:139], v5 offset:512
    ds_read_b64_tr_b16 a[140:141], v5 offset:8192
    ds_read_b64_tr_b16 a[142:143], v5 offset:8704
    s_waitcnt lgkmcnt(0)
    s_barrier
    s_waitcnt vmcnt(38)
    s_barrier
    v_add_u32 v6, 65280, v1
    v_xor_b32 v5, 0x80, v6
    ds_read_b64_tr_b16 a[176:177], v6 offset:0
    ds_read_b64_tr_b16 a[178:179], v6 offset:512
    ds_read_b64_tr_b16 a[180:181], v6 offset:8192
    ds_read_b64_tr_b16 a[182:183], v6 offset:8704
    ds_read_b64_tr_b16 a[184:185], v5 offset:0
    ds_read_b64_tr_b16 a[186:187], v5 offset:512
    ds_read_b64_tr_b16 a[188:189], v5 offset:8192
    ds_read_b64_tr_b16 a[190:191], v5 offset:8704
    s_waitcnt lgkmcnt(0)
    s_barrier
    s_waitcnt vmcnt(34)
    s_barrier
    v_add_u32 v6, 81664, v1
    v_xor_b32 v5, 0x80, v6
    ds_read_b64_tr_b16 a[224:225], v6 offset:0
    ds_read_b64_tr_b16 a[226:227], v6 offset:512
    ds_read_b64_tr_b16 a[228:229], v6 offset:8192
    ds_read_b64_tr_b16 a[230:231], v6 offset:8704
    ds_read_b64_tr_b16 a[232:233], v5 offset:0
    ds_read_b64_tr_b16 a[234:235], v5 offset:512
    ds_read_b64_tr_b16 a[236:237], v5 offset:8192
    ds_read_b64_tr_b16 a[238:239], v5 offset:8704
    s_waitcnt lgkmcnt(0)
    s_barrier
    s_load_dwordx2 s[12:13], s[0:1], 40
    s_waitcnt lgkmcnt(0)
    s_and_b32 s13, s13, 0xffff
    s_mov_b32 s14, 4718592
    s_mov_b32 s15, 0x00020000
    s_lshl_b32 s40, s16, 7
    s_lshr_b32 s41, s17, 1
    s_lshl_b32 s41, s41, 6
    s_add_u32 s40, s40, s41
    s_and_b32 s41, s17, 1
    s_lshl_b32 s41, s41, 4
    s_add_u32 s40, s40, s41
    s_add_u32 s40, s40, 0
    s_mul_i32 s40, s40, 1152
    s_mul_i32 s42, s17, 18464
    s_add_u32 s42, s42, 16128
    s_add_u32 m0, s42, 0
    s_add_u32 s41, s40, 0
    s_nop 0
    buffer_load_dwordx4 v0, s[12:15], s41 offen offset:0 lds
    buffer_load_dwordx4 v0, s[12:15], s41 offen offset:1024 lds
    buffer_load_dwordx4 v0, s[12:15], s41 offen offset:2048 lds
    buffer_load_dwordx4 v0, s[12:15], s41 offen offset:3072 lds
    s_add_u32 m0, s42, 4096
    s_add_u32 s41, s40, 4096
    buffer_load_dwordx4 v0, s[12:15], s41 offen offset:0 lds
    buffer_load_dwordx4 v0, s[12:15], s41 offen offset:1024 lds
    buffer_load_dwordx4 v0, s[12:15], s41 offen offset:2048 lds
    buffer_load_dwordx4 v0, s[12:15], s41 offen offset:3072 lds
    s_add_u32 m0, s42, 8192
    s_add_u32 s41, s40, 8192
    buffer_load_dwordx4 v0, s[12:15], s41 offen offset:0 lds
    buffer_load_dwordx4 v0, s[12:15], s41 offen offset:1024 lds
    buffer_load_dwordx4 v0, s[12:15], s41 offen offset:2048 lds
    buffer_load_dwordx4 v0, s[12:15], s41 offen offset:3072 lds
    s_add_u32 m0, s42, 12288
    s_add_u32 s41, s40, 12288
    buffer_load_dwordx4 v0, s[12:15], s41 offen offset:0 lds
    buffer_load_dwordx4 v0, s[12:15], s41 offen offset:1024 lds
    buffer_load_dwordx4 v0, s[12:15], s41 offen offset:2048 lds
    buffer_load_dwordx4 v0, s[12:15], s41 offen offset:3072 lds
    s_add_u32 m0, s42, 16384
    s_add_u32 s41, s40, 16384
    buffer_load_dwordx4 v0, s[12:15], s41 offen offset:0 lds
    buffer_load_dwordx4 v0, s[12:15], s41 offen offset:1024 lds
    s_waitcnt vmcnt(48)
    s_barrier
    v_add_u32 v6, 98048, v1
    v_xor_b32 v5, 0x80, v6
    ds_read_b64_tr_b16 v[96:97], v6 offset:0
    ds_read_b64_tr_b16 v[98:99], v6 offset:512
    ds_read_b64_tr_b16 v[100:101], v6 offset:8192
    ds_read_b64_tr_b16 v[102:103], v6 offset:8704
    ds_read_b64_tr_b16 v[104:105], v5 offset:0
    ds_read_b64_tr_b16 v[106:107], v5 offset:512
    ds_read_b64_tr_b16 v[108:109], v5 offset:8192
    ds_read_b64_tr_b16 v[110:111], v5 offset:8704
    s_waitcnt lgkmcnt(0)
    s_barrier
    s_waitcnt vmcnt(44)
    s_barrier
    v_add_u32 v6, 114432, v1
    v_xor_b32 v5, 0x80, v6
    ds_read_b64_tr_b16 v[144:145], v6 offset:0
    ds_read_b64_tr_b16 v[146:147], v6 offset:512
    ds_read_b64_tr_b16 v[148:149], v6 offset:8192
    ds_read_b64_tr_b16 v[150:151], v6 offset:8704
    ds_read_b64_tr_b16 v[152:153], v5 offset:0
    ds_read_b64_tr_b16 v[154:155], v5 offset:512
    ds_read_b64_tr_b16 v[156:157], v5 offset:8192
    ds_read_b64_tr_b16 v[158:159], v5 offset:8704
    s_waitcnt lgkmcnt(0)
    s_barrier
    s_waitcnt vmcnt(40)
    s_barrier
    v_add_u32 v6, 130816, v1
    v_xor_b32 v5, 0x80, v6
    ds_read_b64_tr_b16 v[192:193], v6 offset:0
    ds_read_b64_tr_b16 v[194:195], v6 offset:512
    ds_read_b64_tr_b16 v[196:197], v6 offset:8192
    ds_read_b64_tr_b16 v[198:199], v6 offset:8704
    ds_read_b64_tr_b16 v[200:201], v5 offset:0
    ds_read_b64_tr_b16 v[202:203], v5 offset:512
    ds_read_b64_tr_b16 v[204:205], v5 offset:8192
    ds_read_b64_tr_b16 v[206:207], v5 offset:8704
    s_waitcnt lgkmcnt(0)
    s_barrier
    s_waitcnt vmcnt(36)
    s_barrier
    v_add_u32 v6, 147200, v1
    v_xor_b32 v5, 0x80, v6
    ds_read_b64_tr_b16 v[240:241], v6 offset:0
    ds_read_b64_tr_b16 v[242:243], v6 offset:512
    ds_read_b64_tr_b16 v[244:245], v6 offset:8192
    ds_read_b64_tr_b16 v[246:247], v6 offset:8704
    ds_read_b64_tr_b16 v[248:249], v5 offset:0
    ds_read_b64_tr_b16 v[250:251], v5 offset:512
    ds_read_b64_tr_b16 v[252:253], v5 offset:8192
    ds_read_b64_tr_b16 v[254:255], v5 offset:8704
    s_waitcnt lgkmcnt(0)
    s_barrier
    s_mul_i32 s40, s17, 18464
    v_add_u32_e64 v6, s40, v0
    v_add_u32 v6, 89984, v6
    s_waitcnt vmcnt(18)
    s_nop 0
    ds_write_b128 v6, v[8:11] offset:0
    ds_write_b128 v6, v[12:15] offset:1024
    ds_write_b128 v6, v[16:19] offset:2048
    ds_write_b128 v6, v[20:23] offset:3072
    ds_write_b128 v6, v[24:27] offset:4096
    ds_write_b128 v6, v[28:31] offset:5120
    s_waitcnt lgkmcnt(0)
    s_nop 0
    ds_write_b128 v6, v[32:35] offset:6144
    ds_write_b128 v6, v[36:39] offset:7168
    ds_write_b128 v6, v[40:43] offset:8192
    ds_write_b128 v6, v[44:47] offset:9216
    ds_write_b128 v6, v[48:51] offset:10240
    ds_write_b128 v6, v[52:55] offset:11264
    s_waitcnt lgkmcnt(0)
    s_nop 0
    ds_write_b128 v6, v[56:59] offset:12288
    ds_write_b128 v6, v[60:63] offset:13312
    ds_write_b128 v6, v[64:67] offset:14336
    ds_write_b128 v6, v[68:71] offset:15360
    ds_write_b128 v6, v[72:75] offset:16384
    ds_write_b128 v6, v[76:79] offset:17408
    s_waitcnt lgkmcnt(0)
    s_lshl_b32 s40, s17, 14
    v_add_u32_e64 v2, s40, v0
    v_add_u32 v2, 23808, v2
    s_mul_i32 s40, s17, 18432
    v_add_u32_e64 v3, s40, v0
    v_add_u32 v3, 89344, v3
    s_lshl_b32 s40, s17, 11
    v_add_u32 v5, s40, v0
    s_waitcnt vmcnt(0)
    s_barrier
    v_add_u32 v4, 16128, v7
    ds_read_b64_tr_b16 v[8:9], v4 offset:0
    ds_read_b64_tr_b16 v[10:11], v4 offset:2304
    ds_read_b64_tr_b16 v[12:13], v4 offset:9216
    ds_read_b64_tr_b16 v[14:15], v4 offset:11520
    ds_read_b64_tr_b16 v[16:17], v4 offset:128
    ds_read_b64_tr_b16 v[18:19], v4 offset:2432
    ds_read_b64_tr_b16 v[20:21], v4 offset:9344
    ds_read_b64_tr_b16 v[22:23], v4 offset:11648
    ds_read_b64_tr_b16 v[24:25], v4 offset:256
    ds_read_b64_tr_b16 v[26:27], v4 offset:2560
    ds_read_b64_tr_b16 v[28:29], v4 offset:9472
    ds_read_b64_tr_b16 v[30:31], v4 offset:11776
    s_waitcnt lgkmcnt(0)
    s_nop 0
    ds_read_b64_tr_b16 v[32:33], v4 offset:384
    ds_read_b64_tr_b16 v[34:35], v4 offset:2688
    ds_read_b64_tr_b16 v[36:37], v4 offset:9600
    ds_read_b64_tr_b16 v[38:39], v4 offset:11904
    ds_read_b64_tr_b16 v[40:41], v4 offset:512
    ds_read_b64_tr_b16 v[42:43], v4 offset:2816
    ds_read_b64_tr_b16 v[44:45], v4 offset:9728
    ds_read_b64_tr_b16 v[46:47], v4 offset:12032
    ds_read_b64_tr_b16 v[48:49], v4 offset:640
    ds_read_b64_tr_b16 v[50:51], v4 offset:2944
    ds_read_b64_tr_b16 v[52:53], v4 offset:9856
    ds_read_b64_tr_b16 v[54:55], v4 offset:12160
    s_waitcnt lgkmcnt(0)
    s_nop 0
    ds_read_b64_tr_b16 v[56:57], v4 offset:768
    ds_read_b64_tr_b16 v[58:59], v4 offset:3072
    ds_read_b64_tr_b16 v[60:61], v4 offset:9984
    ds_read_b64_tr_b16 v[62:63], v4 offset:12288
    ds_read_b64_tr_b16 v[64:65], v4 offset:896
    ds_read_b64_tr_b16 v[66:67], v4 offset:3200
    ds_read_b64_tr_b16 v[68:69], v4 offset:10112
    ds_read_b64_tr_b16 v[70:71], v4 offset:12416
    ds_read_b64_tr_b16 v[72:73], v4 offset:1024
    ds_read_b64_tr_b16 v[74:75], v4 offset:3328
    ds_read_b64_tr_b16 v[76:77], v4 offset:10240
    ds_read_b64_tr_b16 v[78:79], v4 offset:12544
    s_waitcnt lgkmcnt(0)
    s_barrier
    ds_write_b128 v5, v[8:11] offset:0
    ds_write_b128 v5, v[12:15] offset:1024
    ds_write_b128 v2, v[16:19] offset:0
    ds_write_b128 v2, v[20:23] offset:1024
    ds_write_b128 v2, v[24:27] offset:2048
    ds_write_b128 v2, v[28:31] offset:3072
    s_waitcnt lgkmcnt(0)
    s_nop 0
    ds_write_b128 v2, v[32:35] offset:4096
    ds_write_b128 v2, v[36:39] offset:5120
    ds_write_b128 v2, v[40:43] offset:6144
    ds_write_b128 v2, v[44:47] offset:7168
    ds_write_b128 v2, v[48:51] offset:8192
    ds_write_b128 v2, v[52:55] offset:9216
    s_waitcnt lgkmcnt(0)
    s_nop 0
    ds_write_b128 v2, v[56:59] offset:10240
    ds_write_b128 v2, v[60:63] offset:11264
    ds_write_b128 v2, v[64:67] offset:12288
    ds_write_b128 v2, v[68:71] offset:13312
    ds_write_b128 v2, v[72:75] offset:14336
    ds_write_b128 v2, v[76:79] offset:15360
    s_waitcnt lgkmcnt(0)
    s_waitcnt vmcnt(0)
    s_barrier
    s_nop 0
    v_add_u32 v4, 89984, v7
    ds_read_b64_tr_b16 v[8:9], v4 offset:0
    ds_read_b64_tr_b16 v[10:11], v4 offset:2304
    ds_read_b64_tr_b16 v[12:13], v4 offset:9216
    ds_read_b64_tr_b16 v[14:15], v4 offset:11520
    ds_read_b64_tr_b16 v[16:17], v4 offset:128
    ds_read_b64_tr_b16 v[18:19], v4 offset:2432
    ds_read_b64_tr_b16 v[20:21], v4 offset:9344
    ds_read_b64_tr_b16 v[22:23], v4 offset:11648
    ds_read_b64_tr_b16 v[24:25], v4 offset:256
    ds_read_b64_tr_b16 v[26:27], v4 offset:2560
    ds_read_b64_tr_b16 v[28:29], v4 offset:9472
    ds_read_b64_tr_b16 v[30:31], v4 offset:11776
    s_waitcnt lgkmcnt(0)
    s_nop 0
    ds_read_b64_tr_b16 v[32:33], v4 offset:384
    ds_read_b64_tr_b16 v[34:35], v4 offset:2688
    ds_read_b64_tr_b16 v[36:37], v4 offset:9600
    ds_read_b64_tr_b16 v[38:39], v4 offset:11904
    ds_read_b64_tr_b16 v[40:41], v4 offset:512
    ds_read_b64_tr_b16 v[42:43], v4 offset:2816
    ds_read_b64_tr_b16 v[44:45], v4 offset:9728
    ds_read_b64_tr_b16 v[46:47], v4 offset:12032
    ds_read_b64_tr_b16 v[48:49], v4 offset:640
    ds_read_b64_tr_b16 v[50:51], v4 offset:2944
    ds_read_b64_tr_b16 v[52:53], v4 offset:9856
    ds_read_b64_tr_b16 v[54:55], v4 offset:12160
    s_waitcnt lgkmcnt(0)
    s_nop 0
    ds_read_b64_tr_b16 v[56:57], v4 offset:768
    ds_read_b64_tr_b16 v[58:59], v4 offset:3072
    ds_read_b64_tr_b16 v[60:61], v4 offset:9984
    ds_read_b64_tr_b16 v[62:63], v4 offset:12288
    ds_read_b64_tr_b16 v[64:65], v4 offset:896
    ds_read_b64_tr_b16 v[66:67], v4 offset:3200
    ds_read_b64_tr_b16 v[68:69], v4 offset:10112
    ds_read_b64_tr_b16 v[70:71], v4 offset:12416
    ds_read_b64_tr_b16 v[72:73], v4 offset:1024
    ds_read_b64_tr_b16 v[74:75], v4 offset:3328
    ds_read_b64_tr_b16 v[76:77], v4 offset:10240
    ds_read_b64_tr_b16 v[78:79], v4 offset:12544
    s_waitcnt lgkmcnt(0)
    s_barrier
    ds_write_b128 v3, v[8:11] offset:0
    ds_write_b128 v3, v[12:15] offset:1024
    ds_write_b128 v3, v[16:19] offset:2048
    ds_write_b128 v3, v[20:23] offset:3072
    ds_write_b128 v3, v[24:27] offset:4096
    ds_write_b128 v3, v[28:31] offset:5120
    s_waitcnt lgkmcnt(0)
    s_nop 0
    ds_write_b128 v3, v[32:35] offset:6144
    ds_write_b128 v3, v[36:39] offset:7168
    ds_write_b128 v3, v[40:43] offset:8192
    ds_write_b128 v3, v[44:47] offset:9216
    ds_write_b128 v3, v[48:51] offset:10240
    ds_write_b128 v3, v[52:55] offset:11264
    s_waitcnt lgkmcnt(0)
    s_nop 0
    ds_write_b128 v3, v[56:59] offset:12288
    ds_write_b128 v3, v[60:63] offset:13312
    ds_write_b128 v3, v[64:67] offset:14336
    ds_write_b128 v3, v[68:71] offset:15360
    ds_write_b128 v3, v[72:75] offset:16384
    ds_write_b128 v3, v[76:79] offset:17408
    s_waitcnt lgkmcnt(0)
    ds_read_b128 v[16:19], v5
    ds_read_b128 v[20:23], v5 offset:1024
    v_mov_b32 v7, v2
    v_mov_b32 v11, v3
    s_waitcnt lgkmcnt(0)
    v_mbcnt_lo_u32_b32 v30, -1, 0
    v_mbcnt_hi_u32_b32 v30, -1, v30
    v_mov_b32 v31, s17
    v_and_b32 v32, 15, v30
    v_lshrrev_b32 v33, 4, v30
    v_and_b32 v34, 3, v30
    v_bfe_u32 v35, v30, 2, 2
    v_mov_b32 v36, 0x4444
    v_mov_b32 v37, 0xeeee
    v_cndmask_b32 v1, v37, v36, s[78:79]
    v_and_b32 v36, 3, v32
    v_lshlrev_b32 v2, 5, v36
    v_bfe_u32 v36, v32, 3, 1
    v_lshl_add_u32 v2, v36, 7, v2
    v_bfe_u32 v36, v32, 2, 1
    v_lshl_add_u32 v2, v36, 8, v2
    v_lshl_add_u32 v2, v31, 9, v2
    v_and_b32_e64 v37, 1, v33
    v_lshl_add_u32 v2, v33, 3, v2
    v_add_u32 v2, 2048, v2
    v_lshlrev_b32_e64 v3, 5, v35
    v_lshl_add_u32 v3, v37, 7, v3
    v_lshrrev_b32_e64 v38, 1, v33
    v_lshl_add_u32 v3, v38, 9, v3
    v_lshl_add_u32 v3, v34, 3, v3
    v_add_u32 v3, 2048, v3
    v_lshlrev_b32_e64 v4, 9, v33
    v_lshl_add_u32 v4, v32, 4, v4
    v_add_u32 v4, 6144, v4
    v_lshrrev_b32 v36, 2, v32
    v_lshlrev_b32 v6, 5, v36
    v_and_b32_e64 v36, 1, v32
    v_lshl_add_u32 v6, v36, 4, v6
    v_lshl_add_u32 v6, v33, 7, v6
    v_lshl_add_u32 v5, v31, 9, v6
    v_bfe_u32 v36, v32, 1, 1
    v_lshl_add_u32 v6, v36, 9, v6
    v_lshlrev_b32_e64 v12, 10, v33
    v_lshl_add_u32 v12, v31, 8, v12
    v_lshl_add_u32 v12, v32, 4, v12
    v_lshrrev_b32_e64 v36, 3, v30
    v_mul_u32_u24 v8, 4224, v36
    v_and_b32_e64 v36, 7, v32
    v_lshl_add_u32 v8, v36, 4, v8
    s_cmp_lt_u32 s48, 64
    s_cselect_b32 s43, 10, 8
    v_bfe_u32 v36, v32, 1, 2
    v_lshlrev_b32_e64 v10, s43, v36
    v_lshl_add_u32 v10, v33, 2, v10
    v_and_b32_e64 v36, 1, v32
    v_lshl_add_u32 v10, v36, 4, v10
    v_lshrrev_b32_e64 v36, 3, v32
    v_lshl_add_u32 v10, v36, 30, v10
    v_and_b32 v36, 1, v32
    v_lshlrev_b32 v9, 8, v33
    v_lshl_add_u32 v9, v36, 7, v9
    v_lshrrev_b32_e64 v38, 1, v32
    v_lshl_add_u32 v9, v38, 4, v9
    v_cmp_eq_u32 s[24:25], 1, v36
    v_cmp_eq_u32 s[26:27], 0, v38
    v_cmp_eq_u32 s[28:29], 1, v38
    v_cmp_eq_u32 s[30:31], 2, v38
    v_cmp_eq_u32 s[32:33], 3, v38
    v_mov_b32_e64 v36, 36
CH_RDY:
    buffer_load_dword v37, v36, s[8:11], 0 offen sc1
    s_waitcnt vmcnt(0)
    v_readfirstlane_b32 s40, v37
    s_nop 3
    s_lshr_b32 s87, s40, 16
    s_and_b32 s40, s40, 0xffff
    s_cmp_ge_u32 s40, 32
    s_cbranch_scc1 CH_RDYD
    s_sleep 16
    s_sub_u32 s19, s19, 1
    s_cbranch_scc0 CH_RDY
    s_mov_b32 s19, 0
CH_RDYD:
    s_mov_b32 s18, 0
    s_lshl_b32 s54, s16, 19
    s_mov_b32 s20, 63963136
    s_cmp_lg_u32 s17, 3
    s_cbranch_scc1 CH_KV0D
    s_mov_b32 s40, 0
    v_bfe_u32 v36, v0, 4, 3
    v_lshlrev_b32 v36, 2, v36
CH_KV0_A:
    buffer_load_dword v37, v36, s[8:11], 0 offen offset:128 sc1
    s_waitcnt vmcnt(0)
    v_cmp_gt_u32 vcc, 8, v37
    s_cbranch_vccz CH_KV0_B
    s_sleep 12
    s_sub_u32 s19, s19, 1
    s_cbranch_scc0 CH_KV0_A
    s_mov_b32 s19, 0
CH_KV0_B:
    s_lshl_b32 s41, s40, 8
    s_add_u32 s41, s41, s16
    s_lshl_b32 s41, s41, 2
    s_add_u32 s41, s41, 64552960
    v_mov_b32 v36, 0
    s_lshl_b32 s41, s16, 4
    s_add_u32 s41, s41, 64561152
    v_bfe_u32 v36, v0, 4, 2
    v_lshlrev_b32_e64 v36, 2, v36
CH_KV0_C:
    buffer_load_dword v37, v36, s[4:7], s41 offen sc1
    s_waitcnt vmcnt(0)
    v_cmp_eq_u32 vcc, 0, v37
    s_cbranch_vccz CH_KV0D
    s_sleep 4
    s_sub_u32 s19, s19, 1
    s_cbranch_scc0 CH_KV0_C
    s_mov_b32 s19, 0
CH_KV0D:
    s_barrier
    s_mov_b32 m0, s59
    s_add_u32 s41, s54, s58
    buffer_load_dwordx4 v0, s[4:7], s41 offen lds
    buffer_load_dwordx4 v0, s[4:7], s41 offen offset:1024 lds
    s_add_u32 s58, s58, 8192
    v_lshlrev_b32_e64 v36, 2, v0
    s_mov_b32 m0, 23552
    s_add_u32 s40, s54, s47
    s_add_u32 s41, s40, 8192
    buffer_load_dword v36, s[4:7], s40 offen lds
    buffer_load_dword v36, s[4:7], s41 offen lds
    s_xor_b32 s86, s17, 3
    s_add_u32 s34, s20, 4096
    s_add_u32 s35, s20, 8192
    v_and_b32 v14, 0x3ff, v12
    s_add_u32 s36, s57, s54
    s_add_u32 s37, s36, 4096
    s_min_u32 s38, s18, 61
    s_sub_u32 s38, s38, s18
    s_lshl_b32 s38, s38, 13
    s_add_u32 s38, s38, s54
    s_add_u32 s38, s38, s47
    s_add_u32 s38, s38, 16384
    s_lshr_b32 s39, s54, 1
    s_add_u32 s39, s39, s55
    s_lshr_b32 s46, s54, 2
    s_add_u32 s46, s46, s56
    s_mov_b32 m0, 23552
    s_add_u32 s85, s18, 3
    s_and_b32 s85, s85, 0x47
    s_or_b32 s85, s85, s86
    v_mov_b64 v[40:41], 0
    v_mov_b64 v[42:43], 0
    v_mov_b64 v[44:45], 0
    v_mov_b64 v[46:47], 0
    v_mov_b64 v[48:49], 0
    v_mov_b64 v[50:51], 0
    v_mov_b64 v[52:53], 0
    v_mov_b64 v[54:55], 0
    v_mov_b64 v[56:57], 0
    v_mov_b64 v[58:59], 0
    v_mov_b64 v[60:61], 0
    v_mov_b64 v[62:63], 0
    s_cmp_lg_u32 s87, 0
    s_cbranch_scc1 CHS_ENTRY
    s_mov_b32 s90, 0
    s_mov_b32 s91, 0
    s_mov_b32 s92, 0
CH_LOOP:
    buffer_load_dwordx4 v[76:79], v12, s[4:7], s20 offen sc1
    s_waitcnt vmcnt(0)
CH_FC:
    v_max3_u32 v13, v76, v77, v78
    ds_write_b128 v12, v[76:79] offset:14336
    v_max_u32 v13, v13, v79
    v_cmp_eq_u32 vcc, -1, v13
    s_and_b32 s43, s18, 1
    s_mul_i32 s43, s43, 305152
    s_bfe_u32 s21, s18, 0x10001
    s_cbranch_vccnz CH_RF
CH_FOK:
    s_waitcnt lgkmcnt(0)
    s_barrier
    ds_read_b128 v[24:27], v0 offset:14336
    ds_read_b128 v[28:31], v0 offset:15360
    ds_read_b128 v[32:35], v0 offset:16384
    ds_read_b128 v[36:39], v0 offset:17408
    buffer_load_dwordx4 v[72:75], v12, s[4:7], s34 offen sc1
    buffer_load_dwordx4 v[76:79], v14, s[4:7], s35 offen sc1
    s_waitcnt lgkmcnt(3)
    v_smfmac_f32_16x16x64_bf16 v[40:43], v[24:27], a[0:7], v1
    buffer_load_dwordx4 v[64:67], v0, s[4:7], s36 offen
    v_smfmac_f32_16x16x64_bf16 v[44:47], v[24:27], a[8:15], v1
    buffer_load_dwordx4 v[68:71], v0, s[4:7], s37 offen
    v_smfmac_f32_16x16x64_bf16 v[48:51], v[24:27], a[16:23], v1
    v_smfmac_f32_16x16x64_bf16 v[52:55], v[24:27], a[24:31], v1
    ds_read_b128 v[24:27], v0 offset:14336
    s_waitcnt lgkmcnt(3)
    v_smfmac_f32_16x16x64_bf16 v[40:43], v[28:31], a[48:55], v1
    v_smfmac_f32_16x16x64_bf16 v[44:47], v[28:31], a[56:63], v1
    v_smfmac_f32_16x16x64_bf16 v[48:51], v[28:31], a[64:71], v1
    v_smfmac_f32_16x16x64_bf16 v[52:55], v[28:31], a[72:79], v1
    ds_read_b128 v[28:31], v0 offset:15360
    s_waitcnt lgkmcnt(3)
    v_smfmac_f32_16x16x64_bf16 v[40:43], v[32:35], a[96:103], v1
    v_smfmac_f32_16x16x64_bf16 v[44:47], v[32:35], a[104:111], v1
    v_smfmac_f32_16x16x64_bf16 v[48:51], v[32:35], a[112:119], v1
    v_smfmac_f32_16x16x64_bf16 v[52:55], v[32:35], a[120:127], v1
    s_waitcnt lgkmcnt(2)
    v_smfmac_f32_16x16x64_bf16 v[40:43], v[36:39], a[144:151], v1
    v_smfmac_f32_16x16x64_bf16 v[44:47], v[36:39], a[152:159], v1
    v_smfmac_f32_16x16x64_bf16 v[48:51], v[36:39], a[160:167], v1
    v_smfmac_f32_16x16x64_bf16 v[52:55], v[36:39], a[168:175], v1
    s_waitcnt vmcnt(2)
    v_max3_u32 v13, v72, v73, v74
    v_max3_u32 v13, v13, v75, v76
    v_max3_u32 v13, v13, v77, v78
    v_max_u32 v13, v13, v79
    v_cmp_eq_u32_e64 vcc, -1, v13
    ds_write_b128 v12, v[72:75] offset:18432
    ds_write_b128 v14, v[76:79] offset:22528
    s_waitcnt lgkmcnt(3)
    v_smfmac_f32_16x16x64_bf16 v[56:59], v[24:27], a[32:39], v1
    v_smfmac_f32_16x16x64_bf16 v[60:63], v[24:27], a[40:47], v1
    s_cbranch_vccnz CH_RF2
CH_F2OK:
    s_waitcnt lgkmcnt(0)
    s_barrier
    ds_read_b128 v[32:35], v0 offset:18432
    ds_read_b128 v[36:39], v0 offset:19456
    ds_read_b128 v[24:27], v0 offset:20480
    v_lshlrev_b32 v14, 2, v0
    v_mov_b32 v15, s18
    buffer_load_dword v14, s[4:7], s38 offen lds
    buffer_store_dword v15, off, s[4:7], s53 sc1
    v_smfmac_f32_16x16x64_bf16 v[56:59], v[28:31], a[80:87], v1
    v_lshrrev_b32_e64 v13, 1, v0
    v_smfmac_f32_16x16x64_bf16 v[60:63], v[28:31], a[88:95], v1
    ds_read_b128 v[28:31], v0 offset:21504
    s_waitcnt lgkmcnt(3)
    v_smfmac_f32_16x16x64_bf16 v[40:43], v[32:35], a[192:199], v1
    v_smfmac_f32_16x16x64_bf16 v[44:47], v[32:35], a[200:207], v1
    v_smfmac_f32_16x16x64_bf16 v[48:51], v[32:35], a[208:215], v1
    v_smfmac_f32_16x16x64_bf16 v[52:55], v[32:35], a[216:223], v1
    ds_read_b128 v[32:35], v0 offset:22528
    s_waitcnt lgkmcnt(3)
    v_smfmac_f32_16x16x64_bf16 v[40:43], v[36:39], a[240:247], v1
    v_smfmac_f32_16x16x64_bf16 v[44:47], v[36:39], a[248:255], v1
    v_smfmac_f32_16x16x64_bf16 v[48:51], v[36:39], v[80:87], v1
    v_smfmac_f32_16x16x64_bf16 v[52:55], v[36:39], v[88:95], v1
    ds_read_b128 v[36:39], v0 offset:16384
    s_waitcnt lgkmcnt(3)
    v_smfmac_f32_16x16x64_bf16 v[40:43], v[24:27], v[112:119], v1
    v_smfmac_f32_16x16x64_bf16 v[44:47], v[24:27], v[120:127], v1
    v_smfmac_f32_16x16x64_bf16 v[48:51], v[24:27], v[128:135], v1
    v_smfmac_f32_16x16x64_bf16 v[52:55], v[24:27], v[136:143], v1
    ds_read_b128 v[24:27], v0 offset:17408
    s_waitcnt lgkmcnt(3)
    v_smfmac_f32_16x16x64_bf16 v[40:43], v[28:31], v[160:167], v1
    v_smfmac_f32_16x16x64_bf16 v[44:47], v[28:31], v[168:175], v1
    v_smfmac_f32_16x16x64_bf16 v[48:51], v[28:31], v[176:183], v1
    v_smfmac_f32_16x16x64_bf16 v[52:55], v[28:31], v[184:191], v1
    ds_read_b128 v[28:31], v0 offset:18432
    s_waitcnt lgkmcnt(3)
    v_smfmac_f32_16x16x64_bf16 v[40:43], v[32:35], v[208:215], v1
    v_smfmac_f32_16x16x64_bf16 v[44:47], v[32:35], v[216:223], v1
    v_smfmac_f32_16x16x64_bf16 v[48:51], v[32:35], v[224:231], v1
    v_smfmac_f32_16x16x64_bf16 v[52:55], v[32:35], v[232:239], v1
    ds_read_b128 v[32:35], v0 offset:19456
    s_waitcnt lgkmcnt(3)
    v_smfmac_f32_16x16x64_bf16 v[56:59], v[36:39], a[128:135], v1
    v_smfmac_f32_16x16x64_bf16 v[60:63], v[36:39], a[136:143], v1
    ds_read_b128 v[36:39], v0 offset:20480
    s_nop 2
    s_nop 0
    v_pk_add_f32 v[40:41], v[40:41], v[42:43]
    v_pk_add_f32 v[48:49], v[48:49], v[50:51]
    v_pk_add_f32 v[44:45], v[44:45], v[46:47]
    v_pk_add_f32 v[52:53], v[52:53], v[54:55]
    v_cvt_pk_bf16_f32 v76, v40, v41
    v_cvt_pk_bf16_f32 v77, v48, v49
    ds_write_b64 v2, v[76:77] offset:0
    v_cvt_pk_bf16_f32 v78, v44, v45
    v_cvt_pk_bf16_f32 v79, v52, v53
    ds_write_b64 v2, v[78:79] offset:2048
    buffer_store_dwordx4 v[76:79], v0, s[4:7], s39 offen sc1
    ds_read_b128 v[72:75], v4 offset:0
    s_waitcnt lgkmcnt(6)
    v_smfmac_f32_16x16x64_bf16 v[56:59], v[24:27], a[176:183], v1
    v_smfmac_f32_16x16x64_bf16 v[60:63], v[24:27], a[184:191], v1
    ds_read_b128 v[24:27], v0 offset:21504
    s_waitcnt lgkmcnt(6)
    v_smfmac_f32_16x16x64_bf16 v[56:59], v[28:31], a[224:231], v1
    v_smfmac_f32_16x16x64_bf16 v[60:63], v[28:31], a[232:239], v1
    ds_read_b128 v[28:31], v0 offset:22528
    s_waitcnt lgkmcnt(6)
    v_smfmac_f32_16x16x64_bf16 v[56:59], v[32:35], v[96:103], v1
    v_smfmac_f32_16x16x64_bf16 v[60:63], v[32:35], v[104:111], v1
    s_waitcnt lgkmcnt(3)
    s_barrier
    s_nop 0
    ds_read_b64_tr_b16 v[40:41], v3 offset:0
    ds_read_b64_tr_b16 v[42:43], v3 offset:256
    ds_read_b128 v[32:35], v4 offset:256
    ds_read_b64_tr_b16 v[44:45], v3 offset:1024
    ds_read_b64_tr_b16 v[46:47], v3 offset:1280
    v_smfmac_f32_16x16x64_bf16 v[56:59], v[36:39], v[144:151], v1
    v_smfmac_f32_16x16x64_bf16 v[60:63], v[36:39], v[152:159], v1
    ds_read_b128 v[36:39], v4 offset:2048
    ds_read_b64_tr_b16 v[48:49], v3 offset:2048
    ds_read_b64_tr_b16 v[50:51], v3 offset:2304
    ds_read_b64_tr_b16 v[52:53], v3 offset:3072
    ds_read_b64_tr_b16 v[54:55], v3 offset:3328
    s_waitcnt lgkmcnt(11)
    v_smfmac_f32_16x16x64_bf16 v[56:59], v[24:27], v[192:199], v1
    v_smfmac_f32_16x16x64_bf16 v[60:63], v[24:27], v[200:207], v1
    s_waitcnt lgkmcnt(10)
    v_smfmac_f32_16x16x64_bf16 v[56:59], v[28:31], v[240:247], v1
    v_smfmac_f32_16x16x64_bf16 v[60:63], v[28:31], v[248:255], v1
    s_waitcnt lgkmcnt(8)
    v_mfma_f32_16x16x32_bf16 v[76:79], v[40:43], v[40:43], 0
    v_mfma_f32_16x16x32_bf16 v[24:27], v[72:75], v[40:43], 0
    ds_read_b128 v[72:75], v4 offset:2304
    s_waitcnt lgkmcnt(8)
    v_mfma_f32_16x16x32_bf16 v[28:31], v[32:35], v[40:43], 0
    ds_read_b128 v[32:35], v4 offset:4096
    s_waitcnt lgkmcnt(6)
    v_mfma_f32_16x16x32_bf16 v[76:79], v[44:47], v[44:47], v[76:79]
    v_mfma_f32_16x16x32_bf16 v[24:27], v[36:39], v[44:47], v[24:27]
    ds_read_b128 v[36:39], v4 offset:4352
    s_waitcnt lgkmcnt(2)
    v_mfma_f32_16x16x32_bf16 v[28:31], v[72:75], v[44:47], v[28:31]
    ds_read_b128 v[72:75], v4 offset:6144
    v_pk_add_f32 v[56:57], v[56:57], v[58:59]
    v_pk_add_f32 v[60:61], v[60:61], v[62:63]
    v_mov_b32 v40, 0x3f803f80
    v_mov_b32 v41, 0x3f803f80
    s_waitcnt lgkmcnt(2)
    v_mfma_f32_16x16x32_bf16 v[76:79], v[48:51], v[48:51], v[76:79]
    v_mfma_f32_16x16x32_bf16 v[24:27], v[32:35], v[48:51], v[24:27]
    ds_read_b128 v[32:35], v4 offset:6400
    s_waitcnt lgkmcnt(2)
    v_mfma_f32_16x16x32_bf16 v[28:31], v[36:39], v[48:51], v[28:31]
    v_cvt_pk_bf16_f32 v56, v56, v57
    v_cvt_pk_bf16_f32 v57, v60, v61
    v_mov_b32 v42, 0x3f803f80
    v_mov_b32 v43, 0x3f803f80
    s_cmp_eq_u32 s18, 63
    s_waitcnt lgkmcnt(1)
    v_mfma_f32_16x16x32_bf16 v[76:79], v[52:55], v[52:55], v[76:79]
    v_mfma_f32_16x16x32_bf16 v[24:27], v[72:75], v[52:55], v[24:27]
    s_waitcnt lgkmcnt(0)
    v_mfma_f32_16x16x32_bf16 v[28:31], v[32:35], v[52:55], v[28:31]
    buffer_store_dwordx2 v[56:57], v13, s[4:7], s46 offen sc1
    s_cbranch_scc1 CH_END
    s_nop 1
    v_mov_b32 v45, 0
    v_mov_b32 v46, 0
    s_add_u32 s42, s43, s51
    v_max3_f32 v14, v78, v79, v24
    v_max3_f32 v13, v25, v26, v27
    v_max3_f32 v14, v14, v28, v29
    v_max3_f32 v13, v13, v30, v31
    v_max_f32 v14, v14, v13
    v_mov_b32 v13, v14
    s_nop 1
    v_permlane32_swap_b32 v14, v13
    v_max_f32 v14, v14, v13
    v_mov_b32 v13, v14
    s_nop 1
    v_permlane16_swap_b32 v14, v13
    v_max_f32 v14, v14, v13
    v_mul_f32 v14, s52, v14
    v_mov_b32_e64 v15, v14
    v_pk_fma_f32 v[78:79], v[78:79], s[82:83], v[14:15] neg_lo:[0,0,1] neg_hi:[0,0,1]
    v_pk_fma_f32 v[24:25], v[24:25], s[82:83], v[14:15] neg_lo:[0,0,1] neg_hi:[0,0,1]
    v_exp_f32 v78, v78
    v_exp_f32 v79, v79
    v_pk_fma_f32 v[26:27], v[26:27], s[82:83], v[14:15] neg_lo:[0,0,1] neg_hi:[0,0,1]
    v_cvt_pk_bf16_f32 v44, v78, v79
    v_cvt_pk_bf16_f32 v47, v78, v79
    v_exp_f32 v24, v24
    v_exp_f32 v25, v25
    v_mfma_f32_16x16x16_bf16 v[60:63], v[40:41], v[44:45], 0
    v_exp_f32 v26, v26
    v_exp_f32 v27, v27
    v_mfma_f32_16x16x16_bf16 v[32:35], v[56:57], v[44:45], 0
    v_pk_fma_f32 v[28:29], v[28:29], s[82:83], v[14:15] neg_lo:[0,0,1] neg_hi:[0,0,1]
    v_pk_fma_f32 v[30:31], v[30:31], s[82:83], v[14:15] neg_lo:[0,0,1] neg_hi:[0,0,1]
    v_mfma_f32_16x16x16_bf16 v[36:39], v[56:57], v[46:47], 0
    ds_read_b128 v[72:75], v11 offset:0
    ds_read_b128 v[76:79], v11 offset:1024
    v_exp_f32 v28, v28
    v_exp_f32 v29, v29
    v_exp_f32 v30, v30
    v_exp_f32 v31, v31
    v_cvt_pk_bf16_f32 v52, v24, v25
    v_cvt_pk_bf16_f32 v53, v26, v27
    v_cvt_pk_bf16_f32 v54, v28, v29
    v_cvt_pk_bf16_f32 v55, v30, v31
    s_add_u32 s40, s42, s22
    s_waitcnt vmcnt(4)
    v_mfma_f32_16x16x32_bf16 v[60:63], v[40:43], v[52:55], v[60:63]
    v_mfma_f32_16x16x32_bf16 v[32:35], v[64:67], v[52:55], v[32:35]
    v_mfma_f32_16x16x32_bf16 v[36:39], v[68:71], v[52:55], v[36:39]
    ds_read_b128 v[24:27], v7 offset:0
    ds_read_b128 v[28:31], v7 offset:1024
    ds_read_b128 v[64:67], v11 offset:2048
    ds_read_b128 v[68:71], v11 offset:3072
    s_cmp_eq_u32 s85, 0
    s_cbranch_scc1 CH_KASY
CH_KASYR:
    v_rcp_f32 v14, v60
    s_nop 0
    v_mov_b32_e64 v15, v14
    v_pk_mul_f32 v[32:33], v[32:33], v[14:15]
    v_pk_mul_f32 v[34:35], v[34:35], v[14:15]
    v_pk_mul_f32 v[36:37], v[36:37], v[14:15]
    v_pk_mul_f32 v[38:39], v[38:39], v[14:15]
    v_cvt_pk_bf16_f32 v52, v32, v33
    v_cvt_pk_bf16_f32 v53, v34, v35
    v_cvt_pk_bf16_f32 v54, v36, v37
    v_cvt_pk_bf16_f32 v55, v38, v39
    s_mov_b64 exec, s[78:79]
    ds_write_b128 v5, v[52:55] offset:0
    s_mov_b64 exec, -1
    v_mov_b64 v[32:33], 0
    v_mov_b64 v[34:35], 0
    v_mov_b64 v[36:37], 0
    v_mov_b64 v[38:39], 0
    v_mov_b64 v[60:61], 0
    v_mov_b64 v[62:63], 0
    s_waitcnt lgkmcnt(0)
    s_barrier
    ds_read_b128 v[48:51], v6 offset:0
    ds_read_b128 v[56:59], v6 offset:1024
    s_mov_b32 m0, s59
    s_add_u32 s41, s54, s58
    buffer_load_dwordx4 v0, s[4:7], s41 offen lds
    buffer_load_dwordx4 v0, s[4:7], s41 offen offset:1024 lds
    v_mov_b64 v[52:53], 0
    v_mov_b64 v[54:55], 0
    s_waitcnt lgkmcnt(1)
    v_smfmac_f32_16x16x64_bf16 v[32:35], v[48:51], v[16:23], v1
    s_waitcnt lgkmcnt(0)
    v_smfmac_f32_16x16x64_bf16 v[32:35], v[56:59], v[72:79], v1
    ds_read_b128 v[72:75], v7 offset:2048
    ds_read_b128 v[76:79], v7 offset:3072
    v_smfmac_f32_16x16x64_bf16 v[36:39], v[48:51], v[24:31], v1
    ds_read_b128 v[24:27], v11 offset:4096
    ds_read_b128 v[28:31], v11 offset:5120
    v_smfmac_f32_16x16x64_bf16 v[36:39], v[56:59], v[64:71], v1
    ds_read_b128 v[64:67], v7 offset:4096
    ds_read_b128 v[68:71], v7 offset:5120
    v_pk_add_f32 v[32:33], v[32:33], v[34:35]
    v_cvt_pk_bf16_f32 v40, v32, v33
    v_and_or_b32 v40, v40, -2, s21
    v_mov_b64 v[32:33], 0
    v_mov_b64 v[34:35], 0
    s_waitcnt lgkmcnt(4)
    v_smfmac_f32_16x16x64_bf16 v[60:63], v[48:51], v[72:79], v1
    s_nop 0
    ds_read_b128 v[72:75], v11 offset:6144
    ds_read_b128 v[76:79], v11 offset:7168
    v_pk_add_f32 v[36:37], v[36:37], v[38:39]
    v_cvt_pk_bf16_f32 v41, v36, v37
    v_and_or_b32 v41, v41, -2, s21
    v_mov_b64 v[36:37], 0
    v_mov_b64 v[38:39], 0
    s_waitcnt lgkmcnt(4)
    v_smfmac_f32_16x16x64_bf16 v[60:63], v[56:59], v[24:31], v1
    ds_read_b128 v[24:27], v7 offset:6144
    ds_read_b128 v[28:31], v7 offset:7168
    s_waitcnt lgkmcnt(4)
    v_smfmac_f32_16x16x64_bf16 v[52:55], v[48:51], v[64:71], v1
    ds_read_b128 v[64:67], v11 offset:8192
    ds_read_b128 v[68:71], v11 offset:9216
    s_waitcnt lgkmcnt(4)
    v_smfmac_f32_16x16x64_bf16 v[52:55], v[56:59], v[72:79], v1
    s_nop 0
    ds_read_b128 v[72:75], v7 offset:8192
    ds_read_b128 v[76:79], v7 offset:9216
    v_pk_add_f32 v[60:61], v[60:61], v[62:63]
    v_cvt_pk_bf16_f32 v42, v60, v61
    v_and_or_b32 v42, v42, -2, s21
    v_mov_b64 v[60:61], 0
    v_mov_b64 v[62:63], 0
    s_waitcnt lgkmcnt(4)
    v_smfmac_f32_16x16x64_bf16 v[32:35], v[48:51], v[24:31], v1
    s_nop 0
    ds_read_b128 v[24:27], v11 offset:10240
    ds_read_b128 v[28:31], v11 offset:11264
    v_pk_add_f32 v[52:53], v[52:53], v[54:55]
    v_cvt_pk_bf16_f32 v43, v52, v53
    v_and_or_b32 v43, v43, -2, s21
    buffer_store_dwordx4 v[40:43], v8, s[4:7], s42 offen
    s_add_u32 s42, s42, 135168
    v_mov_b64 v[52:53], 0
    v_mov_b64 v[54:55], 0
    s_waitcnt lgkmcnt(4)
    v_smfmac_f32_16x16x64_bf16 v[32:35], v[56:59], v[64:71], v1
    ds_read_b128 v[64:67], v7 offset:10240
    ds_read_b128 v[68:71], v7 offset:11264
    s_waitcnt lgkmcnt(4)
    v_smfmac_f32_16x16x64_bf16 v[36:39], v[48:51], v[72:79], v1
    ds_read_b128 v[72:75], v11 offset:12288
    ds_read_b128 v[76:79], v11 offset:13312
    s_waitcnt lgkmcnt(4)
    v_smfmac_f32_16x16x64_bf16 v[36:39], v[56:59], v[24:31], v1
    s_nop 0
    ds_read_b128 v[24:27], v7 offset:12288
    ds_read_b128 v[28:31], v7 offset:13312
    v_pk_add_f32 v[32:33], v[32:33], v[34:35]
    v_cvt_pk_bf16_f32 v44, v32, v33
    v_and_or_b32 v44, v44, -2, s21
    v_mov_b64 v[32:33], 0
    v_mov_b64 v[34:35], 0
    s_waitcnt lgkmcnt(4)
    v_smfmac_f32_16x16x64_bf16 v[60:63], v[48:51], v[64:71], v1
    s_nop 0
    ds_read_b128 v[64:67], v11 offset:14336
    ds_read_b128 v[68:71], v11 offset:15360
    v_pk_add_f32 v[36:37], v[36:37], v[38:39]
    v_cvt_pk_bf16_f32 v45, v36, v37
    v_and_or_b32 v45, v45, -2, s21
    s_waitcnt lgkmcnt(4)
    v_smfmac_f32_16x16x64_bf16 v[60:63], v[56:59], v[72:79], v1
    ds_read_b128 v[72:75], v7 offset:14336
    ds_read_b128 v[76:79], v7 offset:15360
    s_waitcnt lgkmcnt(4)
    v_smfmac_f32_16x16x64_bf16 v[52:55], v[48:51], v[24:31], v1
    ds_read_b128 v[24:27], v11 offset:16384
    ds_read_b128 v[28:31], v11 offset:17408
    s_waitcnt lgkmcnt(4)
    v_smfmac_f32_16x16x64_bf16 v[52:55], v[56:59], v[64:71], v1
    v_pk_add_f32 v[60:61], v[60:61], v[62:63]
    v_cvt_pk_bf16_f32 v46, v60, v61
    v_and_or_b32 v46, v46, -2, s21
    s_waitcnt lgkmcnt(2)
    v_smfmac_f32_16x16x64_bf16 v[32:35], v[48:51], v[72:79], v1
    s_waitcnt lgkmcnt(0)
    v_smfmac_f32_16x16x64_bf16 v[32:35], v[56:59], v[24:31], v1
    s_nop 0
    v_pk_add_f32 v[52:53], v[52:53], v[54:55]
    v_cvt_pk_bf16_f32 v47, v52, v53
    v_and_or_b32 v47, v47, -2, s21
    buffer_store_dwordx4 v[44:47], v8, s[4:7], s42 offen
    s_nop 2
    v_pk_add_f32 v[32:33], v[32:33], v[34:35]
    v_cvt_pk_bf16_f32 v32, v32, v33
    v_and_or_b32 v32, v32, -2, s21
    buffer_store_dword v32, v8, s[4:7], s40 offen
    s_add_u32 s42, s43, s49
    s_sub_u32 s43, s50, 63963136
    s_add_u32 s41, s43, s20
    s_add_u32 s18, s18, 1
    s_add_u32 s54, s54, 8192
    s_and_b32 s20, s18, 3
    s_lshl_b32 s20, s20, 14
    s_add_u32 s20, s20, 63963136
    s_sub_u32 s21, 0, s21
    s_cmp_ge_u32 s48, 72
    s_cbranch_scc1 CH_NORED
    s_cmp_ge_u32 s48, 32
    s_cbranch_scc1 CH_RLATE
    buffer_load_dwordx4 v[24:27], v9, s[4:7], s42 offen offset:0 sc1
    buffer_load_dwordx4 v[28:31], v9, s[4:7], s42 offen offset:1024 sc1
    buffer_load_dwordx4 v[32:35], v9, s[4:7], s42 offen offset:2048 sc1
    buffer_load_dwordx4 v[36:39], v9, s[4:7], s42 offen offset:3072 sc1
    s_add_u32 s34, s20, 4096
    s_add_u32 s35, s20, 8192
    v_and_b32 v14, 0x3ff, v12
    s_add_u32 s36, s57, s54
    s_add_u32 s37, s36, 4096
    s_min_u32 s38, s18, 61
    s_sub_u32 s38, s38, s18
    s_lshl_b32 s38, s38, 13
    s_add_u32 s38, s38, s54
    s_add_u32 s38, s38, s47
    s_add_u32 s38, s38, 16384
    s_lshr_b32 s39, s54, 1
    s_add_u32 s39, s39, s55
    s_lshr_b32 s46, s54, 2
    s_add_u32 s46, s46, s56
    s_mov_b32 m0, 23552
    s_add_u32 s85, s18, 3
    s_and_b32 s85, s85, 0x47
    s_or_b32 s85, s85, s86
    v_mov_b64 v[40:41], 0
    v_mov_b64 v[42:43], 0
    v_mov_b64 v[44:45], 0
    v_mov_b64 v[46:47], 0
    v_mov_b64 v[48:49], 0
    v_mov_b64 v[50:51], 0
    v_mov_b64 v[52:53], 0
    v_mov_b64 v[54:55], 0
    v_mov_b64 v[56:57], 0
    v_mov_b64 v[58:59], 0
    v_mov_b64 v[60:61], 0
    v_mov_b64 v[62:63], 0
CH_RNOW:
    s_add_u32 s40, s43, s20
    v_mov_b32 v72, 0x3f80
    v_mov_b32 v73, 0x3f800000
    v_cndmask_b32 v72, v72, v73, s[24:25]
    v_cndmask_b32 v68, 0, v72, s[26:27]
    v_cndmask_b32 v69, 0, v72, s[28:29]
    v_cndmask_b32 v70, 0, v72, s[30:31]
    v_cndmask_b32 v71, 0, v72, s[32:33]
    v_mov_b32 v15, -1
CH_RED2:
    s_waitcnt vmcnt(3)
    v_mfma_f32_16x16x32_bf16 v[64:67], v[24:27], v[68:71], 0
    v_bitop3_b32 v73, v24, v25, s21 bitop3:0x7e
    v_bitop3_b32 v74, v26, v27, s21 bitop3:0x7e
    v_or_b32 v72, v73, v74
    s_waitcnt vmcnt(2)
    v_mfma_f32_16x16x32_bf16 v[64:67], v[28:31], v[68:71], v[64:67]
    v_bitop3_b32 v73, v28, v29, s21 bitop3:0x7e
    v_bitop3_b32 v74, v30, v31, s21 bitop3:0x7e
    v_or3_b32 v72, v72, v73, v74
    s_waitcnt vmcnt(1)
    v_mfma_f32_16x16x32_bf16 v[64:67], v[32:35], v[68:71], v[64:67]
    v_bitop3_b32 v73, v32, v33, s21 bitop3:0x7e
    v_bitop3_b32 v74, v34, v35, s21 bitop3:0x7e
    v_or3_b32 v72, v72, v73, v74
    s_waitcnt vmcnt(0)
    v_mfma_f32_16x16x32_bf16 v[64:67], v[36:39], v[68:71], v[64:67]
    v_bitop3_b32 v73, v36, v37, s21 bitop3:0x7e
    v_bitop3_b32 v74, v38, v39, s21 bitop3:0x7e
    v_or3_b32 v72, v72, v73, v74
    v_and_b32 v72, 1, v72
    v_cmp_ne_u32 vcc, 0, v72
    s_nop 2
    v_add_f32 v64, v64, v65
    v_add_f32_e64 v66, v66, v67
    v_cvt_pk_bf16_f32 v64, v64, v66
    s_cbranch_vccnz CH_RRED
CH_RED_OK:
    buffer_store_dword v64, v10, s[4:7], s40 offen
    buffer_store_dword v15, v10, s[4:7], s41 offen
CH_JOIN:
    s_branch CH_LOOP
CH_RF:
    s_sub_u32 s19, s19, 1
    s_cbranch_scc0 CH_LOOP
    s_mov_b32 s19, 0
    s_branch CH_FOK
CH_RRED:
    s_sub_u32 s19, s19, 1
    s_cbranch_scc1 CH_RREDF
    buffer_load_dwordx4 v[24:27], v9, s[4:7], s42 offen offset:0 sc1
    buffer_load_dwordx4 v[28:31], v9, s[4:7], s42 offen offset:1024 sc1
    buffer_load_dwordx4 v[32:35], v9, s[4:7], s42 offen offset:2048 sc1
    buffer_load_dwordx4 v[36:39], v9, s[4:7], s42 offen offset:3072 sc1
    s_branch CH_RED2
CH_RREDF:
    s_mov_b32 s19, 0
    s_branch CH_RED_OK
CH_RF2:
    s_sub_u32 s19, s19, 1
    s_cbranch_scc1 CH_RF2F
    buffer_load_dwordx4 v[72:75], v12, s[4:7], s34 offen sc1
    buffer_load_dwordx4 v[76:79], v14, s[4:7], s35 offen sc1
    s_waitcnt vmcnt(0)
    v_max3_u32 v13, v72, v73, v74
    v_max3_u32 v13, v13, v75, v76
    v_max3_u32 v13, v13, v77, v78
    v_max_u32 v13, v13, v79
    v_cmp_eq_u32 vcc, -1, v13
    ds_write_b128 v12, v[72:75] offset:18432
    ds_write_b128 v14, v[76:79] offset:22528
    s_cbranch_vccnz CH_RF2
    s_branch CH_F2OK
CH_RF2F:
    s_mov_b32 s19, 0
    s_branch CH_F2OK
CH_KASY:
    s_add_u32 s41, s18, 3
    s_lshl_b32 s41, s41, 5
    s_add_u32 s41, s41, s16
    s_lshl_b32 s41, s41, 2
    s_add_u32 s41, s41, 64552960
    s_mov_b32 m0, 163072
    s_nop 0
    buffer_load_dword off, s[4:7], s41 sc1 lds
    s_branch CH_KASYR
CH_RLATE:
    s_add_u32 s34, s20, 4096
    s_add_u32 s35, s20, 8192
    v_and_b32 v14, 0x3ff, v12
    s_add_u32 s36, s57, s54
    s_add_u32 s37, s36, 4096
    s_min_u32 s38, s18, 61
    s_sub_u32 s38, s38, s18
    s_lshl_b32 s38, s38, 13
    s_add_u32 s38, s38, s54
    s_add_u32 s38, s38, s47
    s_add_u32 s38, s38, 16384
    s_lshr_b32 s39, s54, 1
    s_add_u32 s39, s39, s55
    s_lshr_b32 s46, s54, 2
    s_add_u32 s46, s46, s56
    s_mov_b32 m0, 23552
    s_add_u32 s85, s18, 3
    s_and_b32 s85, s85, 0x47
    s_or_b32 s85, s85, s86
    v_mov_b64 v[40:41], 0
    v_mov_b64 v[42:43], 0
    v_mov_b64 v[44:45], 0
    v_mov_b64 v[46:47], 0
    v_mov_b64 v[48:49], 0
    v_mov_b64 v[50:51], 0
    v_mov_b64 v[52:53], 0
    v_mov_b64 v[54:55], 0
    v_mov_b64 v[56:57], 0
    v_mov_b64 v[58:59], 0
    v_mov_b64 v[60:61], 0
    v_mov_b64 v[62:63], 0
    s_sleep 3
    buffer_load_dwordx4 v[24:27], v9, s[4:7], s42 offen offset:0 sc1
    buffer_load_dwordx4 v[28:31], v9, s[4:7], s42 offen offset:1024 sc1
    buffer_load_dwordx4 v[32:35], v9, s[4:7], s42 offen offset:2048 sc1
    buffer_load_dwordx4 v[36:39], v9, s[4:7], s42 offen offset:3072 sc1
    s_branch CH_RNOW
CH_NORED:
    s_add_u32 s34, s20, 4096
    s_add_u32 s35, s20, 8192
    v_and_b32 v14, 0x3ff, v12
    s_add_u32 s36, s57, s54
    s_add_u32 s37, s36, 4096
    s_min_u32 s38, s18, 61
    s_sub_u32 s38, s38, s18
    s_lshl_b32 s38, s38, 13
    s_add_u32 s38, s38, s54
    s_add_u32 s38, s38, s47
    s_add_u32 s38, s38, 16384
    s_lshr_b32 s39, s54, 1
    s_add_u32 s39, s39, s55
    s_lshr_b32 s46, s54, 2
    s_add_u32 s46, s46, s56
    s_mov_b32 m0, 23552
    s_add_u32 s85, s18, 3
    s_and_b32 s85, s85, 0x47
    s_or_b32 s85, s85, s86
    v_mov_b64 v[40:41], 0
    v_mov_b64 v[42:43], 0
    v_mov_b64 v[44:45], 0
    v_mov_b64 v[46:47], 0
    v_mov_b64 v[48:49], 0
    v_mov_b64 v[50:51], 0
    v_mov_b64 v[52:53], 0
    v_mov_b64 v[54:55], 0
    v_mov_b64 v[56:57], 0
    v_mov_b64 v[58:59], 0
    v_mov_b64 v[60:61], 0
    v_mov_b64 v[62:63], 0
    s_cmp_lg_u32 s17, 3
    s_cbranch_scc1 CH_SLP
    s_add_u32 s40, s18, 2
    s_and_b32 s41, s40, 7
    s_cmp_lg_u32 s41, 0
    s_cbranch_scc1 CH_SLP
    s_cmp_ge_u32 s40, 64
    s_cbranch_scc1 CH_SLP
    s_lshr_b32 s40, s40, 3
    v_mov_b32 v24, 163072
    s_waitcnt vmcnt(3)
    ds_read_b32 v25, v24
    s_waitcnt lgkmcnt(0)
    v_cmp_ne_u32 vcc, 0, v25
    s_cbranch_vccnz CH_SLP
    s_lshl_b32 s41, s40, 8
    s_add_u32 s41, s41, s16
    s_lshl_b32 s41, s41, 2
    s_add_u32 s41, s41, 64552960
    v_mov_b32_e64 v24, 0
CH_KVN_C:
    buffer_load_dword v25, v24, s[4:7], s41 offen sc1
    s_waitcnt vmcnt(0)
    v_cmp_eq_u32 vcc, 0, v25
    s_cbranch_vccz CH_JOIN
    s_sleep 4
    s_sub_u32 s19, s19, 1
    s_cbranch_scc0 CH_KVN_C
    s_mov_b32 s19, 0
CH_SLP:
    s_sleep 5
    s_branch CH_JOIN
CH_END:
    s_waitcnt vmcnt(0) lgkmcnt(0)
    v_mov_b32_e64 v24, 64
    buffer_store_dword v24, off, s[4:7], s53 sc1
    s_barrier
    s_branch CH_DONE
CHS_ENTRY:
    s_mov_b32 s90, 0
    s_mov_b32 s91, 0
    s_mov_b32 s92, 0
CHS_LOOP:
    buffer_load_dwordx4 v[76:79], v12, s[4:7], s20 offen sc1
    s_waitcnt vmcnt(0)
CHS_FC:
    v_max3_u32 v13, v76, v77, v78
    ds_write_b128 v12, v[76:79] offset:14336
    v_max_u32 v13, v13, v79
    v_cmp_eq_u32 vcc, -1, v13
    s_and_b32 s43, s18, 1
    s_mul_i32 s43, s43, 305152
    s_bfe_u32 s21, s18, 0x10001
    s_cbranch_vccnz CHS_RF
CHS_FOK:
    s_waitcnt lgkmcnt(0)
    s_barrier
    ds_read_b128 v[24:27], v0 offset:14336
    ds_read_b128 v[28:31], v0 offset:15360
    ds_read_b128 v[32:35], v0 offset:16384
    ds_read_b128 v[36:39], v0 offset:17408
    buffer_load_dwordx4 v[72:75], v12, s[4:7], s34 offen sc1
    buffer_load_dwordx4 v[76:79], v14, s[4:7], s35 offen sc1
    s_waitcnt lgkmcnt(3)
    v_smfmac_f32_16x16x64_bf16 v[40:43], v[24:27], a[0:7], v1
    buffer_load_dwordx4 v[64:67], v0, s[4:7], s36 offen
    v_smfmac_f32_16x16x64_bf16 v[44:47], v[24:27], a[8:15], v1
    buffer_load_dwordx4 v[68:71], v0, s[4:7], s37 offen
    v_smfmac_f32_16x16x64_bf16 v[48:51], v[24:27], a[16:23], v1
    v_smfmac_f32_16x16x64_bf16 v[52:55], v[24:27], a[24:31], v1
    ds_read_b128 v[24:27], v0 offset:14336
    s_waitcnt lgkmcnt(3)
    v_smfmac_f32_16x16x64_bf16 v[40:43], v[28:31], a[48:55], v1
    v_smfmac_f32_16x16x64_bf16 v[44:47], v[28:31], a[56:63], v1
    v_smfmac_f32_16x16x64_bf16 v[48:51], v[28:31], a[64:71], v1
    v_smfmac_f32_16x16x64_bf16 v[52:55], v[28:31], a[72:79], v1
    ds_read_b128 v[28:31], v0 offset:15360
    s_waitcnt lgkmcnt(3)
    v_smfmac_f32_16x16x64_bf16 v[40:43], v[32:35], a[96:103], v1
    v_smfmac_f32_16x16x64_bf16 v[44:47], v[32:35], a[104:111], v1
    v_smfmac_f32_16x16x64_bf16 v[48:51], v[32:35], a[112:119], v1
    v_smfmac_f32_16x16x64_bf16 v[52:55], v[32:35], a[120:127], v1
    s_waitcnt lgkmcnt(2)
    v_smfmac_f32_16x16x64_bf16 v[40:43], v[36:39], a[144:151], v1
    v_smfmac_f32_16x16x64_bf16 v[44:47], v[36:39], a[152:159], v1
    v_smfmac_f32_16x16x64_bf16 v[48:51], v[36:39], a[160:167], v1
    v_smfmac_f32_16x16x64_bf16 v[52:55], v[36:39], a[168:175], v1
    s_waitcnt vmcnt(2)
    v_max3_u32 v13, v72, v73, v74
    v_max3_u32 v13, v13, v75, v76
    v_max3_u32 v13, v13, v77, v78
    v_max_u32 v13, v13, v79
    v_cmp_eq_u32_e64 vcc, -1, v13
    ds_write_b128 v12, v[72:75] offset:18432
    ds_write_b128 v14, v[76:79] offset:22528
    s_waitcnt lgkmcnt(3)
    v_smfmac_f32_16x16x64_bf16 v[56:59], v[24:27], a[32:39], v1
    v_smfmac_f32_16x16x64_bf16 v[60:63], v[24:27], a[40:47], v1
    s_cbranch_vccnz CHS_RF2
CHS_F2OK:
    s_waitcnt lgkmcnt(0)
    s_barrier
    ds_read_b128 v[32:35], v0 offset:18432
    ds_read_b128 v[36:39], v0 offset:19456
    ds_read_b128 v[24:27], v0 offset:20480
    v_lshlrev_b32 v14, 2, v0
    v_mov_b32 v15, s18
    buffer_load_dword v14, s[4:7], s38 offen lds
    buffer_store_dword v15, off, s[4:7], s53 sc1
    v_smfmac_f32_16x16x64_bf16 v[56:59], v[28:31], a[80:87], v1
    v_lshrrev_b32_e64 v13, 1, v0
    v_smfmac_f32_16x16x64_bf16 v[60:63], v[28:31], a[88:95], v1
    ds_read_b128 v[28:31], v0 offset:21504
    s_waitcnt lgkmcnt(3)
    v_smfmac_f32_16x16x64_bf16 v[40:43], v[32:35], a[192:199], v1
    v_smfmac_f32_16x16x64_bf16 v[44:47], v[32:35], a[200:207], v1
    v_smfmac_f32_16x16x64_bf16 v[48:51], v[32:35], a[208:215], v1
    v_smfmac_f32_16x16x64_bf16 v[52:55], v[32:35], a[216:223], v1
    ds_read_b128 v[32:35], v0 offset:22528
    s_waitcnt lgkmcnt(3)
    v_smfmac_f32_16x16x64_bf16 v[40:43], v[36:39], a[240:247], v1
    v_smfmac_f32_16x16x64_bf16 v[44:47], v[36:39], a[248:255], v1
    v_smfmac_f32_16x16x64_bf16 v[48:51], v[36:39], v[80:87], v1
    v_smfmac_f32_16x16x64_bf16 v[52:55], v[36:39], v[88:95], v1
    ds_read_b128 v[36:39], v0 offset:16384
    s_waitcnt lgkmcnt(3)
    v_smfmac_f32_16x16x64_bf16 v[40:43], v[24:27], v[112:119], v1
    v_smfmac_f32_16x16x64_bf16 v[44:47], v[24:27], v[120:127], v1
    v_smfmac_f32_16x16x64_bf16 v[48:51], v[24:27], v[128:135], v1
    v_smfmac_f32_16x16x64_bf16 v[52:55], v[24:27], v[136:143], v1
    ds_read_b128 v[24:27], v0 offset:17408
    s_waitcnt lgkmcnt(3)
    v_smfmac_f32_16x16x64_bf16 v[40:43], v[28:31], v[160:167], v1
    v_smfmac_f32_16x16x64_bf16 v[44:47], v[28:31], v[168:175], v1
    v_smfmac_f32_16x16x64_bf16 v[48:51], v[28:31], v[176:183], v1
    v_smfmac_f32_16x16x64_bf16 v[52:55], v[28:31], v[184:191], v1
    ds_read_b128 v[28:31], v0 offset:18432
    s_waitcnt lgkmcnt(3)
    v_smfmac_f32_16x16x64_bf16 v[40:43], v[32:35], v[208:215], v1
    v_smfmac_f32_16x16x64_bf16 v[44:47], v[32:35], v[216:223], v1
    v_smfmac_f32_16x16x64_bf16 v[48:51], v[32:35], v[224:231], v1
    v_smfmac_f32_16x16x64_bf16 v[52:55], v[32:35], v[232:239], v1
    ds_read_b128 v[32:35], v0 offset:19456
    s_waitcnt lgkmcnt(3)
    v_smfmac_f32_16x16x64_bf16 v[56:59], v[36:39], a[128:135], v1
    v_smfmac_f32_16x16x64_bf16 v[60:63], v[36:39], a[136:143], v1
    ds_read_b128 v[36:39], v0 offset:20480
    s_nop 2
    s_nop 0
    v_pk_add_f32 v[40:41], v[40:41], v[42:43]
    v_pk_add_f32 v[48:49], v[48:49], v[50:51]
    v_pk_add_f32 v[44:45], v[44:45], v[46:47]
    v_pk_add_f32 v[52:53], v[52:53], v[54:55]
    v_cvt_pk_bf16_f32 v76, v40, v41
    v_cvt_pk_bf16_f32 v77, v48, v49
    ds_write_b64 v2, v[76:77] offset:0
    v_cvt_pk_bf16_f32 v78, v44, v45
    v_cvt_pk_bf16_f32 v79, v52, v53
    ds_write_b64 v2, v[78:79] offset:2048
    buffer_store_dwordx4 v[76:79], v0, s[4:7], s39 offen sc1
    ds_read_b128 v[72:75], v4 offset:0
    s_waitcnt lgkmcnt(6)
    v_smfmac_f32_16x16x64_bf16 v[56:59], v[24:27], a[176:183], v1
    v_smfmac_f32_16x16x64_bf16 v[60:63], v[24:27], a[184:191], v1
    ds_read_b128 v[24:27], v0 offset:21504
    s_waitcnt lgkmcnt(6)
    v_smfmac_f32_16x16x64_bf16 v[56:59], v[28:31], a[224:231], v1
    v_smfmac_f32_16x16x64_bf16 v[60:63], v[28:31], a[232:239], v1
    ds_read_b128 v[28:31], v0 offset:22528
    s_waitcnt lgkmcnt(6)
    v_smfmac_f32_16x16x64_bf16 v[56:59], v[32:35], v[96:103], v1
    v_smfmac_f32_16x16x64_bf16 v[60:63], v[32:35], v[104:111], v1
    s_waitcnt lgkmcnt(3)
    s_barrier
    s_nop 0
    ds_read_b64_tr_b16 v[40:41], v3 offset:0
    ds_read_b64_tr_b16 v[42:43], v3 offset:256
    ds_read_b128 v[32:35], v4 offset:256
    ds_read_b64_tr_b16 v[44:45], v3 offset:1024
    ds_read_b64_tr_b16 v[46:47], v3 offset:1280
    v_smfmac_f32_16x16x64_bf16 v[56:59], v[36:39], v[144:151], v1
    v_smfmac_f32_16x16x64_bf16 v[60:63], v[36:39], v[152:159], v1
    ds_read_b128 v[36:39], v4 offset:2048
    ds_read_b64_tr_b16 v[48:49], v3 offset:2048
    ds_read_b64_tr_b16 v[50:51], v3 offset:2304
    ds_read_b64_tr_b16 v[52:53], v3 offset:3072
    ds_read_b64_tr_b16 v[54:55], v3 offset:3328
    s_waitcnt lgkmcnt(11)
    v_smfmac_f32_16x16x64_bf16 v[56:59], v[24:27], v[192:199], v1
    v_smfmac_f32_16x16x64_bf16 v[60:63], v[24:27], v[200:207], v1
    s_waitcnt lgkmcnt(10)
    v_smfmac_f32_16x16x64_bf16 v[56:59], v[28:31], v[240:247], v1
    v_smfmac_f32_16x16x64_bf16 v[60:63], v[28:31], v[248:255], v1
    s_waitcnt lgkmcnt(8)
    v_mfma_f32_16x16x32_bf16 v[76:79], v[40:43], v[40:43], 0
    v_mfma_f32_16x16x32_bf16 v[24:27], v[72:75], v[40:43], 0
    ds_read_b128 v[72:75], v4 offset:2304
    s_waitcnt lgkmcnt(8)
    v_mfma_f32_16x16x32_bf16 v[28:31], v[32:35], v[40:43], 0
    ds_read_b128 v[32:35], v4 offset:4096
    s_waitcnt lgkmcnt(6)
    v_mfma_f32_16x16x32_bf16 v[76:79], v[44:47], v[44:47], v[76:79]
    v_mfma_f32_16x16x32_bf16 v[24:27], v[36:39], v[44:47], v[24:27]
    ds_read_b128 v[36:39], v4 offset:4352
    s_waitcnt lgkmcnt(2)
    v_mfma_f32_16x16x32_bf16 v[28:31], v[72:75], v[44:47], v[28:31]
    ds_read_b128 v[72:75], v4 offset:6144
    v_pk_add_f32 v[56:57], v[56:57], v[58:59]
    v_pk_add_f32 v[60:61], v[60:61], v[62:63]
    v_mov_b32 v40, 0x3f803f80
    v_mov_b32 v41, 0x3f803f80
    s_waitcnt lgkmcnt(2)
    v_mfma_f32_16x16x32_bf16 v[76:79], v[48:51], v[48:51], v[76:79]
    v_mfma_f32_16x16x32_bf16 v[24:27], v[32:35], v[48:51], v[24:27]
    ds_read_b128 v[32:35], v4 offset:6400
    s_waitcnt lgkmcnt(2)
    v_mfma_f32_16x16x32_bf16 v[28:31], v[36:39], v[48:51], v[28:31]
    v_cvt_pk_bf16_f32 v56, v56, v57
    v_cvt_pk_bf16_f32 v57, v60, v61
    v_mov_b32 v42, 0x3f803f80
    v_mov_b32 v43, 0x3f803f80
    s_cmp_eq_u32 s18, 63
    s_waitcnt lgkmcnt(1)
    v_mfma_f32_16x16x32_bf16 v[76:79], v[52:55], v[52:55], v[76:79]
    v_mfma_f32_16x16x32_bf16 v[24:27], v[72:75], v[52:55], v[24:27]
    s_waitcnt lgkmcnt(0)
    v_mfma_f32_16x16x32_bf16 v[28:31], v[32:35], v[52:55], v[28:31]
    buffer_store_dwordx2 v[56:57], v13, s[4:7], s46 offen sc1
    s_cbranch_scc1 CHS_END
    s_nop 1
    v_mov_b32 v45, 0
    v_mov_b32 v46, 0
    s_add_u32 s42, s43, s51
    v_max3_f32 v14, v78, v79, v24
    v_max3_f32 v13, v25, v26, v27
    v_max3_f32 v14, v14, v28, v29
    v_max3_f32 v13, v13, v30, v31
    v_max_f32 v14, v14, v13
    v_mov_b32 v13, v14
    s_nop 1
    v_permlane32_swap_b32 v14, v13
    v_max_f32 v14, v14, v13
    v_mov_b32 v13, v14
    s_nop 1
    v_permlane16_swap_b32 v14, v13
    v_max_f32 v14, v14, v13
    v_mul_f32 v14, s52, v14
    v_mov_b32_e64 v15, v14
    v_pk_fma_f32 v[78:79], v[78:79], s[82:83], v[14:15] neg_lo:[0,0,1] neg_hi:[0,0,1]
    v_pk_fma_f32 v[24:25], v[24:25], s[82:83], v[14:15] neg_lo:[0,0,1] neg_hi:[0,0,1]
    v_exp_f32 v78, v78
    v_exp_f32 v79, v79
    v_pk_fma_f32 v[26:27], v[26:27], s[82:83], v[14:15] neg_lo:[0,0,1] neg_hi:[0,0,1]
    v_cvt_pk_bf16_f32 v44, v78, v79
    v_cvt_pk_bf16_f32 v47, v78, v79
    v_exp_f32 v24, v24
    v_exp_f32 v25, v25
    v_mfma_f32_16x16x16_bf16 v[60:63], v[40:41], v[44:45], 0
    v_exp_f32 v26, v26
    v_exp_f32 v27, v27
    v_mfma_f32_16x16x16_bf16 v[32:35], v[56:57], v[44:45], 0
    v_pk_fma_f32 v[28:29], v[28:29], s[82:83], v[14:15] neg_lo:[0,0,1] neg_hi:[0,0,1]
    v_pk_fma_f32 v[30:31], v[30:31], s[82:83], v[14:15] neg_lo:[0,0,1] neg_hi:[0,0,1]
    v_mfma_f32_16x16x16_bf16 v[36:39], v[56:57], v[46:47], 0
    ds_read_b128 v[72:75], v11 offset:0
    ds_read_b128 v[76:79], v11 offset:1024
    v_exp_f32 v28, v28
    v_exp_f32 v29, v29
    v_exp_f32 v30, v30
    v_exp_f32 v31, v31
    v_cvt_pk_bf16_f32 v52, v24, v25
    v_cvt_pk_bf16_f32 v53, v26, v27
    v_cvt_pk_bf16_f32 v54, v28, v29
    v_cvt_pk_bf16_f32 v55, v30, v31
    s_add_u32 s40, s42, s22
    s_waitcnt vmcnt(4)
    v_mfma_f32_16x16x32_bf16 v[60:63], v[40:43], v[52:55], v[60:63]
    v_mfma_f32_16x16x32_bf16 v[32:35], v[64:67], v[52:55], v[32:35]
    v_mfma_f32_16x16x32_bf16 v[36:39], v[68:71], v[52:55], v[36:39]
    ds_read_b128 v[24:27], v7 offset:0
    ds_read_b128 v[28:31], v7 offset:1024
    ds_read_b128 v[64:67], v11 offset:2048
    ds_read_b128 v[68:71], v11 offset:3072
    s_cmp_eq_u32 s85, 0
    s_cbranch_scc1 CHS_KASY
CHS_KASYR:
    v_rcp_f32 v14, v60
    s_nop 0
    v_mov_b32_e64 v15, v14
    v_pk_mul_f32 v[32:33], v[32:33], v[14:15]
    v_pk_mul_f32 v[34:35], v[34:35], v[14:15]
    v_pk_mul_f32 v[36:37], v[36:37], v[14:15]
    v_pk_mul_f32 v[38:39], v[38:39], v[14:15]
    v_cvt_pk_bf16_f32 v52, v32, v33
    v_cvt_pk_bf16_f32 v53, v34, v35
    v_cvt_pk_bf16_f32 v54, v36, v37
    v_cvt_pk_bf16_f32 v55, v38, v39
    s_mov_b64 exec, s[78:79]
    ds_write_b128 v5, v[52:55] offset:0
    s_mov_b64 exec, -1
    v_mov_b64 v[32:33], 0
    v_mov_b64 v[34:35], 0
    v_mov_b64 v[36:37], 0
    v_mov_b64 v[38:39], 0
    v_mov_b64 v[60:61], 0
    v_mov_b64 v[62:63], 0
    s_waitcnt lgkmcnt(0)
    s_barrier
    ds_read_b128 v[48:51], v6 offset:0
    ds_read_b128 v[56:59], v6 offset:1024
    s_mov_b32 m0, s59
    s_add_u32 s41, s54, s58
    buffer_load_dwordx4 v0, s[4:7], s41 offen lds
    buffer_load_dwordx4 v0, s[4:7], s41 offen offset:1024 lds
    v_mov_b64 v[52:53], 0
    v_mov_b64 v[54:55], 0
    s_waitcnt lgkmcnt(1)
    v_smfmac_f32_16x16x64_bf16 v[32:35], v[48:51], v[16:23], v1
    s_waitcnt lgkmcnt(0)
    v_smfmac_f32_16x16x64_bf16 v[32:35], v[56:59], v[72:79], v1
    ds_read_b128 v[72:75], v7 offset:2048
    ds_read_b128 v[76:79], v7 offset:3072
    v_smfmac_f32_16x16x64_bf16 v[36:39], v[48:51], v[24:31], v1
    ds_read_b128 v[24:27], v11 offset:4096
    ds_read_b128 v[28:31], v11 offset:5120
    v_smfmac_f32_16x16x64_bf16 v[36:39], v[56:59], v[64:71], v1
    ds_read_b128 v[64:67], v7 offset:4096
    ds_read_b128 v[68:71], v7 offset:5120
    v_pk_add_f32 v[32:33], v[32:33], v[34:35]
    v_cvt_pk_bf16_f32 v40, v32, v33
    v_and_or_b32 v40, v40, -2, s21
    v_mov_b64 v[32:33], 0
    v_mov_b64 v[34:35], 0
    s_waitcnt lgkmcnt(4)
    v_smfmac_f32_16x16x64_bf16 v[60:63], v[48:51], v[72:79], v1
    s_nop 0
    ds_read_b128 v[72:75], v11 offset:6144
    ds_read_b128 v[76:79], v11 offset:7168
    v_pk_add_f32 v[36:37], v[36:37], v[38:39]
    v_cvt_pk_bf16_f32 v41, v36, v37
    v_and_or_b32 v41, v41, -2, s21
    v_mov_b64 v[36:37], 0
    v_mov_b64 v[38:39], 0
    s_waitcnt lgkmcnt(4)
    v_smfmac_f32_16x16x64_bf16 v[60:63], v[56:59], v[24:31], v1
    ds_read_b128 v[24:27], v7 offset:6144
    ds_read_b128 v[28:31], v7 offset:7168
    s_waitcnt lgkmcnt(4)
    v_smfmac_f32_16x16x64_bf16 v[52:55], v[48:51], v[64:71], v1
    ds_read_b128 v[64:67], v11 offset:8192
    ds_read_b128 v[68:71], v11 offset:9216
    s_waitcnt lgkmcnt(4)
    v_smfmac_f32_16x16x64_bf16 v[52:55], v[56:59], v[72:79], v1
    s_nop 0
    ds_read_b128 v[72:75], v7 offset:8192
    ds_read_b128 v[76:79], v7 offset:9216
    v_pk_add_f32 v[60:61], v[60:61], v[62:63]
    v_cvt_pk_bf16_f32 v42, v60, v61
    v_and_or_b32 v42, v42, -2, s21
    v_mov_b64 v[60:61], 0
    v_mov_b64 v[62:63], 0
    s_waitcnt lgkmcnt(4)
    v_smfmac_f32_16x16x64_bf16 v[32:35], v[48:51], v[24:31], v1
    s_nop 0
    ds_read_b128 v[24:27], v11 offset:10240
    ds_read_b128 v[28:31], v11 offset:11264
    v_pk_add_f32 v[52:53], v[52:53], v[54:55]
    v_cvt_pk_bf16_f32 v43, v52, v53
    v_and_or_b32 v43, v43, -2, s21
    buffer_store_dwordx4 v[40:43], v8, s[4:7], s42 offen sc1
    s_add_u32 s42, s42, 135168
    v_mov_b64 v[52:53], 0
    v_mov_b64 v[54:55], 0
    s_waitcnt lgkmcnt(4)
    v_smfmac_f32_16x16x64_bf16 v[32:35], v[56:59], v[64:71], v1
    ds_read_b128 v[64:67], v7 offset:10240
    ds_read_b128 v[68:71], v7 offset:11264
    s_waitcnt lgkmcnt(4)
    v_smfmac_f32_16x16x64_bf16 v[36:39], v[48:51], v[72:79], v1
    ds_read_b128 v[72:75], v11 offset:12288
    ds_read_b128 v[76:79], v11 offset:13312
    s_waitcnt lgkmcnt(4)
    v_smfmac_f32_16x16x64_bf16 v[36:39], v[56:59], v[24:31], v1
    s_nop 0
    ds_read_b128 v[24:27], v7 offset:12288
    ds_read_b128 v[28:31], v7 offset:13312
    v_pk_add_f32 v[32:33], v[32:33], v[34:35]
    v_cvt_pk_bf16_f32 v44, v32, v33
    v_and_or_b32 v44, v44, -2, s21
    v_mov_b64 v[32:33], 0
    v_mov_b64 v[34:35], 0
    s_waitcnt lgkmcnt(4)
    v_smfmac_f32_16x16x64_bf16 v[60:63], v[48:51], v[64:71], v1
    s_nop 0
    ds_read_b128 v[64:67], v11 offset:14336
    ds_read_b128 v[68:71], v11 offset:15360
    v_pk_add_f32 v[36:37], v[36:37], v[38:39]
    v_cvt_pk_bf16_f32 v45, v36, v37
    v_and_or_b32 v45, v45, -2, s21
    s_waitcnt lgkmcnt(4)
    v_smfmac_f32_16x16x64_bf16 v[60:63], v[56:59], v[72:79], v1
    ds_read_b128 v[72:75], v7 offset:14336
    ds_read_b128 v[76:79], v7 offset:15360
    s_waitcnt lgkmcnt(4)
    v_smfmac_f32_16x16x64_bf16 v[52:55], v[48:51], v[24:31], v1
    ds_read_b128 v[24:27], v11 offset:16384
    ds_read_b128 v[28:31], v11 offset:17408
    s_waitcnt lgkmcnt(4)
    v_smfmac_f32_16x16x64_bf16 v[52:55], v[56:59], v[64:71], v1
    v_pk_add_f32 v[60:61], v[60:61], v[62:63]
    v_cvt_pk_bf16_f32 v46, v60, v61
    v_and_or_b32 v46, v46, -2, s21
    s_waitcnt lgkmcnt(2)
    v_smfmac_f32_16x16x64_bf16 v[32:35], v[48:51], v[72:79], v1
    s_waitcnt lgkmcnt(0)
    v_smfmac_f32_16x16x64_bf16 v[32:35], v[56:59], v[24:31], v1
    s_nop 0
    v_pk_add_f32 v[52:53], v[52:53], v[54:55]
    v_cvt_pk_bf16_f32 v47, v52, v53
    v_and_or_b32 v47, v47, -2, s21
    buffer_store_dwordx4 v[44:47], v8, s[4:7], s42 offen sc1
    s_nop 2
    v_pk_add_f32 v[32:33], v[32:33], v[34:35]
    v_cvt_pk_bf16_f32 v32, v32, v33
    v_and_or_b32 v32, v32, -2, s21
    buffer_store_dword v32, v8, s[4:7], s40 offen sc1
    s_add_u32 s42, s43, s49
    s_sub_u32 s43, s50, 63963136
    s_add_u32 s41, s43, s20
    s_add_u32 s18, s18, 1
    s_add_u32 s54, s54, 8192
    s_and_b32 s20, s18, 3
    s_lshl_b32 s20, s20, 14
    s_add_u32 s20, s20, 63963136
    s_sub_u32 s21, 0, s21
    s_cmp_ge_u32 s48, 72
    s_cbranch_scc1 CHS_NORED
    s_cmp_ge_u32 s48, 32
    s_cbranch_scc1 CHS_RLATE
    buffer_load_dwordx4 v[24:27], v9, s[4:7], s42 offen offset:0 sc1
    buffer_load_dwordx4 v[28:31], v9, s[4:7], s42 offen offset:1024 sc1
    buffer_load_dwordx4 v[32:35], v9, s[4:7], s42 offen offset:2048 sc1
    buffer_load_dwordx4 v[36:39], v9, s[4:7], s42 offen offset:3072 sc1
    s_add_u32 s34, s20, 4096
    s_add_u32 s35, s20, 8192
    v_and_b32 v14, 0x3ff, v12
    s_add_u32 s36, s57, s54
    s_add_u32 s37, s36, 4096
    s_min_u32 s38, s18, 61
    s_sub_u32 s38, s38, s18
    s_lshl_b32 s38, s38, 13
    s_add_u32 s38, s38, s54
    s_add_u32 s38, s38, s47
    s_add_u32 s38, s38, 16384
    s_lshr_b32 s39, s54, 1
    s_add_u32 s39, s39, s55
    s_lshr_b32 s46, s54, 2
    s_add_u32 s46, s46, s56
    s_mov_b32 m0, 23552
    s_add_u32 s85, s18, 3
    s_and_b32 s85, s85, 0x47
    s_or_b32 s85, s85, s86
    v_mov_b64 v[40:41], 0
    v_mov_b64 v[42:43], 0
    v_mov_b64 v[44:45], 0
    v_mov_b64 v[46:47], 0
    v_mov_b64 v[48:49], 0
    v_mov_b64 v[50:51], 0
    v_mov_b64 v[52:53], 0
    v_mov_b64 v[54:55], 0
    v_mov_b64 v[56:57], 0
    v_mov_b64 v[58:59], 0
    v_mov_b64 v[60:61], 0
    v_mov_b64 v[62:63], 0
CHS_RNOW:
    s_add_u32 s40, s43, s20
    v_mov_b32 v72, 0x3f80
    v_mov_b32 v73, 0x3f800000
    v_cndmask_b32 v72, v72, v73, s[24:25]
    v_cndmask_b32 v68, 0, v72, s[26:27]
    v_cndmask_b32 v69, 0, v72, s[28:29]
    v_cndmask_b32 v70, 0, v72, s[30:31]
    v_cndmask_b32 v71, 0, v72, s[32:33]
    v_mov_b32 v15, -1
CHS_RED2:
    s_waitcnt vmcnt(3)
    v_mfma_f32_16x16x32_bf16 v[64:67], v[24:27], v[68:71], 0
    v_bitop3_b32 v73, v24, v25, s21 bitop3:0x7e
    v_bitop3_b32 v74, v26, v27, s21 bitop3:0x7e
    v_or_b32 v72, v73, v74
    s_waitcnt vmcnt(2)
    v_mfma_f32_16x16x32_bf16 v[64:67], v[28:31], v[68:71], v[64:67]
    v_bitop3_b32 v73, v28, v29, s21 bitop3:0x7e
    v_bitop3_b32 v74, v30, v31, s21 bitop3:0x7e
    v_or3_b32 v72, v72, v73, v74
    s_waitcnt vmcnt(1)
    v_mfma_f32_16x16x32_bf16 v[64:67], v[32:35], v[68:71], v[64:67]
    v_bitop3_b32 v73, v32, v33, s21 bitop3:0x7e
    v_bitop3_b32 v74, v34, v35, s21 bitop3:0x7e
    v_or3_b32 v72, v72, v73, v74
    s_waitcnt vmcnt(0)
    v_mfma_f32_16x16x32_bf16 v[64:67], v[36:39], v[68:71], v[64:67]
    v_bitop3_b32 v73, v36, v37, s21 bitop3:0x7e
    v_bitop3_b32 v74, v38, v39, s21 bitop3:0x7e
    v_or3_b32 v72, v72, v73, v74
    v_and_b32 v72, 1, v72
    v_cmp_ne_u32 vcc, 0, v72
    s_nop 2
    v_add_f32 v64, v64, v65
    v_add_f32_e64 v66, v66, v67
    v_cvt_pk_bf16_f32 v64, v64, v66
    s_cbranch_vccnz CHS_RRED
CHS_RED_OK:
    buffer_store_dword v64, v10, s[4:7], s40 offen sc1
    buffer_store_dword v15, v10, s[4:7], s41 offen sc1
CHS_JOIN:
    s_branch CHS_LOOP
CHS_RF:
    s_sub_u32 s19, s19, 1
    s_cbranch_scc0 CHS_LOOP
    s_mov_b32 s19, 0
    s_branch CHS_FOK
CHS_RRED:
    s_sub_u32 s19, s19, 1
    s_cbranch_scc1 CHS_RREDF
    buffer_load_dwordx4 v[24:27], v9, s[4:7], s42 offen offset:0 sc1
    buffer_load_dwordx4 v[28:31], v9, s[4:7], s42 offen offset:1024 sc1
    buffer_load_dwordx4 v[32:35], v9, s[4:7], s42 offen offset:2048 sc1
    buffer_load_dwordx4 v[36:39], v9, s[4:7], s42 offen offset:3072 sc1
    s_branch CHS_RED2
CHS_RREDF:
    s_mov_b32 s19, 0
    s_branch CHS_RED_OK
CHS_RF2:
    s_sub_u32 s19, s19, 1
    s_cbranch_scc1 CHS_RF2F
    buffer_load_dwordx4 v[72:75], v12, s[4:7], s34 offen sc1
    buffer_load_dwordx4 v[76:79], v14, s[4:7], s35 offen sc1
    s_waitcnt vmcnt(0)
    v_max3_u32 v13, v72, v73, v74
    v_max3_u32 v13, v13, v75, v76
    v_max3_u32 v13, v13, v77, v78
    v_max_u32 v13, v13, v79
    v_cmp_eq_u32 vcc, -1, v13
    ds_write_b128 v12, v[72:75] offset:18432
    ds_write_b128 v14, v[76:79] offset:22528
    s_cbranch_vccnz CHS_RF2
    s_branch CHS_F2OK
CHS_RF2F:
    s_mov_b32 s19, 0
    s_branch CHS_F2OK
CHS_KASY:
    s_add_u32 s41, s18, 3
    s_lshl_b32 s41, s41, 5
    s_add_u32 s41, s41, s16
    s_lshl_b32 s41, s41, 2
    s_add_u32 s41, s41, 64552960
    s_mov_b32 m0, 163072
    s_nop 0
    buffer_load_dword off, s[4:7], s41 sc1 lds
    s_branch CHS_KASYR
CHS_RLATE:
    s_add_u32 s34, s20, 4096
    s_add_u32 s35, s20, 8192
    v_and_b32 v14, 0x3ff, v12
    s_add_u32 s36, s57, s54
    s_add_u32 s37, s36, 4096
    s_min_u32 s38, s18, 61
    s_sub_u32 s38, s38, s18
    s_lshl_b32 s38, s38, 13
    s_add_u32 s38, s38, s54
    s_add_u32 s38, s38, s47
    s_add_u32 s38, s38, 16384
    s_lshr_b32 s39, s54, 1
    s_add_u32 s39, s39, s55
    s_lshr_b32 s46, s54, 2
    s_add_u32 s46, s46, s56
    s_mov_b32 m0, 23552
    s_add_u32 s85, s18, 3
    s_and_b32 s85, s85, 0x47
    s_or_b32 s85, s85, s86
    v_mov_b64 v[40:41], 0
    v_mov_b64 v[42:43], 0
    v_mov_b64 v[44:45], 0
    v_mov_b64 v[46:47], 0
    v_mov_b64 v[48:49], 0
    v_mov_b64 v[50:51], 0
    v_mov_b64 v[52:53], 0
    v_mov_b64 v[54:55], 0
    v_mov_b64 v[56:57], 0
    v_mov_b64 v[58:59], 0
    v_mov_b64 v[60:61], 0
    v_mov_b64 v[62:63], 0
    s_sleep 3
    buffer_load_dwordx4 v[24:27], v9, s[4:7], s42 offen offset:0 sc1
    buffer_load_dwordx4 v[28:31], v9, s[4:7], s42 offen offset:1024 sc1
    buffer_load_dwordx4 v[32:35], v9, s[4:7], s42 offen offset:2048 sc1
    buffer_load_dwordx4 v[36:39], v9, s[4:7], s42 offen offset:3072 sc1
    s_branch CHS_RNOW
CHS_NORED:
    s_add_u32 s34, s20, 4096
    s_add_u32 s35, s20, 8192
    v_and_b32 v14, 0x3ff, v12
    s_add_u32 s36, s57, s54
    s_add_u32 s37, s36, 4096
    s_min_u32 s38, s18, 61
    s_sub_u32 s38, s38, s18
    s_lshl_b32 s38, s38, 13
    s_add_u32 s38, s38, s54
    s_add_u32 s38, s38, s47
    s_add_u32 s38, s38, 16384
    s_lshr_b32 s39, s54, 1
    s_add_u32 s39, s39, s55
    s_lshr_b32 s46, s54, 2
    s_add_u32 s46, s46, s56
    s_mov_b32 m0, 23552
    s_add_u32 s85, s18, 3
    s_and_b32 s85, s85, 0x47
    s_or_b32 s85, s85, s86
    v_mov_b64 v[40:41], 0
    v_mov_b64 v[42:43], 0
    v_mov_b64 v[44:45], 0
    v_mov_b64 v[46:47], 0
    v_mov_b64 v[48:49], 0
    v_mov_b64 v[50:51], 0
    v_mov_b64 v[52:53], 0
    v_mov_b64 v[54:55], 0
    v_mov_b64 v[56:57], 0
    v_mov_b64 v[58:59], 0
    v_mov_b64 v[60:61], 0
    v_mov_b64 v[62:63], 0
    s_cmp_lg_u32 s17, 3
    s_cbranch_scc1 CHS_SLP
    s_add_u32 s40, s18, 2
    s_and_b32 s41, s40, 7
    s_cmp_lg_u32 s41, 0
    s_cbranch_scc1 CHS_SLP
    s_cmp_ge_u32 s40, 64
    s_cbranch_scc1 CHS_SLP
    s_lshr_b32 s40, s40, 3
    v_mov_b32 v24, 163072
    s_waitcnt vmcnt(3)
    ds_read_b32 v25, v24
    s_waitcnt lgkmcnt(0)
    v_cmp_ne_u32 vcc, 0, v25
    s_cbranch_vccnz CHS_SLP
    s_lshl_b32 s41, s40, 8
    s_add_u32 s41, s41, s16
    s_lshl_b32 s41, s41, 2
    s_add_u32 s41, s41, 64552960
    v_mov_b32_e64 v24, 0
CHS_KVN_C:
    buffer_load_dword v25, v24, s[4:7], s41 offen sc1
    s_waitcnt vmcnt(0)
    v_cmp_eq_u32 vcc, 0, v25
    s_cbranch_vccz CHS_JOIN
    s_sleep 4
    s_sub_u32 s19, s19, 1
    s_cbranch_scc0 CHS_KVN_C
    s_mov_b32 s19, 0
CHS_SLP:
    s_sleep 5
    s_branch CHS_JOIN
CHS_END:
    s_waitcnt vmcnt(0) lgkmcnt(0)
    v_mov_b32_e64 v24, 64
    buffer_store_dword v24, off, s[4:7], s53 sc1
    s_barrier
    s_branch CH_DONE
CH_DONE:
NEXT:
    s_branch DQ_START
LN_HELP:
    v_mov_b32 v250, 163832
    s_cmp_lg_u32 s17, 0
    s_cbranch_scc1 DQ_WAIT
    s_branch DQ_LN
DQ_START:
    v_mov_b32 v250, 163832
    s_cmp_lg_u32 s17, 0
    s_cbranch_scc1 DQ_WAIT
    s_cmp_lg_u32 s99, 0
    s_cbranch_scc1 DQ_PEND
    s_cmp_eq_u32 s96, 1
    s_cbranch_scc1 DQ_G
    s_cmp_eq_u32 s96, 2
    s_cbranch_scc1 DQ_D
    s_cmp_eq_u32 s96, 3
    s_cbranch_scc1 DQ_R
    s_mov_b32 s96, 1
DQ_G:
    s_mov_b32 s40, s97
    s_cmp_eq_u32 s40, 0
    s_cbranch_scc1 DQ_G_steal
DQ_G_try:
    s_lshl_b32 s42, s40, 2
    s_add_u32 s42, s42, 0
    v_mov_b32 v251, s42
    v_mov_b32 v252, 1
    s_mov_b64 exec, 1
    buffer_atomic_add v252, v251, s[8:11], 0 offen sc0
    s_waitcnt vmcnt(0)
    v_readfirstlane_b32 s41, v252
    s_mov_b64 exec, -1
    s_mov_b32 s43, 110
    s_cmp_eq_u32 s40, 7
    s_cselect_b32 s43, 108, s43
    s_cmp_ge_u32 s41, s43
    s_cbranch_scc1 DQ_G_steal
    s_mul_i32 s20, s40, 14
    s_add_u32 s20, s20, s41
    s_add_u32 s20, s20, 626
    s_cmp_ge_u32 s41, 96
    s_cbranch_scc1 DQ_DONE
    s_lshr_b32 s42, s41, 5
    s_mul_i32 s20, s42, 224
    s_and_b32 s42, s41, 31
    s_add_u32 s20, s20, s42
    s_lshl_b32 s42, s40, 5
    s_add_u32 s20, s20, s42
    s_add_u32 s20, s20, 32
    s_branch DQ_DONE
DQ_G_steal:
    v_mbcnt_lo_u32_b32 v251, -1, 0
    v_and_b32 v251, 7, v251
    v_lshlrev_b32_e64 v252, 2, v251
    buffer_load_dword v253, v252, s[8:11], 0 offen offset:0 sc1
    v_mov_b32 v254, 110
    v_mov_b32 v255, 108
    v_cmp_eq_u32 vcc, 7, v251
    s_nop 1
    v_cndmask_b32 v254, v254, v255, vcc
    s_waitcnt vmcnt(0)
    v_cmp_lt_u32 vcc, v253, v254
    s_nop 3
    s_and_b32 s42, vcc_lo, 0xfe
    s_cbranch_scc0 DQ_D0
    s_ff1_i32_b32 s40, s42
    s_branch DQ_G_try
DQ_D0:
    s_mov_b32 s96, 2
DQ_D:
    s_mov_b32 s40, s97
    s_cmp_eq_u32 s40, 0
    s_cbranch_scc1 DQ_D_steal
DQ_D_try:
    s_lshl_b32 s42, s40, 2
    s_add_u32 s42, s42, 64
    v_mov_b32 v251, s42
    v_mov_b32 v252, 1
    s_mov_b64 exec, 1
    buffer_atomic_add v252, v251, s[8:11], 0 offen sc0
    s_waitcnt vmcnt(0)
    v_readfirstlane_b32 s41, v252
    s_mov_b64 exec, -1
    s_mov_b32 s43, 28
    s_cmp_eq_u32 s40, 7
    s_cselect_b32 s43, 24, s43
    s_cmp_ge_u32 s41, s43
    s_cbranch_scc1 DQ_D_steal
    s_mul_i32 s20, s40, 28
    s_add_u32 s20, s20, s41
    s_add_u32 s20, s20, 804
    s_branch DQ_DONE
DQ_D_steal:
    v_mbcnt_lo_u32_b32 v251, -1, 0
    v_and_b32 v251, 7, v251
    v_lshlrev_b32_e64 v252, 2, v251
    buffer_load_dword v253, v252, s[8:11], 0 offen offset:64 sc1
    v_mov_b32 v254, 28
    v_mov_b32 v255, 24
    v_cmp_eq_u32 vcc, 7, v251
    s_nop 1
    v_cndmask_b32 v254, v254, v255, vcc
    s_waitcnt vmcnt(0)
    v_cmp_lt_u32 vcc, v253, v254
    s_nop 3
    s_and_b32 s42, vcc_lo, 0xfe
    s_cbranch_scc0 DQ_R0
    s_ff1_i32_b32 s40, s42
    s_branch DQ_D_try
DQ_R0:
    s_mov_b32 s96, 3
    v_mov_b32 v251, 164
    buffer_load_dword v252, v251, s[8:11], 0 offen sc1
    s_waitcnt vmcnt(0)
    v_readfirstlane_b32 s41, v252
    s_nop 3
    s_cmp_ge_u32 s41, 32
    s_cbranch_scc1 DQ_R
    v_mov_b32 v251, 164
    v_mov_b32 v252, 1
    s_mov_b64 exec, 1
    buffer_atomic_add v252, v251, s[8:11], 0 offen sc0
    s_waitcnt vmcnt(0)
    v_readfirstlane_b32 s41, v252
    s_mov_b64 exec, -1
    s_cmp_ge_u32 s41, 32
    s_cbranch_scc1 DQ_R
    s_add_u32 s20, s41, 0x8000
    s_branch DQ_OUT
DQ_R:
    v_mov_b32 v251, 56
    v_mov_b32 v252, 1
    s_mov_b64 exec, 1
    buffer_atomic_add v252, v251, s[8:11], 0 offen sc0
    s_waitcnt vmcnt(0)
    v_readfirstlane_b32 s41, v252
    s_mov_b64 exec, -1
    s_add_u32 s20, s41, 1024
    s_branch DQ_OUT
DQ_PEND:
    s_mov_b32 s20, s99
    s_mov_b32 s99, 0
    s_branch DQ_OUT
DQ_DONE:
    s_cmp_lg_u32 s96, 1
    s_cbranch_scc1 DQ_OUT
    s_cmp_ge_u32 s41, 10
    s_cbranch_scc1 DQ_OUT
DQ_LN:
    v_mov_b32 v251, 160
    v_mov_b32 v252, 1
    s_mov_b64 exec, 1
    buffer_atomic_add v252, v251, s[8:11], 0 offen sc0
    s_waitcnt vmcnt(0)
    v_readfirstlane_b32 s41, v252
    s_mov_b64 exec, -1
    s_cmp_ge_u32 s41, 64
    s_cbranch_scc1 DQ_OUT
    s_mov_b32 s99, s20
    s_mov_b32 s20, s41
DQ_OUT:
    v_mov_b32_e64 v252, s20
    ds_write_b32 v250, v252
    s_waitcnt lgkmcnt(0)
DQ_WAIT:
    s_barrier
    ds_read_b32 v251, v250
    s_waitcnt vmcnt(0) lgkmcnt(0)
    v_readfirstlane_b32 s20, v251
    s_barrier
    s_and_b32 s16, s20, 31
    s_cmp_ge_u32 s20, 0x8000
    s_cbranch_scc1 DO_CHAIN
    s_mov_b32 s22, s20
    s_cmp_lt_u32 s20, 64
    s_cbranch_scc1 DO_LN
    s_cmp_ge_u32 s20, 832
    s_cbranch_scc1 DS_D
    s_sub_u32 s40, s20, 64
    s_cmp_ge_u32 s40, 128
    s_cbranch_scc1 DS_G1
    s_lshr_b32 s22, s40, 2
    s_and_b32 s37, s40, 3
    s_branch DO_KV0
DS_G1:
    s_cmp_ge_u32 s40, 320
    s_cbranch_scc1 DS_G2
    s_sub_u32 s40, s40, 128
    s_mul_i32 s22, s40, 21846
    s_lshr_b32 s22, s22, 16
    s_mul_i32 s41, s22, 3
    s_sub_u32 s21, s40, s41
    s_add_u32 s21, s21, 1
    s_lshr_b32 s41, s22, 5
    s_mul_i32 s41, s41, 3
    s_add_u32 s21, s21, s41
    s_and_b32 s22, s22, 31
    s_branch DO_KV
DS_G2:
    s_cmp_ge_u32 s40, 608
    s_cbranch_scc1 DS_G3
    s_sub_u32 s40, s40, 320
    s_lshr_b32 s22, s40, 3
    s_and_b32 s21, s40, 7
    s_mov_b32 s37, 1
    s_branch DO_QG
DS_G3:
    s_cmp_ge_u32 s40, 640
    s_cbranch_scc1 DS_G4
    s_sub_u32 s22, s40, 608
    s_mov_b32 s21, 7
    s_branch DO_KV
DS_G4:
    s_sub_u32 s40, s40, 640
    s_lshr_b32 s22, s40, 3
    s_and_b32 s21, s40, 7
    s_mov_b32 s37, 0
    s_branch DO_QG
DS_D:
    s_cmp_ge_u32 s20, 1024
    s_cbranch_scc1 DS_R
    s_sub_u32 s22, s20, 832
    s_branch DO_DN
DS_R:
    s_cmp_ge_u32 s20, 1728
    s_cbranch_scc1 EXIT2
    s_sub_u32 s22, s20, 1152
    s_cmp_ge_u32 s20, 1152
    s_cbranch_scc1 DO_RED
    s_sub_u32 s22, s20, 1024
    s_lshr_b32 s34, s22, 5
    s_and_b32 s22, s22, 31
    s_branch DO_R
DO_R:
    v_mbcnt_lo_u32_b32 v8, -1, 0
    v_mbcnt_hi_u32_b32 v8, -1, v8
    s_load_dwordx2 s[12:13], s[0:1], 40
    s_waitcnt lgkmcnt(0)
    s_and_b32 s13, s13, 0xffff
    s_mov_b32 s14, 4718592
    s_mov_b32 s15, 0x00020000
    s_and_b32 s21, s17, 1
    s_lshr_b32 s23, s17, 1
    v_and_b32 v9, 15, v8
    v_lshrrev_b32 v10, 4, v8
    v_and_b32_e64 v11, 3, v8
    v_bfe_u32 v12, v8, 2, 2
    v_lshlrev_b32 v0, 4, v8
    v_lshlrev_b32 v3, 3, v8
    v_lshlrev_b32_e64 v2, 9, v10
    v_lshl_add_u32 v2, v9, 4, v2
    s_lshl_b32 s40, s21, 8
    v_add_u32 v1, s40, v2
    s_lshl_b32 s40, s17, 12
    v_lshlrev_b32 v4, 5, v9
    v_lshl_add_u32 v4, v10, 3, v4
    v_add_u32_e64 v4, s40, v4
    v_lshl_add_u32 v13, v10, 3, v12
    v_lshlrev_b32_e64 v6, 5, v13
    v_lshl_add_u32 v6, v11, 3, v6
    v_add_u32_e64 v6, s40, v6
    v_mov_b32 v5, 0xf149f2ca
    s_mov_b32 s28, 0x3e0293ee
    v_mov_b32 v192, 0x3f803f80
    v_mov_b32 v193, 0x3f803f80
    v_mov_b32 v194, 0x3f803f80
    v_mov_b32 v195, 0x3f803f80
    v_mov_b32 v121, 0
    v_mov_b32 v122, 0
    s_lshl_b32 s40, s21, 4
    v_add_u32 v13, s40, v9
    v_lshlrev_b32 v14, 2, v10
    v_sub_u32 v13, v13, v14
    v_cmp_le_i32 s[64:65], 0, v13
    v_cmp_le_i32 s[66:67], 1, v13
    v_cmp_le_i32 s[68:69], 2, v13
    v_cmp_le_i32 s[70:71], 3, v13
    v_cmp_le_i32 s[72:73], 16, v13
    v_cmp_le_i32 s[74:75], 17, v13
    v_cmp_le_i32 s[76:77], 18, v13
    v_cmp_le_i32 s[78:79], 19, v13
    s_mul_i32 s40, s22, 147456
    s_mul_i32 s42, s17, 36864
    s_add_u32 s40, s40, s42
    s_add_u32 m0, s42, 0
    s_add_u32 s41, s40, 0
    s_nop 0
    buffer_load_dwordx4 v0, s[12:15], s41 offen offset:0 lds
    buffer_load_dwordx4 v0, s[12:15], s41 offen offset:1024 lds
    buffer_load_dwordx4 v0, s[12:15], s41 offen offset:2048 lds
    buffer_load_dwordx4 v0, s[12:15], s41 offen offset:3072 lds
    s_add_u32 m0, s42, 4096
    s_add_u32 s41, s40, 4096
    buffer_load_dwordx4 v0, s[12:15], s41 offen offset:0 lds
    buffer_load_dwordx4 v0, s[12:15], s41 offen offset:1024 lds
    buffer_load_dwordx4 v0, s[12:15], s41 offen offset:2048 lds
    buffer_load_dwordx4 v0, s[12:15], s41 offen offset:3072 lds
    s_add_u32 m0, s42, 8192
    s_add_u32 s41, s40, 8192
    buffer_load_dwordx4 v0, s[12:15], s41 offen offset:0 lds
    buffer_load_dwordx4 v0, s[12:15], s41 offen offset:1024 lds
    buffer_load_dwordx4 v0, s[12:15], s41 offen offset:2048 lds
    buffer_load_dwordx4 v0, s[12:15], s41 offen offset:3072 lds
    s_add_u32 m0, s42, 12288
    s_add_u32 s41, s40, 12288
    buffer_load_dwordx4 v0, s[12:15], s41 offen offset:0 lds
    buffer_load_dwordx4 v0, s[12:15], s41 offen offset:1024 lds
    buffer_load_dwordx4 v0, s[12:15], s41 offen offset:2048 lds
    buffer_load_dwordx4 v0, s[12:15], s41 offen offset:3072 lds
    s_add_u32 m0, s42, 16384
    s_add_u32 s41, s40, 16384
    buffer_load_dwordx4 v0, s[12:15], s41 offen offset:0 lds
    buffer_load_dwordx4 v0, s[12:15], s41 offen offset:1024 lds
    buffer_load_dwordx4 v0, s[12:15], s41 offen offset:2048 lds
    buffer_load_dwordx4 v0, s[12:15], s41 offen offset:3072 lds
    s_add_u32 m0, s42, 20480
    s_add_u32 s41, s40, 20480
    buffer_load_dwordx4 v0, s[12:15], s41 offen offset:0 lds
    buffer_load_dwordx4 v0, s[12:15], s41 offen offset:1024 lds
    buffer_load_dwordx4 v0, s[12:15], s41 offen offset:2048 lds
    buffer_load_dwordx4 v0, s[12:15], s41 offen offset:3072 lds
    s_add_u32 m0, s42, 24576
    s_add_u32 s41, s40, 24576
    buffer_load_dwordx4 v0, s[12:15], s41 offen offset:0 lds
    buffer_load_dwordx4 v0, s[12:15], s41 offen offset:1024 lds
    buffer_load_dwordx4 v0, s[12:15], s41 offen offset:2048 lds
    buffer_load_dwordx4 v0, s[12:15], s41 offen offset:3072 lds
    s_add_u32 m0, s42, 28672
    s_add_u32 s41, s40, 28672
    buffer_load_dwordx4 v0, s[12:15], s41 offen offset:0 lds
    buffer_load_dwordx4 v0, s[12:15], s41 offen offset:1024 lds
    buffer_load_dwordx4 v0, s[12:15], s41 offen offset:2048 lds
    buffer_load_dwordx4 v0, s[12:15], s41 offen offset:3072 lds
    s_add_u32 m0, s42, 32768
    s_add_u32 s41, s40, 32768
    buffer_load_dwordx4 v0, s[12:15], s41 offen offset:0 lds
    buffer_load_dwordx4 v0, s[12:15], s41 offen offset:1024 lds
    buffer_load_dwordx4 v0, s[12:15], s41 offen offset:2048 lds
    buffer_load_dwordx4 v0, s[12:15], s41 offen offset:3072 lds
    v_lshl_add_u32 v13, v10, 2, v12
    v_mul_u32_u24 v13, 1152, v13
    v_lshl_add_u32 v13, v11, 3, v13
    s_mul_i32 s40, s23, 576
    v_add_u32 v13, s40, v13
    s_waitcnt vmcnt(0)
    s_barrier
    v_add_u32 v14, 0, v13
    ds_read_b64_tr_b16 a[0:1], v14 offset:0
    ds_read_b64_tr_b16 a[16:17], v14 offset:32
    ds_read_b64_tr_b16 a[32:33], v14 offset:64
    ds_read_b64_tr_b16 a[48:49], v14 offset:96
    ds_read_b64_tr_b16 a[64:65], v14 offset:128
    ds_read_b64_tr_b16 a[80:81], v14 offset:160
    ds_read_b64_tr_b16 a[96:97], v14 offset:192
    ds_read_b64_tr_b16 a[112:113], v14 offset:224
    ds_read_b64_tr_b16 a[128:129], v14 offset:256
    s_waitcnt lgkmcnt(0)
    s_nop 0
    ds_read_b64_tr_b16 a[144:145], v14 offset:288
    ds_read_b64_tr_b16 a[160:161], v14 offset:320
    ds_read_b64_tr_b16 a[176:177], v14 offset:352
    ds_read_b64_tr_b16 a[192:193], v14 offset:384
    ds_read_b64_tr_b16 a[208:209], v14 offset:416
    ds_read_b64_tr_b16 a[224:225], v14 offset:448
    ds_read_b64_tr_b16 a[240:241], v14 offset:480
    ds_read_b64_tr_b16 v[224:225], v14 offset:512
    ds_read_b64_tr_b16 v[240:241], v14 offset:544
    s_waitcnt lgkmcnt(0)
    s_nop 0
    v_add_u32 v14, 18432, v13
    ds_read_b64_tr_b16 a[2:3], v14 offset:0
    ds_read_b64_tr_b16 a[18:19], v14 offset:32
    ds_read_b64_tr_b16 a[34:35], v14 offset:64
    ds_read_b64_tr_b16 a[50:51], v14 offset:96
    ds_read_b64_tr_b16 a[66:67], v14 offset:128
    ds_read_b64_tr_b16 a[82:83], v14 offset:160
    ds_read_b64_tr_b16 a[98:99], v14 offset:192
    ds_read_b64_tr_b16 a[114:115], v14 offset:224
    ds_read_b64_tr_b16 a[130:131], v14 offset:256
    s_waitcnt lgkmcnt(0)
    s_nop 0
    ds_read_b64_tr_b16 a[146:147], v14 offset:288
    ds_read_b64_tr_b16 a[162:163], v14 offset:320
    ds_read_b64_tr_b16 a[178:179], v14 offset:352
    ds_read_b64_tr_b16 a[194:195], v14 offset:384
    ds_read_b64_tr_b16 a[210:211], v14 offset:416
    ds_read_b64_tr_b16 a[226:227], v14 offset:448
    ds_read_b64_tr_b16 a[242:243], v14 offset:480
    ds_read_b64_tr_b16 v[226:227], v14 offset:512
    ds_read_b64_tr_b16 v[242:243], v14 offset:544
    s_waitcnt lgkmcnt(0)
    s_nop 0
    v_add_u32 v14, 36864, v13
    ds_read_b64_tr_b16 a[4:5], v14 offset:0
    ds_read_b64_tr_b16 a[20:21], v14 offset:32
    ds_read_b64_tr_b16 a[36:37], v14 offset:64
    ds_read_b64_tr_b16 a[52:53], v14 offset:96
    ds_read_b64_tr_b16 a[68:69], v14 offset:128
    ds_read_b64_tr_b16 a[84:85], v14 offset:160
    ds_read_b64_tr_b16 a[100:101], v14 offset:192
    ds_read_b64_tr_b16 a[116:117], v14 offset:224
    ds_read_b64_tr_b16 a[132:133], v14 offset:256
    s_waitcnt lgkmcnt(0)
    s_nop 0
    ds_read_b64_tr_b16 a[148:149], v14 offset:288
    ds_read_b64_tr_b16 a[164:165], v14 offset:320
    ds_read_b64_tr_b16 a[180:181], v14 offset:352
    ds_read_b64_tr_b16 a[196:197], v14 offset:384
    ds_read_b64_tr_b16 a[212:213], v14 offset:416
    ds_read_b64_tr_b16 a[228:229], v14 offset:448
    ds_read_b64_tr_b16 a[244:245], v14 offset:480
    ds_read_b64_tr_b16 v[228:229], v14 offset:512
    ds_read_b64_tr_b16 v[244:245], v14 offset:544
    s_waitcnt lgkmcnt(0)
    s_nop 0
    v_add_u32 v14, 55296, v13
    ds_read_b64_tr_b16 a[6:7], v14 offset:0
    ds_read_b64_tr_b16 a[22:23], v14 offset:32
    ds_read_b64_tr_b16 a[38:39], v14 offset:64
    ds_read_b64_tr_b16 a[54:55], v14 offset:96
    ds_read_b64_tr_b16 a[70:71], v14 offset:128
    ds_read_b64_tr_b16 a[86:87], v14 offset:160
    ds_read_b64_tr_b16 a[102:103], v14 offset:192
    ds_read_b64_tr_b16 a[118:119], v14 offset:224
    ds_read_b64_tr_b16 a[134:135], v14 offset:256
    s_waitcnt lgkmcnt(0)
    s_nop 0
    ds_read_b64_tr_b16 a[150:151], v14 offset:288
    ds_read_b64_tr_b16 a[166:167], v14 offset:320
    ds_read_b64_tr_b16 a[182:183], v14 offset:352
    ds_read_b64_tr_b16 a[198:199], v14 offset:384
    ds_read_b64_tr_b16 a[214:215], v14 offset:416
    ds_read_b64_tr_b16 a[230:231], v14 offset:448
    ds_read_b64_tr_b16 a[246:247], v14 offset:480
    ds_read_b64_tr_b16 v[230:231], v14 offset:512
    ds_read_b64_tr_b16 v[246:247], v14 offset:544
    s_waitcnt lgkmcnt(0)
    s_nop 0
    v_add_u32 v14, 73728, v13
    ds_read_b64_tr_b16 a[8:9], v14 offset:0
    ds_read_b64_tr_b16 a[24:25], v14 offset:32
    ds_read_b64_tr_b16 a[40:41], v14 offset:64
    ds_read_b64_tr_b16 a[56:57], v14 offset:96
    ds_read_b64_tr_b16 a[72:73], v14 offset:128
    ds_read_b64_tr_b16 a[88:89], v14 offset:160
    ds_read_b64_tr_b16 a[104:105], v14 offset:192
    ds_read_b64_tr_b16 a[120:121], v14 offset:224
    ds_read_b64_tr_b16 a[136:137], v14 offset:256
    s_waitcnt lgkmcnt(0)
    s_nop 0
    ds_read_b64_tr_b16 a[152:153], v14 offset:288
    ds_read_b64_tr_b16 a[168:169], v14 offset:320
    ds_read_b64_tr_b16 a[184:185], v14 offset:352
    ds_read_b64_tr_b16 a[200:201], v14 offset:384
    ds_read_b64_tr_b16 a[216:217], v14 offset:416
    ds_read_b64_tr_b16 a[232:233], v14 offset:448
    ds_read_b64_tr_b16 a[248:249], v14 offset:480
    ds_read_b64_tr_b16 v[232:233], v14 offset:512
    ds_read_b64_tr_b16 v[248:249], v14 offset:544
    s_waitcnt lgkmcnt(0)
    s_nop 0
    v_add_u32 v14, 92160, v13
    ds_read_b64_tr_b16 a[10:11], v14 offset:0
    ds_read_b64_tr_b16 a[26:27], v14 offset:32
    ds_read_b64_tr_b16 a[42:43], v14 offset:64
    ds_read_b64_tr_b16 a[58:59], v14 offset:96
    ds_read_b64_tr_b16 a[74:75], v14 offset:128
    ds_read_b64_tr_b16 a[90:91], v14 offset:160
    ds_read_b64_tr_b16 a[106:107], v14 offset:192
    ds_read_b64_tr_b16 a[122:123], v14 offset:224
    ds_read_b64_tr_b16 a[138:139], v14 offset:256
    s_waitcnt lgkmcnt(0)
    s_nop 0
    ds_read_b64_tr_b16 a[154:155], v14 offset:288
    ds_read_b64_tr_b16 a[170:171], v14 offset:320
    ds_read_b64_tr_b16 a[186:187], v14 offset:352
    ds_read_b64_tr_b16 a[202:203], v14 offset:384
    ds_read_b64_tr_b16 a[218:219], v14 offset:416
    ds_read_b64_tr_b16 a[234:235], v14 offset:448
    ds_read_b64_tr_b16 a[250:251], v14 offset:480
    ds_read_b64_tr_b16 v[234:235], v14 offset:512
    ds_read_b64_tr_b16 v[250:251], v14 offset:544
    s_waitcnt lgkmcnt(0)
    s_nop 0
    v_add_u32 v14, 110592, v13
    ds_read_b64_tr_b16 a[12:13], v14 offset:0
    ds_read_b64_tr_b16 a[28:29], v14 offset:32
    ds_read_b64_tr_b16 a[44:45], v14 offset:64
    ds_read_b64_tr_b16 a[60:61], v14 offset:96
    ds_read_b64_tr_b16 a[76:77], v14 offset:128
    ds_read_b64_tr_b16 a[92:93], v14 offset:160
    ds_read_b64_tr_b16 a[108:109], v14 offset:192
    ds_read_b64_tr_b16 a[124:125], v14 offset:224
    ds_read_b64_tr_b16 a[140:141], v14 offset:256
    s_waitcnt lgkmcnt(0)
    s_nop 0
    ds_read_b64_tr_b16 a[156:157], v14 offset:288
    ds_read_b64_tr_b16 a[172:173], v14 offset:320
    ds_read_b64_tr_b16 a[188:189], v14 offset:352
    ds_read_b64_tr_b16 a[204:205], v14 offset:384
    ds_read_b64_tr_b16 a[220:221], v14 offset:416
    ds_read_b64_tr_b16 a[236:237], v14 offset:448
    ds_read_b64_tr_b16 a[252:253], v14 offset:480
    ds_read_b64_tr_b16 v[236:237], v14 offset:512
    ds_read_b64_tr_b16 v[252:253], v14 offset:544
    s_waitcnt lgkmcnt(0)
    s_nop 0
    v_add_u32 v14, 129024, v13
    ds_read_b64_tr_b16 a[14:15], v14 offset:0
    ds_read_b64_tr_b16 a[30:31], v14 offset:32
    ds_read_b64_tr_b16 a[46:47], v14 offset:64
    ds_read_b64_tr_b16 a[62:63], v14 offset:96
    ds_read_b64_tr_b16 a[78:79], v14 offset:128
    ds_read_b64_tr_b16 a[94:95], v14 offset:160
    ds_read_b64_tr_b16 a[110:111], v14 offset:192
    ds_read_b64_tr_b16 a[126:127], v14 offset:224
    ds_read_b64_tr_b16 a[142:143], v14 offset:256
    s_waitcnt lgkmcnt(0)
    s_nop 0
    ds_read_b64_tr_b16 a[158:159], v14 offset:288
    ds_read_b64_tr_b16 a[174:175], v14 offset:320
    ds_read_b64_tr_b16 a[190:191], v14 offset:352
    ds_read_b64_tr_b16 a[206:207], v14 offset:384
    ds_read_b64_tr_b16 a[222:223], v14 offset:416
    ds_read_b64_tr_b16 a[238:239], v14 offset:448
    ds_read_b64_tr_b16 a[254:255], v14 offset:480
    ds_read_b64_tr_b16 v[238:239], v14 offset:512
    ds_read_b64_tr_b16 v[254:255], v14 offset:544
    s_waitcnt lgkmcnt(0)
    s_barrier
    s_cmp_lg_u32 s17, 0
    s_cbranch_scc1 WCok_4
    v_mov_b32_e64 v13, 36
WC_3:
    buffer_load_dword v14, v13, s[8:11], 0 offen sc1
    s_waitcnt vmcnt(0)
    v_and_b32 v14, 0xffff, v14
    v_cmp_le_u32 vcc, 32, v14
    s_cbranch_vccnz WCok_4
    s_sleep 8
    s_sub_u32 s19, s19, 1
    s_cbranch_scc0 WC_3
    s_mov_b32 s19, 0
WCok_4:
    s_barrier
    s_mov_b32 s43, 0
    s_bitcmp1_b32 s98, s43
    s_cbranch_scc1 LNW_5
    s_lshl_b32 s40, s43, 2
    s_add_u32 s40, s40, 128
    s_cmp_lg_u32 s17, 0
    s_cbranch_scc1 WCok_7
    v_mov_b32_e64 v13, s40
WC_6:
    buffer_load_dword v14, v13, s[8:11], 0 offen sc1
    s_waitcnt vmcnt(0)
    v_and_b32 v14, -1, v14
    v_cmp_le_u32 vcc, 8, v14
    s_cbranch_vccnz WCok_7
    s_sleep 10
    s_sub_u32 s19, s19, 1
    s_cbranch_scc0 WC_6
    s_mov_b32 s19, 0
WCok_7:
    s_barrier
    s_bitset1_b32 s98, s43
LNW_5:
    s_mov_b32 s43, 1
    s_bitcmp1_b32 s98, s43
    s_cbranch_scc1 LNW_8
    s_lshl_b32 s40, s43, 2
    s_add_u32 s40, s40, 128
    s_cmp_lg_u32 s17, 0
    s_cbranch_scc1 WCok_10
    v_mov_b32_e64 v13, s40
WC_9:
    buffer_load_dword v14, v13, s[8:11], 0 offen sc1
    s_waitcnt vmcnt(0)
    v_and_b32 v14, -1, v14
    v_cmp_le_u32 vcc, 8, v14
    s_cbranch_vccnz WCok_10
    s_sleep 10
    s_sub_u32 s19, s19, 1
    s_cbranch_scc0 WC_9
    s_mov_b32 s19, 0
WCok_10:
    s_barrier
    s_bitset1_b32 s98, s43
LNW_8:
    s_mov_b32 s43, 2
    s_bitcmp1_b32 s98, s43
    s_cbranch_scc1 LNW_11
    s_lshl_b32 s40, s43, 2
    s_add_u32 s40, s40, 128
    s_cmp_lg_u32 s17, 0
    s_cbranch_scc1 WCok_13
    v_mov_b32_e64 v13, s40
WC_12:
    buffer_load_dword v14, v13, s[8:11], 0 offen sc1
    s_waitcnt vmcnt(0)
    v_and_b32 v14, -1, v14
    v_cmp_le_u32 vcc, 8, v14
    s_cbranch_vccnz WCok_13
    s_sleep 10
    s_sub_u32 s19, s19, 1
    s_cbranch_scc0 WC_12
    s_mov_b32 s19, 0
WCok_13:
    s_barrier
    s_bitset1_b32 s98, s43
LNW_11:
    s_mov_b32 s43, 3
    s_bitcmp1_b32 s98, s43
    s_cbranch_scc1 LNW_14
    s_lshl_b32 s40, s43, 2
    s_add_u32 s40, s40, 128
    s_cmp_lg_u32 s17, 0
    s_cbranch_scc1 WCok_16
    v_mov_b32_e64 v13, s40
WC_15:
    buffer_load_dword v14, v13, s[8:11], 0 offen sc1
    s_waitcnt vmcnt(0)
    v_and_b32 v14, -1, v14
    v_cmp_le_u32 vcc, 8, v14
    s_cbranch_vccnz WCok_16
    s_sleep 10
    s_sub_u32 s19, s19, 1
    s_cbranch_scc0 WC_15
    s_mov_b32 s19, 0
WCok_16:
    s_barrier
    s_bitset1_b32 s98, s43
LNW_14:
    s_mov_b32 s43, 4
    s_bitcmp1_b32 s98, s43
    s_cbranch_scc1 LNW_17
    s_lshl_b32 s40, s43, 2
    s_add_u32 s40, s40, 128
    s_cmp_lg_u32 s17, 0
    s_cbranch_scc1 WCok_19
    v_mov_b32_e64 v13, s40
WC_18:
    buffer_load_dword v14, v13, s[8:11], 0 offen sc1
    s_waitcnt vmcnt(0)
    v_and_b32 v14, -1, v14
    v_cmp_le_u32 vcc, 8, v14
    s_cbranch_vccnz WCok_19
    s_sleep 10
    s_sub_u32 s19, s19, 1
    s_cbranch_scc0 WC_18
    s_mov_b32 s19, 0
WCok_19:
    s_barrier
    s_bitset1_b32 s98, s43
LNW_17:
    s_mov_b32 s43, 5
    s_bitcmp1_b32 s98, s43
    s_cbranch_scc1 LNW_20
    s_lshl_b32 s40, s43, 2
    s_add_u32 s40, s40, 128
    s_cmp_lg_u32 s17, 0
    s_cbranch_scc1 WCok_22
    v_mov_b32_e64 v13, s40
WC_21:
    buffer_load_dword v14, v13, s[8:11], 0 offen sc1
    s_waitcnt vmcnt(0)
    v_and_b32 v14, -1, v14
    v_cmp_le_u32 vcc, 8, v14
    s_cbranch_vccnz WCok_22
    s_sleep 10
    s_sub_u32 s19, s19, 1
    s_cbranch_scc0 WC_21
    s_mov_b32 s19, 0
WCok_22:
    s_barrier
    s_bitset1_b32 s98, s43
LNW_20:
    s_mov_b32 s43, 6
    s_bitcmp1_b32 s98, s43
    s_cbranch_scc1 LNW_23
    s_lshl_b32 s40, s43, 2
    s_add_u32 s40, s40, 128
    s_cmp_lg_u32 s17, 0
    s_cbranch_scc1 WCok_25
    v_mov_b32_e64 v13, s40
WC_24:
    buffer_load_dword v14, v13, s[8:11], 0 offen sc1
    s_waitcnt vmcnt(0)
    v_and_b32 v14, -1, v14
    v_cmp_le_u32 vcc, 8, v14
    s_cbranch_vccnz WCok_25
    s_sleep 10
    s_sub_u32 s19, s19, 1
    s_cbranch_scc0 WC_24
    s_mov_b32 s19, 0
WCok_25:
    s_barrier
    s_bitset1_b32 s98, s43
LNW_23:
    s_mov_b32 s43, 7
    s_bitcmp1_b32 s98, s43
    s_cbranch_scc1 LNW_26
    s_lshl_b32 s40, s43, 2
    s_add_u32 s40, s40, 128
    s_cmp_lg_u32 s17, 0
    s_cbranch_scc1 WCok_28
    v_mov_b32_e64 v13, s40
WC_27:
    buffer_load_dword v14, v13, s[8:11], 0 offen sc1
    s_waitcnt vmcnt(0)
    v_and_b32 v14, -1, v14
    v_cmp_le_u32 vcc, 8, v14
    s_cbranch_vccnz WCok_28
    s_sleep 10
    s_sub_u32 s19, s19, 1
    s_cbranch_scc0 WC_27
    s_mov_b32 s19, 0
WCok_28:
    s_barrier
    s_bitset1_b32 s98, s43
LNW_26:
    s_lshl_b32 s45, s22, 4
    s_add_u32 s45, s45, 64561152
    s_cmp_lg_u32 s17, 0
    s_cbranch_scc1 WFok_30
    v_mbcnt_lo_u32_b32 v13, -1, 0
    v_mbcnt_hi_u32_b32 v13, -1, v13
    v_min_u32 v13, 3, v13
    v_mul_u32_u24_e64 v13, 4, v13
WF_29:
    buffer_load_dword v14, v13, s[4:7], s45 offen sc1
    s_waitcnt vmcnt(0)
    v_cmp_eq_u32 vcc, 0, v14
    s_cbranch_vccz WFok_30
    s_sleep 16
    s_sub_u32 s19, s19, 1
    s_cbranch_scc0 WF_29
    s_mov_b32 s19, 0
WFok_30:
    s_barrier
    s_lshl_b32 s45, s22, 2
    s_add_u32 s45, s45, 64553984
    s_cmp_lg_u32 s17, 0
    s_cbranch_scc1 WFok_32
    v_mbcnt_lo_u32_b32 v13, -1, 0
    v_mbcnt_hi_u32_b32 v13, -1, v13
    v_min_u32 v13, 6, v13
    v_mul_u32_u24 v13, 1024, v13
WF_31:
    buffer_load_dword v14, v13, s[4:7], s45 offen sc1
    s_waitcnt vmcnt(0)
    v_cmp_eq_u32 vcc, 0, v14
    s_cbranch_vccz WFok_32
    s_sleep 16
    s_sub_u32 s19, s19, 1
    s_cbranch_scc0 WF_31
    s_mov_b32 s19, 0
WFok_32:
    s_barrier
    s_lshr_b32 s45, s22, 1
    s_lshl_b32 s45, s45, 2
    s_add_u32 s45, s45, 64553472
    s_cmp_lg_u32 s17, 0
    s_cbranch_scc1 WFok_34
    v_mbcnt_lo_u32_b32 v13, -1, 0
    v_mbcnt_hi_u32_b32 v13, -1, v13
    v_min_u32_e64 v13, 7, v13
    v_mul_u32_u24 v13, 1024, v13
WF_33:
    buffer_load_dword v14, v13, s[4:7], s45 offen sc1
    s_waitcnt vmcnt(0)
    v_cmp_eq_u32 vcc, 0, v14
    s_cbranch_vccz WFok_34
    s_sleep 16
    s_sub_u32 s19, s19, 1
    s_cbranch_scc0 WF_33
    s_mov_b32 s19, 0
WFok_34:
    s_barrier
    s_mov_b32 s24, s34
    s_mov_b32 s33, 64
    s_mov_b32 s31, 0
    s_mov_b32 s32, 0
    s_lshl_b32 s25, s22, 6
    s_add_u32 s25, s25, s24
    s_lshl_b32 s25, s25, 13
    s_lshl_b32 s27, s24, 5
    s_add_u32 s27, s27, s22
    s_mul_i32 s27, s27, 36
    s_mul_i32 s40, s21, 18
    s_add_u32 s27, s27, s40
    s_mul_i32 s40, s23, 9
    s_add_u32 s27, s27, s40
    s_lshl_b32 s27, s27, 10
    s_add_u32 s27, s27, 134217728
    s_lshl_b32 s30, s22, 7
    s_add_u32 s30, s30, 64569344
    s_lshl_b32 s29, s22, 2
    s_lshl_b32 s40, s17, 7
    s_add_u32 s29, s29, s40
    s_lshl_b32 s40, s34, 9
    s_add_u32 s29, s29, s40
    s_nop 0
    s_add_u32 s29, s29, 64487936
    s_add_u32 s40, s25, 37748736
    s_add_u32 s41, s40, 4096
    buffer_load_dwordx4 v[16:19], v1, s[4:7], s40 offen offset:0
    buffer_load_dwordx4 v[20:23], v1, s[4:7], s40 offen offset:2048
    buffer_load_dwordx4 v[24:27], v1, s[4:7], s41 offen offset:0
    buffer_load_dwordx4 v[28:31], v1, s[4:7], s41 offen offset:2048
    s_add_u32 s40, s25, 4194304
    s_add_u32 s41, s40, 4096
    buffer_load_dwordx4 v[32:35], v2, s[4:7], s40 offen offset:0
    buffer_load_dwordx4 v[36:39], v2, s[4:7], s40 offen offset:256
    buffer_load_dwordx4 v[40:43], v2, s[4:7], s40 offen offset:2048
    buffer_load_dwordx4 v[44:47], v2, s[4:7], s40 offen offset:2304
    buffer_load_dwordx4 v[48:51], v2, s[4:7], s41 offen offset:0
    buffer_load_dwordx4 v[52:55], v2, s[4:7], s41 offen offset:256
    buffer_load_dwordx4 v[56:59], v2, s[4:7], s41 offen offset:2048
    buffer_load_dwordx4 v[60:63], v2, s[4:7], s41 offen offset:2304
    s_add_u32 s40, s25, 20971520
    s_add_u32 s41, s40, 4096
    buffer_load_dwordx4 v[64:67], v0, s[4:7], s40 offen offset:0
    buffer_load_dwordx4 v[68:71], v0, s[4:7], s40 offen offset:1024
    buffer_load_dwordx4 v[72:75], v0, s[4:7], s40 offen offset:2048
    buffer_load_dwordx4 v[76:79], v0, s[4:7], s40 offen offset:3072
    buffer_load_dwordx4 v[80:83], v0, s[4:7], s41 offen offset:0
    buffer_load_dwordx4 v[84:87], v0, s[4:7], s41 offen offset:1024
    buffer_load_dwordx4 v[88:91], v0, s[4:7], s41 offen offset:2048
    buffer_load_dwordx4 v[92:95], v0, s[4:7], s41 offen offset:3072
R_LOOP:
    s_cmp_eq_u32 s32, 1
    s_cbranch_scc1 R_HAVE
    s_waitcnt vmcnt(0)
    v_mov_b32 v13, s24
    buffer_store_dword v13, off, s[4:7], s29 sc1
R_POLL:
    buffer_load_dwordx4 v[8:11], off, s[4:7], s30 sc1
    s_waitcnt vmcnt(0)
    v_min3_u32 v8, v8, v9, v10
    v_min_u32 v8, v8, v11
    s_nop 0
    v_readfirstlane_b32 s31, v8
    s_nop 1
    s_cmp_gt_u32 s31, s24
    s_cbranch_scc1 R_GO
    s_sleep 3
    s_mov_b32 s40, s31
R_BK:
    s_cmp_ge_u32 s40, s24
    s_cbranch_scc1 R_BK2
    s_sleep 50
    s_add_u32 s40, s40, 1
    s_branch R_BK
R_BK2:
    s_sub_u32 s19, s19, 1
    s_cbranch_scc0 R_POLL
    s_mov_b32 s19, 0
R_GO:
    s_lshr_b32 s40, s25, 1
    s_add_u32 s40, s40, 234881024
    s_lshr_b32 s41, s25, 2
    s_nop 0
    s_add_u32 s41, s41, 218103808
    buffer_load_dwordx4 v[96:99], v0, s[4:7], s40 offen offset:0 sc1
    buffer_load_dwordx4 v[100:103], v0, s[4:7], s40 offen offset:1024 sc1
    buffer_load_dwordx4 v[104:107], v0, s[4:7], s40 offen offset:2048 sc1
    buffer_load_dwordx4 v[108:111], v0, s[4:7], s40 offen offset:3072 sc1
    buffer_load_dwordx2 v[112:113], v3, s[4:7], s41 offen offset:0 sc1
    buffer_load_dwordx2 v[114:115], v3, s[4:7], s41 offen offset:512 sc1
    buffer_load_dwordx2 v[116:117], v3, s[4:7], s41 offen offset:1024 sc1
    buffer_load_dwordx2 v[118:119], v3, s[4:7], s41 offen offset:1536 sc1
    s_waitcnt vmcnt(0)
    s_branch R_HAVE2
R_HAVE:
    s_waitcnt vmcnt(9)
    v_min3_u32 v8, v8, v9, v10
    v_min_u32 v8, v8, v11
    s_nop 0
    v_readfirstlane_b32 s31, v8
    s_sub_u32 s40, s24, 4
    v_mov_b32 v13, s40
    buffer_store_dword v13, off, s[4:7], s29 sc1
R_HAVE2:
    ds_write_b64 v4, v[96:97] offset:0
    ds_write_b64 v4, v[98:99] offset:2048
    ds_write_b64 v4, v[100:101] offset:512
    ds_write_b64 v4, v[102:103] offset:2560
    ds_write_b64 v4, v[104:105] offset:1024
    ds_write_b64 v4, v[106:107] offset:3072
    ds_write_b64 v4, v[108:109] offset:1536
    ds_write_b64 v4, v[110:111] offset:3584
    v_mfma_f32_16x16x32_bf16 v[132:135], v[32:35], v[16:19], 0
    v_mfma_f32_16x16x32_bf16 v[136:139], v[36:39], v[16:19], 0
    v_mfma_f32_16x16x32_bf16 v[132:135], v[40:43], v[20:23], v[132:135]
    v_mfma_f32_16x16x32_bf16 v[136:139], v[44:47], v[20:23], v[136:139]
    s_waitcnt lgkmcnt(0)
    s_nop 0
    ds_read_b64_tr_b16 v[96:97], v6 offset:0
    ds_read_b64_tr_b16 v[98:99], v6 offset:128
    ds_read_b64_tr_b16 v[100:101], v6 offset:1024
    ds_read_b64_tr_b16 v[102:103], v6 offset:1152
    ds_read_b64_tr_b16 v[104:105], v6 offset:2048
    ds_read_b64_tr_b16 v[106:107], v6 offset:2176
    ds_read_b64_tr_b16 v[108:109], v6 offset:3072
    ds_read_b64_tr_b16 v[110:111], v6 offset:3200
    v_mfma_f32_16x16x32_bf16 v[132:135], v[48:51], v[24:27], v[132:135]
    v_mfma_f32_16x16x32_bf16 v[136:139], v[52:55], v[24:27], v[136:139]
    v_mfma_f32_16x16x32_bf16 v[132:135], v[56:59], v[28:31], v[132:135]
    v_mfma_f32_16x16x32_bf16 v[136:139], v[60:63], v[28:31], v[136:139]
    s_waitcnt lgkmcnt(6)
    v_mfma_f32_16x16x32_bf16 v[128:131], v[96:99], v[16:19], 0
    s_waitcnt lgkmcnt(4)
    v_mfma_f32_16x16x32_bf16 v[128:131], v[100:103], v[20:23], v[128:131]
    s_waitcnt lgkmcnt(2)
    v_mfma_f32_16x16x32_bf16 v[128:131], v[104:107], v[24:27], v[128:131]
    s_waitcnt lgkmcnt(0)
    v_mfma_f32_16x16x32_bf16 v[128:131], v[108:111], v[28:31], v[128:131]
    v_cndmask_b32 v132, v5, v132, s[64:65]
    v_cndmask_b32 v133, v5, v133, s[66:67]
    v_cndmask_b32 v134, v5, v134, s[68:69]
    v_cndmask_b32 v135, v5, v135, s[70:71]
    v_cndmask_b32 v136, v5, v136, s[72:73]
    v_cndmask_b32 v137, v5, v137, s[74:75]
    v_cndmask_b32 v138, v5, v138, s[76:77]
    v_cndmask_b32 v139, v5, v139, s[78:79]
    v_max3_f32 v204, v132, v133, v134
    v_max3_f32 v204, v204, v135, v136
    v_max3_f32 v204, v204, v137, v138
    v_max3_f32 v202, v130, v131, v139
    v_max_f32 v202, v202, v204
    v_mov_b32 v204, v202
    s_nop 1
    v_permlane32_swap_b32 v202, v204
    v_max_f32 v202, v202, v204
    v_mov_b32 v204, v202
    s_nop 1
    v_permlane16_swap_b32 v202, v204
    v_max_f32 v202, v202, v204
    v_mul_f32 v202, s28, v202
    v_fma_f32 v130, v130, s28, -v202
    v_fma_f32 v131, v131, s28, -v202
    v_fma_f32 v132, v132, s28, -v202
    v_fma_f32 v133, v133, s28, -v202
    v_fma_f32 v134, v134, s28, -v202
    v_fma_f32 v135, v135, s28, -v202
    v_fma_f32 v136, v136, s28, -v202
    v_fma_f32 v137, v137, s28, -v202
    v_fma_f32 v138, v138, s28, -v202
    v_fma_f32 v139, v139, s28, -v202
    v_exp_f32 v130, v130
    v_exp_f32 v131, v131
    v_exp_f32 v132, v132
    v_exp_f32 v133, v133
    v_exp_f32 v134, v134
    v_exp_f32 v135, v135
    v_exp_f32 v136, v136
    v_exp_f32 v137, v137
    v_exp_f32 v138, v138
    v_exp_f32 v139, v139
    s_nop 0
    s_nop 0
    v_cvt_pk_bf16_f32 v120, v130, v131
    v_cvt_pk_bf16_f32 v123, v130, v131
    v_cvt_pk_bf16_f32 v198, v132, v133
    v_cvt_pk_bf16_f32 v199, v134, v135
    v_cvt_pk_bf16_f32 v200, v136, v137
    v_cvt_pk_bf16_f32 v201, v138, v139
    s_nop 1
    v_mfma_f32_16x16x32_bf16 v[172:175], v[192:195], v[198:201], 0
    v_mfma_f32_16x16x32_bf16 v[140:143], v[64:67], v[198:201], 0
    v_mfma_f32_16x16x32_bf16 v[144:147], v[68:71], v[198:201], 0
    v_mfma_f32_16x16x32_bf16 v[148:151], v[72:75], v[198:201], 0
    v_mfma_f32_16x16x32_bf16 v[152:155], v[76:79], v[198:201], 0
    v_mfma_f32_16x16x32_bf16 v[156:159], v[80:83], v[198:201], 0
    v_mfma_f32_16x16x32_bf16 v[160:163], v[84:87], v[198:201], 0
    v_mfma_f32_16x16x32_bf16 v[164:167], v[88:91], v[198:201], 0
    v_mfma_f32_16x16x32_bf16 v[168:171], v[92:95], v[198:201], 0
    v_mfma_f32_16x16x16_bf16 v[172:175], v[192:193], v[120:121], v[172:175]
    v_mfma_f32_16x16x16_bf16 v[140:143], v[112:113], v[120:121], v[140:143]
    v_mfma_f32_16x16x16_bf16 v[144:147], v[114:115], v[120:121], v[144:147]
    v_mfma_f32_16x16x16_bf16 v[148:151], v[116:117], v[120:121], v[148:151]
    v_mfma_f32_16x16x16_bf16 v[152:155], v[118:119], v[120:121], v[152:155]
    v_mfma_f32_16x16x16_bf16 v[156:159], v[112:113], v[122:123], v[156:159]
    v_mfma_f32_16x16x16_bf16 v[160:163], v[114:115], v[122:123], v[160:163]
    v_mfma_f32_16x16x16_bf16 v[164:167], v[116:117], v[122:123], v[164:167]
    v_mfma_f32_16x16x16_bf16 v[168:171], v[118:119], v[122:123], v[168:171]
    v_rcp_f32 v202, v172
    s_add_u32 s24, s24, 4
    s_add_u32 s25, s25, 32768
    s_mov_b32 s32, 0
    s_cmp_ge_u32 s24, s33
    s_cbranch_scc1 R_nopf_35
    s_add_u32 s40, s25, 37748736
    s_add_u32 s41, s40, 4096
    buffer_load_dwordx4 v[16:19], v1, s[4:7], s40 offen offset:0
    buffer_load_dwordx4 v[20:23], v1, s[4:7], s40 offen offset:2048
    buffer_load_dwordx4 v[24:27], v1, s[4:7], s41 offen offset:0
    buffer_load_dwordx4 v[28:31], v1, s[4:7], s41 offen offset:2048
    s_add_u32 s40, s25, 4194304
    s_add_u32 s41, s40, 4096
    buffer_load_dwordx4 v[32:35], v2, s[4:7], s40 offen offset:0
    buffer_load_dwordx4 v[36:39], v2, s[4:7], s40 offen offset:256
    buffer_load_dwordx4 v[40:43], v2, s[4:7], s40 offen offset:2048
    buffer_load_dwordx4 v[44:47], v2, s[4:7], s40 offen offset:2304
    buffer_load_dwordx4 v[48:51], v2, s[4:7], s41 offen offset:0
    buffer_load_dwordx4 v[52:55], v2, s[4:7], s41 offen offset:256
    buffer_load_dwordx4 v[56:59], v2, s[4:7], s41 offen offset:2048
    buffer_load_dwordx4 v[60:63], v2, s[4:7], s41 offen offset:2304
    s_add_u32 s40, s25, 20971520
    s_add_u32 s41, s40, 4096
    buffer_load_dwordx4 v[64:67], v0, s[4:7], s40 offen offset:0
    buffer_load_dwordx4 v[68:71], v0, s[4:7], s40 offen offset:1024
    buffer_load_dwordx4 v[72:75], v0, s[4:7], s40 offen offset:2048
    buffer_load_dwordx4 v[76:79], v0, s[4:7], s40 offen offset:3072
    buffer_load_dwordx4 v[80:83], v0, s[4:7], s41 offen offset:0
    buffer_load_dwordx4 v[84:87], v0, s[4:7], s41 offen offset:1024
    buffer_load_dwordx4 v[88:91], v0, s[4:7], s41 offen offset:2048
    buffer_load_dwordx4 v[92:95], v0, s[4:7], s41 offen offset:3072
    s_cmp_le_u32 s31, s24
    s_cbranch_scc1 R_nopf_35
    s_mov_b32 s32, 1
    s_lshr_b32 s40, s25, 1
    s_add_u32 s40, s40, 234881024
    s_lshr_b32 s41, s25, 2
    s_nop 0
    s_add_u32 s41, s41, 218103808
    buffer_load_dwordx4 v[96:99], v0, s[4:7], s40 offen offset:0 sc1
    buffer_load_dwordx4 v[100:103], v0, s[4:7], s40 offen offset:1024 sc1
    buffer_load_dwordx4 v[104:107], v0, s[4:7], s40 offen offset:2048 sc1
    buffer_load_dwordx4 v[108:111], v0, s[4:7], s40 offen offset:3072 sc1
    buffer_load_dwordx2 v[112:113], v3, s[4:7], s41 offen offset:0 sc1
    buffer_load_dwordx2 v[114:115], v3, s[4:7], s41 offen offset:512 sc1
    buffer_load_dwordx2 v[116:117], v3, s[4:7], s41 offen offset:1024 sc1
    buffer_load_dwordx2 v[118:119], v3, s[4:7], s41 offen offset:1536 sc1
    buffer_load_dwordx4 v[8:11], off, s[4:7], s30 sc1
R_nopf_35:
    v_mov_b32 v203, v202
    s_nop 7
    v_pk_mul_f32 v[140:141], v[140:141], v[202:203]
    v_pk_mul_f32 v[142:143], v[142:143], v[202:203]
    v_cvt_pk_bf16_f32 v176, v140, v141
    v_cvt_pk_bf16_f32 v177, v142, v143
    v_pk_mul_f32 v[144:145], v[144:145], v[202:203]
    v_pk_mul_f32 v[146:147], v[146:147], v[202:203]
    v_cvt_pk_bf16_f32 v178, v144, v145
    v_cvt_pk_bf16_f32 v179, v146, v147
    v_pk_mul_f32 v[148:149], v[148:149], v[202:203]
    v_pk_mul_f32 v[150:151], v[150:151], v[202:203]
    v_cvt_pk_bf16_f32 v180, v148, v149
    v_cvt_pk_bf16_f32 v181, v150, v151
    v_pk_mul_f32 v[152:153], v[152:153], v[202:203]
    v_pk_mul_f32 v[154:155], v[154:155], v[202:203]
    v_cvt_pk_bf16_f32 v182, v152, v153
    v_cvt_pk_bf16_f32 v183, v154, v155
    v_pk_mul_f32 v[156:157], v[156:157], v[202:203]
    v_pk_mul_f32 v[158:159], v[158:159], v[202:203]
    v_cvt_pk_bf16_f32 v184, v156, v157
    v_cvt_pk_bf16_f32 v185, v158, v159
    v_pk_mul_f32 v[160:161], v[160:161], v[202:203]
    v_pk_mul_f32 v[162:163], v[162:163], v[202:203]
    v_cvt_pk_bf16_f32 v186, v160, v161
    v_cvt_pk_bf16_f32 v187, v162, v163
    v_pk_mul_f32 v[164:165], v[164:165], v[202:203]
    v_pk_mul_f32 v[166:167], v[166:167], v[202:203]
    v_cvt_pk_bf16_f32 v188, v164, v165
    v_cvt_pk_bf16_f32 v189, v166, v167
    v_pk_mul_f32 v[168:169], v[168:169], v[202:203]
    v_pk_mul_f32 v[170:171], v[170:171], v[202:203]
    v_cvt_pk_bf16_f32 v190, v168, v169
    v_cvt_pk_bf16_f32 v191, v170, v171
    s_mov_b32 s40, s27
    s_add_u32 s41, s27, 4096
    s_add_u32 s42, s27, 8192
    s_add_u32 s27, s27, 4718592
    v_mfma_f32_16x16x32_bf16 v[206:209], a[0:3], v[176:179], 0
    v_mfma_f32_16x16x32_bf16 v[210:213], a[16:19], v[176:179], 0
    v_mfma_f32_16x16x32_bf16 v[206:209], a[4:7], v[180:183], v[206:209]
    v_mfma_f32_16x16x32_bf16 v[210:213], a[20:23], v[180:183], v[210:213]
    v_mfma_f32_16x16x32_bf16 v[206:209], a[8:11], v[184:187], v[206:209]
    v_mfma_f32_16x16x32_bf16 v[210:213], a[24:27], v[184:187], v[210:213]
    v_mfma_f32_16x16x32_bf16 v[206:209], a[12:15], v[188:191], v[206:209]
    v_mfma_f32_16x16x32_bf16 v[210:213], a[28:31], v[188:191], v[210:213]
    v_mfma_f32_16x16x32_bf16 v[214:217], a[32:35], v[176:179], 0
    v_mfma_f32_16x16x32_bf16 v[218:221], a[48:51], v[176:179], 0
    v_mfma_f32_16x16x32_bf16 v[214:217], a[36:39], v[180:183], v[214:217]
    v_mfma_f32_16x16x32_bf16 v[218:221], a[52:55], v[180:183], v[218:221]
    v_mfma_f32_16x16x32_bf16 v[214:217], a[40:43], v[184:187], v[214:217]
    v_mfma_f32_16x16x32_bf16 v[218:221], a[56:59], v[184:187], v[218:221]
    v_mfma_f32_16x16x32_bf16 v[214:217], a[44:47], v[188:191], v[214:217]
    v_mfma_f32_16x16x32_bf16 v[218:221], a[60:63], v[188:191], v[218:221]
    s_nop 0
    v_cvt_pk_bf16_f32 v140, v206, v207
    v_cvt_pk_bf16_f32 v141, v208, v209
    v_cvt_pk_bf16_f32 v142, v210, v211
    v_cvt_pk_bf16_f32 v143, v212, v213
    buffer_store_dwordx4 v[140:143], v0, s[4:7], s40 offen offset:0 sc1
    v_mfma_f32_16x16x32_bf16 v[206:209], a[64:67], v[176:179], 0
    v_mfma_f32_16x16x32_bf16 v[210:213], a[80:83], v[176:179], 0
    v_mfma_f32_16x16x32_bf16 v[206:209], a[68:71], v[180:183], v[206:209]
    v_mfma_f32_16x16x32_bf16 v[210:213], a[84:87], v[180:183], v[210:213]
    v_mfma_f32_16x16x32_bf16 v[206:209], a[72:75], v[184:187], v[206:209]
    v_mfma_f32_16x16x32_bf16 v[210:213], a[88:91], v[184:187], v[210:213]
    v_mfma_f32_16x16x32_bf16 v[206:209], a[76:79], v[188:191], v[206:209]
    v_mfma_f32_16x16x32_bf16 v[210:213], a[92:95], v[188:191], v[210:213]
    v_cvt_pk_bf16_f32 v144, v214, v215
    v_cvt_pk_bf16_f32 v145, v216, v217
    v_cvt_pk_bf16_f32 v146, v218, v219
    v_cvt_pk_bf16_f32 v147, v220, v221
    buffer_store_dwordx4 v[144:147], v0, s[4:7], s40 offen offset:1024 sc1
    v_mfma_f32_16x16x32_bf16 v[214:217], a[96:99], v[176:179], 0
    v_mfma_f32_16x16x32_bf16 v[218:221], a[112:115], v[176:179], 0
    v_mfma_f32_16x16x32_bf16 v[214:217], a[100:103], v[180:183], v[214:217]
    v_mfma_f32_16x16x32_bf16 v[218:221], a[116:119], v[180:183], v[218:221]
    v_mfma_f32_16x16x32_bf16 v[214:217], a[104:107], v[184:187], v[214:217]
    v_mfma_f32_16x16x32_bf16 v[218:221], a[120:123], v[184:187], v[218:221]
    v_mfma_f32_16x16x32_bf16 v[214:217], a[108:111], v[188:191], v[214:217]
    v_mfma_f32_16x16x32_bf16 v[218:221], a[124:127], v[188:191], v[218:221]
    v_cvt_pk_bf16_f32 v148, v206, v207
    v_cvt_pk_bf16_f32 v149, v208, v209
    v_cvt_pk_bf16_f32 v150, v210, v211
    v_cvt_pk_bf16_f32 v151, v212, v213
    buffer_store_dwordx4 v[148:151], v0, s[4:7], s40 offen offset:2048 sc1
    v_mfma_f32_16x16x32_bf16 v[206:209], a[128:131], v[176:179], 0
    v_mfma_f32_16x16x32_bf16 v[210:213], a[144:147], v[176:179], 0
    v_mfma_f32_16x16x32_bf16 v[206:209], a[132:135], v[180:183], v[206:209]
    v_mfma_f32_16x16x32_bf16 v[210:213], a[148:151], v[180:183], v[210:213]
    v_mfma_f32_16x16x32_bf16 v[206:209], a[136:139], v[184:187], v[206:209]
    v_mfma_f32_16x16x32_bf16 v[210:213], a[152:155], v[184:187], v[210:213]
    v_mfma_f32_16x16x32_bf16 v[206:209], a[140:143], v[188:191], v[206:209]
    v_mfma_f32_16x16x32_bf16 v[210:213], a[156:159], v[188:191], v[210:213]
    v_cvt_pk_bf16_f32 v152, v214, v215
    v_cvt_pk_bf16_f32 v153, v216, v217
    v_cvt_pk_bf16_f32 v154, v218, v219
    v_cvt_pk_bf16_f32 v155, v220, v221
    buffer_store_dwordx4 v[152:155], v0, s[4:7], s40 offen offset:3072 sc1
    v_mfma_f32_16x16x32_bf16 v[214:217], a[160:163], v[176:179], 0
    v_mfma_f32_16x16x32_bf16 v[218:221], a[176:179], v[176:179], 0
    v_mfma_f32_16x16x32_bf16 v[214:217], a[164:167], v[180:183], v[214:217]
    v_mfma_f32_16x16x32_bf16 v[218:221], a[180:183], v[180:183], v[218:221]
    v_mfma_f32_16x16x32_bf16 v[214:217], a[168:171], v[184:187], v[214:217]
    v_mfma_f32_16x16x32_bf16 v[218:221], a[184:187], v[184:187], v[218:221]
    v_mfma_f32_16x16x32_bf16 v[214:217], a[172:175], v[188:191], v[214:217]
    v_mfma_f32_16x16x32_bf16 v[218:221], a[188:191], v[188:191], v[218:221]
    v_cvt_pk_bf16_f32 v156, v206, v207
    v_cvt_pk_bf16_f32 v157, v208, v209
    v_cvt_pk_bf16_f32 v158, v210, v211
    v_cvt_pk_bf16_f32 v159, v212, v213
    buffer_store_dwordx4 v[156:159], v0, s[4:7], s41 offen offset:0 sc1
    v_mfma_f32_16x16x32_bf16 v[206:209], a[192:195], v[176:179], 0
    v_mfma_f32_16x16x32_bf16 v[210:213], a[208:211], v[176:179], 0
    v_mfma_f32_16x16x32_bf16 v[206:209], a[196:199], v[180:183], v[206:209]
    v_mfma_f32_16x16x32_bf16 v[210:213], a[212:215], v[180:183], v[210:213]
    v_mfma_f32_16x16x32_bf16 v[206:209], a[200:203], v[184:187], v[206:209]
    v_mfma_f32_16x16x32_bf16 v[210:213], a[216:219], v[184:187], v[210:213]
    v_mfma_f32_16x16x32_bf16 v[206:209], a[204:207], v[188:191], v[206:209]
    v_mfma_f32_16x16x32_bf16 v[210:213], a[220:223], v[188:191], v[210:213]
    v_cvt_pk_bf16_f32 v160, v214, v215
    v_cvt_pk_bf16_f32 v161, v216, v217
    v_cvt_pk_bf16_f32 v162, v218, v219
    v_cvt_pk_bf16_f32 v163, v220, v221
    buffer_store_dwordx4 v[160:163], v0, s[4:7], s41 offen offset:1024 sc1
    v_mfma_f32_16x16x32_bf16 v[214:217], a[224:227], v[176:179], 0
    v_mfma_f32_16x16x32_bf16 v[218:221], a[240:243], v[176:179], 0
    v_mfma_f32_16x16x32_bf16 v[214:217], a[228:231], v[180:183], v[214:217]
    v_mfma_f32_16x16x32_bf16 v[218:221], a[244:247], v[180:183], v[218:221]
    v_mfma_f32_16x16x32_bf16 v[214:217], a[232:235], v[184:187], v[214:217]
    v_mfma_f32_16x16x32_bf16 v[218:221], a[248:251], v[184:187], v[218:221]
    v_mfma_f32_16x16x32_bf16 v[214:217], a[236:239], v[188:191], v[214:217]
    v_mfma_f32_16x16x32_bf16 v[218:221], a[252:255], v[188:191], v[218:221]
    v_cvt_pk_bf16_f32 v164, v206, v207
    v_cvt_pk_bf16_f32 v165, v208, v209
    v_cvt_pk_bf16_f32 v166, v210, v211
    v_cvt_pk_bf16_f32 v167, v212, v213
    buffer_store_dwordx4 v[164:167], v0, s[4:7], s41 offen offset:2048 sc1
    v_mfma_f32_16x16x32_bf16 v[206:209], v[224:227], v[176:179], 0
    v_mfma_f32_16x16x32_bf16 v[210:213], v[240:243], v[176:179], 0
    v_mfma_f32_16x16x32_bf16 v[206:209], v[228:231], v[180:183], v[206:209]
    v_mfma_f32_16x16x32_bf16 v[210:213], v[244:247], v[180:183], v[210:213]
    v_mfma_f32_16x16x32_bf16 v[206:209], v[232:235], v[184:187], v[206:209]
    v_mfma_f32_16x16x32_bf16 v[210:213], v[248:251], v[184:187], v[210:213]
    v_mfma_f32_16x16x32_bf16 v[206:209], v[236:239], v[188:191], v[206:209]
    v_mfma_f32_16x16x32_bf16 v[210:213], v[252:255], v[188:191], v[210:213]
    v_cvt_pk_bf16_f32 v168, v214, v215
    v_cvt_pk_bf16_f32 v169, v216, v217
    v_cvt_pk_bf16_f32 v170, v218, v219
    v_cvt_pk_bf16_f32 v171, v220, v221
    buffer_store_dwordx4 v[168:171], v0, s[4:7], s41 offen offset:3072 sc1
    s_nop 3
    s_nop 0
    v_cvt_pk_bf16_f32 v140, v206, v207
    v_cvt_pk_bf16_f32 v141, v208, v209
    v_cvt_pk_bf16_f32 v142, v210, v211
    v_cvt_pk_bf16_f32 v143, v212, v213
    buffer_store_dwordx4 v[140:143], v0, s[4:7], s42 offen offset:0 sc1
    s_cmp_lt_u32 s24, s33
    s_cbranch_scc1 R_LOOP
    s_waitcnt vmcnt(0)
    v_mov_b32 v13, s24
    buffer_store_dword v13, off, s[4:7], s29 sc1
    s_waitcnt vmcnt(0)
    s_barrier
    s_branch NEXT
DO_RED:
    v_mbcnt_lo_u32_b32 v8, -1, 0
    v_mbcnt_hi_u32_b32 v8, -1, v8
    s_load_dwordx2 s[12:13], s[0:1], 0
    s_waitcnt lgkmcnt(0)
    s_and_b32 s13, s13, 0xffff
    s_mov_b32 s14, 2359296
    s_mov_b32 s15, 0x00020000
    s_load_dwordx2 s[60:61], s[0:1], 88
    s_waitcnt lgkmcnt(0)
    s_and_b32 s61, s61, 0xffff
    s_mov_b32 s62, 2359296
    s_mov_b32 s63, 0x00020000
    s_mul_i32 s24, s22, 7282
    s_lshr_b32 s24, s24, 16
    s_mul_i32 s40, s24, 9
    s_sub_u32 s31, s22, s40
    s_lshl_b32 s31, s31, 1
    s_lshr_b32 s40, s17, 1
    s_add_u32 s31, s31, s40
    s_and_b32 s21, s17, 1
    v_and_b32 v9, 15, v8
    v_lshrrev_b32 v10, 4, v8
    v_and_b32 v11, 1, v10
    v_lshrrev_b32 v12, 1, v10
    v_mul_u32_u24 v0, 36864, v11
    v_lshl_add_u32 v0, v9, 4, v0
    v_lshl_add_u32 v0, v12, 8, v0
    v_lshlrev_b32_e64 v1, 11, v11
    v_lshl_add_u32 v1, v12, 9, v1
    v_lshl_add_u32 v1, v9, 4, v1
    v_mul_u32_u24 v2, 1152, v9
    v_lshl_add_u32 v2, v11, 5, v2
    v_lshl_add_u32 v2, v12, 3, v2
    v_and_b32 v3, 31, v8
    v_lshlrev_b32 v3, 2, v3
    v_and_b32 v11, 1, v9
    v_lshlrev_b32 v11, 4, v11
    v_mov_b32 v13, 0x3f80
    v_lshlrev_b32 v13, v11, v13
    v_lshrrev_b32 v11, 3, v9
    v_cmp_eq_u32 vcc, v11, v12
    s_nop 1
    v_cndmask_b32_e64 v13, 0, v13, vcc
    v_bfe_u32 v11, v9, 1, 2
    v_cmp_eq_u32 vcc, 0, v11
    s_nop 1
    v_cndmask_b32 v4, 0, v13, vcc
    v_cmp_eq_u32 vcc, 1, v11
    s_nop 1
    v_cndmask_b32 v5, 0, v13, vcc
    v_cmp_eq_u32 vcc, 2, v11
    s_nop 1
    v_cndmask_b32 v6, 0, v13, vcc
    v_cmp_eq_u32 vcc, 3, v11
    s_nop 1
    v_cndmask_b32 v7, 0, v13, vcc
    s_mov_b32 s43, 0
    s_bitcmp1_b32 s98, s43
    s_cbranch_scc1 LNW_36
    s_lshl_b32 s40, s43, 2
    s_add_u32 s40, s40, 128
    s_cmp_lg_u32 s17, 0
    s_cbranch_scc1 WCok_38
    v_mov_b32_e64 v11, s40
WC_37:
    buffer_load_dword v12, v11, s[8:11], 0 offen sc1
    s_waitcnt vmcnt(0)
    v_and_b32 v12, -1, v12
    v_cmp_le_u32 vcc, 8, v12
    s_cbranch_vccnz WCok_38
    s_sleep 10
    s_sub_u32 s19, s19, 1
    s_cbranch_scc0 WC_37
    s_mov_b32 s19, 0
WCok_38:
    s_barrier
    s_bitset1_b32 s98, s43
LNW_36:
    s_lshr_b32 s43, s24, 3
    s_bitcmp1_b32 s98, s43
    s_cbranch_scc1 LNW_39
    s_lshl_b32 s40, s43, 2
    s_add_u32 s40, s40, 128
    s_cmp_lg_u32 s17, 0
    s_cbranch_scc1 WCok_41
    v_mov_b32_e64 v11, s40
WC_40:
    buffer_load_dword v12, v11, s[8:11], 0 offen sc1
    s_waitcnt vmcnt(0)
    v_and_b32 v12, -1, v12
    v_cmp_le_u32 vcc, 8, v12
    s_cbranch_vccnz WCok_41
    s_sleep 10
    s_sub_u32 s19, s19, 1
    s_cbranch_scc0 WC_40
    s_mov_b32 s19, 0
WCok_41:
    s_barrier
    s_bitset1_b32 s98, s43
LNW_39:
    s_mul_i32 s44, s31, 43
    s_lshr_b32 s44, s44, 8
    s_lshl_b32 s44, s44, 3
    s_lshl_b32 s45, s43, 8
    s_add_u32 s45, s45, s44
    s_lshl_b32 s45, s45, 2
    s_add_u32 s45, s45, 64553728
    s_cmp_lg_u32 s17, 0
    s_cbranch_scc1 WFok_43
    v_mbcnt_lo_u32_b32 v11, -1, 0
    v_mbcnt_hi_u32_b32 v11, -1, v11
    v_min_u32 v11, 7, v11
    v_mul_u32_u24 v11, 4, v11
WF_42:
    buffer_load_dword v12, v11, s[4:7], s45 offen sc1
    s_waitcnt vmcnt(0)
    v_cmp_eq_u32 vcc, 0, v12
    s_cbranch_vccz WFok_43
    s_sleep 16
    s_sub_u32 s19, s19, 1
    s_cbranch_scc0 WF_42
    s_mov_b32 s19, 0
WFok_43:
    s_barrier
    s_mul_i32 s40, s24, 18
    s_add_u32 s40, s40, s31
    s_lshl_b32 s40, s40, 12
    s_lshl_b32 s41, s21, 8
    s_add_u32 s40, s40, s41
    s_nop 0
    s_add_u32 s40, s40, 88080384
    buffer_load_dwordx4 v[16:19], v1, s[4:7], s40 offen offset:0
    buffer_load_dwordx4 v[48:51], v1, s[4:7], s40 offen offset:1024
    s_add_u32 s40, s40, 4718592
    buffer_load_dwordx4 v[20:23], v1, s[4:7], s40 offen offset:0
    buffer_load_dwordx4 v[52:55], v1, s[4:7], s40 offen offset:1024
    s_add_u32 s40, s40, 4718592
    buffer_load_dwordx4 v[24:27], v1, s[4:7], s40 offen offset:0
    buffer_load_dwordx4 v[56:59], v1, s[4:7], s40 offen offset:1024
    s_add_u32 s40, s40, 4718592
    buffer_load_dwordx4 v[28:31], v1, s[4:7], s40 offen offset:0
    buffer_load_dwordx4 v[60:63], v1, s[4:7], s40 offen offset:1024
    s_add_u32 s40, s40, 4718592
    buffer_load_dwordx4 v[32:35], v1, s[4:7], s40 offen offset:0
    buffer_load_dwordx4 v[64:67], v1, s[4:7], s40 offen offset:1024
    s_add_u32 s40, s40, 4718592
    buffer_load_dwordx4 v[36:39], v1, s[4:7], s40 offen offset:0
    buffer_load_dwordx4 v[68:71], v1, s[4:7], s40 offen offset:1024
    s_add_u32 s40, s40, 4718592
    buffer_load_dwordx4 v[40:43], v1, s[4:7], s40 offen offset:0
    buffer_load_dwordx4 v[72:75], v1, s[4:7], s40 offen offset:1024
    s_add_u32 s40, s40, 4718592
    buffer_load_dwordx4 v[44:47], v1, s[4:7], s40 offen offset:0
    buffer_load_dwordx4 v[76:79], v1, s[4:7], s40 offen offset:1024
    s_lshl_b32 s44, s24, 5
    s_lshl_b32 s41, s21, 4
    s_add_u32 s44, s44, s41
    s_mul_i32 s44, s44, 1152
    s_lshl_b32 s41, s31, 6
    s_add_u32 s44, s44, s41
    buffer_load_dwordx2 v[80:81], v2, s[12:15], s44 offen offset:0
    buffer_load_dwordx2 v[82:83], v2, s[12:15], s44 offen offset:16
    s_cmp_ge_u32 s31, 9
    s_cselect_b32 s41, 2, 0
    s_add_u32 s41, s41, s21
    s_lshl_b32 s41, s41, 7
    s_and_b32 s42, s24, 3
    s_lshl_b32 s42, s42, 9
    s_add_u32 s41, s41, s42
    s_add_u32 s41, s41, 64487936
    s_waitcnt vmcnt(0)
    s_nop 0
    v_pk_add_f32 v[16:17], v[16:17], v[20:21]
    v_pk_add_f32 v[16:17], v[16:17], v[24:25]
    v_pk_add_f32 v[16:17], v[16:17], v[28:29]
    v_pk_add_f32 v[16:17], v[16:17], v[32:33]
    v_pk_add_f32 v[16:17], v[16:17], v[36:37]
    v_pk_add_f32 v[16:17], v[16:17], v[40:41]
    v_pk_add_f32 v[16:17], v[16:17], v[44:45]
    v_pk_add_f32 v[18:19], v[18:19], v[22:23]
    v_pk_add_f32 v[18:19], v[18:19], v[26:27]
    v_pk_add_f32 v[18:19], v[18:19], v[30:31]
    v_pk_add_f32 v[18:19], v[18:19], v[34:35]
    v_pk_add_f32 v[18:19], v[18:19], v[38:39]
    v_pk_add_f32 v[18:19], v[18:19], v[42:43]
    v_pk_add_f32 v[18:19], v[18:19], v[46:47]
    v_pk_add_f32 v[48:49], v[48:49], v[52:53]
    v_pk_add_f32 v[48:49], v[48:49], v[56:57]
    v_pk_add_f32 v[48:49], v[48:49], v[60:61]
    v_pk_add_f32 v[48:49], v[48:49], v[64:65]
    v_pk_add_f32 v[48:49], v[48:49], v[68:69]
    v_pk_add_f32 v[48:49], v[48:49], v[72:73]
    v_pk_add_f32 v[48:49], v[48:49], v[76:77]
    v_pk_add_f32 v[50:51], v[50:51], v[54:55]
    v_pk_add_f32 v[50:51], v[50:51], v[58:59]
    v_pk_add_f32 v[50:51], v[50:51], v[62:63]
    v_pk_add_f32 v[50:51], v[50:51], v[66:67]
    v_pk_add_f32 v[50:51], v[50:51], v[70:71]
    v_pk_add_f32 v[50:51], v[50:51], v[74:75]
    v_pk_add_f32 v[50:51], v[50:51], v[78:79]
    s_cmp_lg_u32 s17, 0
    s_cbranch_scc1 WCok_45
    v_mov_b32_e64 v11, 36
WC_44:
    buffer_load_dword v12, v11, s[8:11], 0 offen sc1
    s_waitcnt vmcnt(0)
    v_and_b32 v12, 0xffff, v12
    v_cmp_le_u32 vcc, 32, v12
    s_cbranch_vccnz WCok_45
    s_sleep 64
    s_sub_u32 s19, s19, 1
    s_cbranch_scc0 WC_44
    s_mov_b32 s19, 0
WCok_45:
    s_barrier
    s_and_b32 s45, s22, 31
    s_lshl_b32 s45, s45, 7
    s_add_u32 s45, s45, 64569344
RD_CW:
    buffer_load_dword v12, off, s[4:7], s45 sc1
    s_waitcnt vmcnt(0)
    v_readfirstlane_b32 s42, v12
    s_nop 3
    s_cmp_ge_u32 s42, s24
    s_cbranch_scc1 RD_CW2
RD_CWS:
    s_sleep 56
    s_add_u32 s42, s42, 1
    s_cmp_lt_u32 s42, s24
    s_cbranch_scc1 RD_CWS
    s_sub_u32 s19, s19, 1
    s_cbranch_scc0 RD_CW
    s_mov_b32 s19, 0
RD_CW2:
RD_poll_46:
    buffer_load_dword v12, v3, s[4:7], s41 offen sc1
    s_waitcnt vmcnt(0)
    v_cmp_ge_u32 vcc, s24, v12
    s_cbranch_vccz RD_go_47
    v_add_u32 v13, 1, v12
    v_cmp_gt_u32 vcc, s24, v12
    s_sleep 4
    s_cbranch_vccz RD_poll_46c
    s_sleep 30
    v_cmp_gt_u32 vcc, s24, v13
    v_add_u32 v13, 3, v12
    s_cbranch_vccz RD_poll_46c
    s_sleep 40
    v_cmp_gt_u32 vcc, s24, v13
    v_add_u32 v13, 7, v12
    s_cbranch_vccz RD_poll_46c
    s_sleep 100
    v_cmp_gt_u32 vcc, s24, v13
    s_cbranch_vccz RD_poll_46c
    s_sleep 127
    s_sleep 127
RD_poll_46c:
    s_sub_u32 s19, s19, 1
    s_cbranch_scc0 RD_poll_46
    s_mov_b32 s19, 0
RD_go_47:
    s_mul_i32 s40, s24, 1152
    s_mul_i32 s41, s21, 18
    s_add_u32 s40, s40, s41
    s_add_u32 s40, s40, s31
    s_lshl_b32 s40, s40, 10
    s_nop 0
    s_add_u32 s40, s40, 134217728
    buffer_load_dwordx4 v[96:99], v0, s[4:7], s40 offen offset:0 sc1
    buffer_load_dwordx4 v[100:103], v0, s[4:7], s40 offen offset:512 sc1
    s_add_u32 s40, s40, 73728
    buffer_load_dwordx4 v[104:107], v0, s[4:7], s40 offen offset:0 sc1
    buffer_load_dwordx4 v[108:111], v0, s[4:7], s40 offen offset:512 sc1
    s_add_u32 s40, s40, 73728
    buffer_load_dwordx4 v[112:115], v0, s[4:7], s40 offen offset:0 sc1
    buffer_load_dwordx4 v[116:119], v0, s[4:7], s40 offen offset:512 sc1
    s_add_u32 s40, s40, 73728
    buffer_load_dwordx4 v[120:123], v0, s[4:7], s40 offen offset:0 sc1
    buffer_load_dwordx4 v[124:127], v0, s[4:7], s40 offen offset:512 sc1
    s_add_u32 s40, s40, 73728
    buffer_load_dwordx4 v[128:131], v0, s[4:7], s40 offen offset:0 sc1
    buffer_load_dwordx4 v[132:135], v0, s[4:7], s40 offen offset:512 sc1
    s_add_u32 s40, s40, 73728
    buffer_load_dwordx4 v[136:139], v0, s[4:7], s40 offen offset:0 sc1
    buffer_load_dwordx4 v[140:143], v0, s[4:7], s40 offen offset:512 sc1
    s_add_u32 s40, s40, 73728
    buffer_load_dwordx4 v[144:147], v0, s[4:7], s40 offen offset:0 sc1
    buffer_load_dwordx4 v[148:151], v0, s[4:7], s40 offen offset:512 sc1
    s_add_u32 s40, s40, 73728
    buffer_load_dwordx4 v[152:155], v0, s[4:7], s40 offen offset:0 sc1
    buffer_load_dwordx4 v[156:159], v0, s[4:7], s40 offen offset:512 sc1
    s_add_u32 s40, s40, 73728
    buffer_load_dwordx4 v[160:163], v0, s[4:7], s40 offen offset:0 sc1
    buffer_load_dwordx4 v[164:167], v0, s[4:7], s40 offen offset:512 sc1
    s_add_u32 s40, s40, 73728
    buffer_load_dwordx4 v[168:171], v0, s[4:7], s40 offen offset:0 sc1
    buffer_load_dwordx4 v[172:175], v0, s[4:7], s40 offen offset:512 sc1
    s_add_u32 s40, s40, 73728
    buffer_load_dwordx4 v[176:179], v0, s[4:7], s40 offen offset:0 sc1
    buffer_load_dwordx4 v[180:183], v0, s[4:7], s40 offen offset:512 sc1
    s_add_u32 s40, s40, 73728
    buffer_load_dwordx4 v[184:187], v0, s[4:7], s40 offen offset:0 sc1
    buffer_load_dwordx4 v[188:191], v0, s[4:7], s40 offen offset:512 sc1
    s_add_u32 s40, s40, 73728
    buffer_load_dwordx4 v[192:195], v0, s[4:7], s40 offen offset:0 sc1
    buffer_load_dwordx4 v[196:199], v0, s[4:7], s40 offen offset:512 sc1
    s_add_u32 s40, s40, 73728
    buffer_load_dwordx4 v[200:203], v0, s[4:7], s40 offen offset:0 sc1
    buffer_load_dwordx4 v[204:207], v0, s[4:7], s40 offen offset:512 sc1
    s_add_u32 s40, s40, 73728
    buffer_load_dwordx4 v[208:211], v0, s[4:7], s40 offen offset:0 sc1
    buffer_load_dwordx4 v[212:215], v0, s[4:7], s40 offen offset:512 sc1
    s_add_u32 s40, s40, 73728
    buffer_load_dwordx4 v[216:219], v0, s[4:7], s40 offen offset:0 sc1
    buffer_load_dwordx4 v[220:223], v0, s[4:7], s40 offen offset:512 sc1
    s_waitcnt vmcnt(30)
    v_mfma_f32_16x16x32_bf16 v[84:87], v[4:7], v[96:99], 0
    v_mfma_f32_16x16x32_bf16 v[88:91], v[4:7], v[100:103], 0
    s_waitcnt vmcnt(28)
    v_mfma_f32_16x16x32_bf16 v[84:87], v[4:7], v[104:107], v[84:87]
    v_mfma_f32_16x16x32_bf16 v[88:91], v[4:7], v[108:111], v[88:91]
    s_waitcnt vmcnt(26)
    v_mfma_f32_16x16x32_bf16 v[84:87], v[4:7], v[112:115], v[84:87]
    v_mfma_f32_16x16x32_bf16 v[88:91], v[4:7], v[116:119], v[88:91]
    s_waitcnt vmcnt(24)
    v_mfma_f32_16x16x32_bf16 v[84:87], v[4:7], v[120:123], v[84:87]
    v_mfma_f32_16x16x32_bf16 v[88:91], v[4:7], v[124:127], v[88:91]
    s_waitcnt vmcnt(22)
    v_mfma_f32_16x16x32_bf16 v[84:87], v[4:7], v[128:131], v[84:87]
    v_mfma_f32_16x16x32_bf16 v[88:91], v[4:7], v[132:135], v[88:91]
    s_waitcnt vmcnt(20)
    v_mfma_f32_16x16x32_bf16 v[84:87], v[4:7], v[136:139], v[84:87]
    v_mfma_f32_16x16x32_bf16 v[88:91], v[4:7], v[140:143], v[88:91]
    s_waitcnt vmcnt(18)
    v_mfma_f32_16x16x32_bf16 v[84:87], v[4:7], v[144:147], v[84:87]
    v_mfma_f32_16x16x32_bf16 v[88:91], v[4:7], v[148:151], v[88:91]
    s_waitcnt vmcnt(16)
    v_mfma_f32_16x16x32_bf16 v[84:87], v[4:7], v[152:155], v[84:87]
    v_mfma_f32_16x16x32_bf16 v[88:91], v[4:7], v[156:159], v[88:91]
    s_waitcnt vmcnt(14)
    v_mfma_f32_16x16x32_bf16 v[84:87], v[4:7], v[160:163], v[84:87]
    v_mfma_f32_16x16x32_bf16 v[88:91], v[4:7], v[164:167], v[88:91]
    s_waitcnt vmcnt(12)
    v_mfma_f32_16x16x32_bf16 v[84:87], v[4:7], v[168:171], v[84:87]
    v_mfma_f32_16x16x32_bf16 v[88:91], v[4:7], v[172:175], v[88:91]
    s_waitcnt vmcnt(10)
    v_mfma_f32_16x16x32_bf16 v[84:87], v[4:7], v[176:179], v[84:87]
    v_mfma_f32_16x16x32_bf16 v[88:91], v[4:7], v[180:183], v[88:91]
    s_waitcnt vmcnt(8)
    v_mfma_f32_16x16x32_bf16 v[84:87], v[4:7], v[184:187], v[84:87]
    v_mfma_f32_16x16x32_bf16 v[88:91], v[4:7], v[188:191], v[88:91]
    s_waitcnt vmcnt(6)
    v_mfma_f32_16x16x32_bf16 v[84:87], v[4:7], v[192:195], v[84:87]
    v_mfma_f32_16x16x32_bf16 v[88:91], v[4:7], v[196:199], v[88:91]
    s_waitcnt vmcnt(4)
    v_mfma_f32_16x16x32_bf16 v[84:87], v[4:7], v[200:203], v[84:87]
    v_mfma_f32_16x16x32_bf16 v[88:91], v[4:7], v[204:207], v[88:91]
    s_waitcnt vmcnt(2)
    v_mfma_f32_16x16x32_bf16 v[84:87], v[4:7], v[208:211], v[84:87]
    v_mfma_f32_16x16x32_bf16 v[88:91], v[4:7], v[212:215], v[88:91]
    s_waitcnt vmcnt(0)
    v_mfma_f32_16x16x32_bf16 v[84:87], v[4:7], v[216:219], v[84:87]
    v_mfma_f32_16x16x32_bf16 v[88:91], v[4:7], v[220:223], v[88:91]
    v_cvt_pk_bf16_f32 v20, v16, v17
    v_cvt_pk_bf16_f32 v21, v18, v19
    v_lshlrev_b32_e64 v16, 16, v20
    v_and_b32 v17, 0xffff0000, v20
    v_lshlrev_b32_e64 v18, 16, v21
    v_and_b32 v19, 0xffff0000, v21
    v_lshlrev_b32_e64 v24, 16, v80
    v_and_b32 v25, 0xffff0000, v80
    v_lshlrev_b32_e64 v26, 16, v81
    v_and_b32 v27, 0xffff0000, v81
    v_cvt_pk_bf16_f32 v52, v48, v49
    v_cvt_pk_bf16_f32 v53, v50, v51
    v_lshlrev_b32_e64 v48, 16, v52
    v_and_b32 v49, 0xffff0000, v52
    v_lshlrev_b32_e64 v50, 16, v53
    v_and_b32 v51, 0xffff0000, v53
    v_lshlrev_b32_e64 v56, 16, v82
    v_and_b32 v57, 0xffff0000, v82
    v_lshlrev_b32_e64 v58, 16, v83
    v_and_b32 v59, 0xffff0000, v83
    v_cvt_pk_bf16_f32 v20, v84, v85
    v_cvt_pk_bf16_f32 v21, v86, v87
    v_lshlrev_b32_e64 v84, 16, v20
    v_and_b32 v85, 0xffff0000, v20
    v_lshlrev_b32_e64 v86, 16, v21
    v_and_b32 v87, 0xffff0000, v21
    v_pk_add_f32 v[84:85], v[84:85], v[24:25]
    v_pk_add_f32 v[86:87], v[86:87], v[26:27]
    v_cvt_pk_bf16_f32 v20, v84, v85
    v_cvt_pk_bf16_f32 v21, v86, v87
    v_lshlrev_b32_e64 v84, 16, v20
    v_and_b32 v85, 0xffff0000, v20
    v_lshlrev_b32_e64 v86, 16, v21
    v_and_b32 v87, 0xffff0000, v21
    v_pk_add_f32 v[84:85], v[84:85], v[16:17]
    v_pk_add_f32 v[86:87], v[86:87], v[18:19]
    v_cvt_pk_bf16_f32 v20, v84, v85
    v_cvt_pk_bf16_f32 v21, v86, v87
    buffer_store_dwordx2 v[20:21], v2, s[60:63], s44 offen offset:0
    v_cvt_pk_bf16_f32 v52, v88, v89
    v_cvt_pk_bf16_f32 v53, v90, v91
    v_lshlrev_b32_e64 v88, 16, v52
    v_and_b32 v89, 0xffff0000, v52
    v_lshlrev_b32_e64 v90, 16, v53
    v_and_b32 v91, 0xffff0000, v53
    v_pk_add_f32 v[88:89], v[88:89], v[56:57]
    v_pk_add_f32 v[90:91], v[90:91], v[58:59]
    v_cvt_pk_bf16_f32 v52, v88, v89
    v_cvt_pk_bf16_f32 v53, v90, v91
    v_lshlrev_b32_e64 v88, 16, v52
    v_and_b32 v89, 0xffff0000, v52
    v_lshlrev_b32_e64 v90, 16, v53
    v_and_b32 v91, 0xffff0000, v53
    v_pk_add_f32 v[88:89], v[88:89], v[48:49]
    v_pk_add_f32 v[90:91], v[90:91], v[50:51]
    v_cvt_pk_bf16_f32 v52, v88, v89
    v_cvt_pk_bf16_f32 v53, v90, v91
    buffer_store_dwordx2 v[52:53], v2, s[60:63], s44 offen offset:16
    s_branch NEXT
DO_LN:
    s_load_dwordx2 s[12:13], s[0:1], 0
    s_waitcnt lgkmcnt(0)
    s_and_b32 s13, s13, 0xffff
    s_mov_b32 s14, 2359296
    s_mov_b32 s15, 0x00020000
    v_mbcnt_lo_u32_b32 v1, -1, 0
    v_mbcnt_hi_u32_b32 v1, -1, v1
    v_and_b32 v2, 7, v1
    v_lshrrev_b32 v3, 3, v1
    s_lshl_b32 s40, s17, 3
    v_add_u32 v3, s40, v3
    v_mul_u32_u24 v4, 1152, v3
    v_lshl_add_u32 v4, v2, 4, v4
    v_lshlrev_b32_e64 v5, 9, v2
    v_lshl_add_u32 v5, v3, 4, v5
    s_mul_i32 s40, s22, 36864
    s_mul_i32 s41, s22, 36864
    s_add_u32 s41, s41, 0
    s_nop 0
    buffer_load_dwordx4 v[8:11], v4, s[12:15], s40 offen offset:0
    buffer_load_dwordx4 v[12:15], v4, s[12:15], s40 offen offset:128
    buffer_load_dwordx4 v[16:19], v4, s[12:15], s40 offen offset:256
    buffer_load_dwordx4 v[20:23], v4, s[12:15], s40 offen offset:384
    buffer_load_dwordx4 v[24:27], v4, s[12:15], s40 offen offset:512
    buffer_load_dwordx4 v[28:31], v4, s[12:15], s40 offen offset:640
    buffer_load_dwordx4 v[32:35], v4, s[12:15], s40 offen offset:768
    buffer_load_dwordx4 v[36:39], v4, s[12:15], s40 offen offset:896
    buffer_load_dwordx4 v[40:43], v4, s[12:15], s40 offen offset:1024
    s_or_b32 s42, s22, s17
    s_cmp_lg_u32 s42, 0
    s_cbranch_scc1 LNz_48
    v_mov_b32 v6, 0
    v_mov_b32 v7, 0
    v_lshlrev_b32 v120, 3, v1
    s_mov_b32 s42, 64487936
    s_mov_b32 s43, 64492032
    buffer_store_dwordx2 v[6:7], v120, s[4:7], s42 offen offset:0 sc1
    buffer_store_dwordx2 v[6:7], v120, s[4:7], s43 offen offset:0 sc1
    buffer_store_dwordx2 v[6:7], v120, s[4:7], s42 offen offset:512 sc1
    buffer_store_dwordx2 v[6:7], v120, s[4:7], s43 offen offset:512 sc1
    buffer_store_dwordx2 v[6:7], v120, s[4:7], s42 offen offset:1024 sc1
    buffer_store_dwordx2 v[6:7], v120, s[4:7], s43 offen offset:1024 sc1
    buffer_store_dwordx2 v[6:7], v120, s[4:7], s42 offen offset:1536 sc1
    buffer_store_dwordx2 v[6:7], v120, s[4:7], s43 offen offset:1536 sc1
    buffer_store_dwordx2 v[6:7], v120, s[4:7], s42 offen offset:2048 sc1
    buffer_store_dwordx2 v[6:7], v120, s[4:7], s43 offen offset:2048 sc1
    buffer_store_dwordx2 v[6:7], v120, s[4:7], s42 offen offset:2560 sc1
    buffer_store_dwordx2 v[6:7], v120, s[4:7], s43 offen offset:2560 sc1
    buffer_store_dwordx2 v[6:7], v120, s[4:7], s42 offen offset:3072 sc1
    buffer_store_dwordx2 v[6:7], v120, s[4:7], s43 offen offset:3072 sc1
    buffer_store_dwordx2 v[6:7], v120, s[4:7], s42 offen offset:3584 sc1
    buffer_store_dwordx2 v[6:7], v120, s[4:7], s43 offen offset:3584 sc1
    s_mov_b32 s42, 64561152
    buffer_store_dwordx2 v[6:7], v120, s[4:7], s42 offen sc1
    s_waitcnt vmcnt(0)
    v_mov_b32 v120, 48
    v_mov_b32 v6, 1
    s_mov_b64 exec, 1
    buffer_atomic_add v6, v120, s[8:11], 0 offen
    s_mov_b64 exec, -1
LNz_48:
    s_and_b32 s42, s22, 7
    s_or_b32 s42, s42, s17
    s_cmp_lg_u32 s42, 0
    s_cbranch_scc1 LNf_49
    v_mov_b32 v120, 0
    v_mov_b32 v121, 0
    v_mov_b32 v122, 0
    v_mov_b32 v123, 0
    v_lshlrev_b32 v6, 4, v1
    s_lshl_b32 s42, s22, 7
    s_add_u32 s42, s42, 64552960
    buffer_store_dwordx4 v[120:123], v6, s[4:7], s42 offen sc1
    s_nop 1
LNf_49:
    v_mov_b32 v120, 0
    v_mov_b32 v121, 0
    v_mov_b32 v122, 0
    v_mov_b32 v123, 0
    s_waitcnt vmcnt(0)
    v_lshlrev_b32 v48, 16, v8
    v_and_b32 v49, 0xffff0000, v8
    v_pk_add_f32 v[120:121], v[120:121], v[48:49]
    v_lshlrev_b32_e64 v50, 16, v9
    v_and_b32 v51, 0xffff0000, v9
    v_pk_add_f32 v[122:123], v[122:123], v[50:51]
    v_lshlrev_b32_e64 v52, 16, v10
    v_and_b32 v53, 0xffff0000, v10
    v_pk_add_f32 v[120:121], v[120:121], v[52:53]
    v_lshlrev_b32_e64 v54, 16, v11
    v_and_b32 v55, 0xffff0000, v11
    v_pk_add_f32 v[122:123], v[122:123], v[54:55]
    v_lshlrev_b32_e64 v56, 16, v12
    v_and_b32 v57, 0xffff0000, v12
    v_pk_add_f32 v[120:121], v[120:121], v[56:57]
    v_lshlrev_b32_e64 v58, 16, v13
    v_and_b32 v59, 0xffff0000, v13
    v_pk_add_f32 v[122:123], v[122:123], v[58:59]
    v_lshlrev_b32_e64 v60, 16, v14
    v_and_b32 v61, 0xffff0000, v14
    v_pk_add_f32 v[120:121], v[120:121], v[60:61]
    v_lshlrev_b32_e64 v62, 16, v15
    v_and_b32 v63, 0xffff0000, v15
    v_pk_add_f32 v[122:123], v[122:123], v[62:63]
    v_lshlrev_b32_e64 v64, 16, v16
    v_and_b32 v65, 0xffff0000, v16
    v_pk_add_f32 v[120:121], v[120:121], v[64:65]
    v_lshlrev_b32_e64 v66, 16, v17
    v_and_b32 v67, 0xffff0000, v17
    v_pk_add_f32 v[122:123], v[122:123], v[66:67]
    v_lshlrev_b32_e64 v68, 16, v18
    v_and_b32 v69, 0xffff0000, v18
    v_pk_add_f32 v[120:121], v[120:121], v[68:69]
    v_lshlrev_b32_e64 v70, 16, v19
    v_and_b32 v71, 0xffff0000, v19
    v_pk_add_f32 v[122:123], v[122:123], v[70:71]
    v_lshlrev_b32_e64 v72, 16, v20
    v_and_b32 v73, 0xffff0000, v20
    v_pk_add_f32 v[120:121], v[120:121], v[72:73]
    v_lshlrev_b32_e64 v74, 16, v21
    v_and_b32 v75, 0xffff0000, v21
    v_pk_add_f32 v[122:123], v[122:123], v[74:75]
    v_lshlrev_b32_e64 v76, 16, v22
    v_and_b32 v77, 0xffff0000, v22
    v_pk_add_f32 v[120:121], v[120:121], v[76:77]
    v_lshlrev_b32_e64 v78, 16, v23
    v_and_b32 v79, 0xffff0000, v23
    v_pk_add_f32 v[122:123], v[122:123], v[78:79]
    v_lshlrev_b32_e64 v80, 16, v24
    v_and_b32 v81, 0xffff0000, v24
    v_pk_add_f32 v[120:121], v[120:121], v[80:81]
    v_lshlrev_b32_e64 v82, 16, v25
    v_and_b32 v83, 0xffff0000, v25
    v_pk_add_f32 v[122:123], v[122:123], v[82:83]
    v_lshlrev_b32_e64 v84, 16, v26
    v_and_b32 v85, 0xffff0000, v26
    v_pk_add_f32 v[120:121], v[120:121], v[84:85]
    v_lshlrev_b32_e64 v86, 16, v27
    v_and_b32 v87, 0xffff0000, v27
    v_pk_add_f32 v[122:123], v[122:123], v[86:87]
    v_lshlrev_b32_e64 v88, 16, v28
    v_and_b32 v89, 0xffff0000, v28
    v_pk_add_f32 v[120:121], v[120:121], v[88:89]
    v_lshlrev_b32_e64 v90, 16, v29
    v_and_b32 v91, 0xffff0000, v29
    v_pk_add_f32 v[122:123], v[122:123], v[90:91]
    v_lshlrev_b32_e64 v92, 16, v30
    v_and_b32 v93, 0xffff0000, v30
    v_pk_add_f32 v[120:121], v[120:121], v[92:93]
    v_lshlrev_b32_e64 v94, 16, v31
    v_and_b32 v95, 0xffff0000, v31
    v_pk_add_f32 v[122:123], v[122:123], v[94:95]
    v_lshlrev_b32_e64 v96, 16, v32
    v_and_b32 v97, 0xffff0000, v32
    v_pk_add_f32 v[120:121], v[120:121], v[96:97]
    v_lshlrev_b32_e64 v98, 16, v33
    v_and_b32 v99, 0xffff0000, v33
    v_pk_add_f32 v[122:123], v[122:123], v[98:99]
    v_lshlrev_b32_e64 v100, 16, v34
    v_and_b32 v101, 0xffff0000, v34
    v_pk_add_f32 v[120:121], v[120:121], v[100:101]
    v_lshlrev_b32_e64 v102, 16, v35
    v_and_b32 v103, 0xffff0000, v35
    v_pk_add_f32 v[122:123], v[122:123], v[102:103]
    v_lshlrev_b32_e64 v104, 16, v36
    v_and_b32 v105, 0xffff0000, v36
    v_pk_add_f32 v[120:121], v[120:121], v[104:105]
    v_lshlrev_b32_e64 v106, 16, v37
    v_and_b32 v107, 0xffff0000, v37
    v_pk_add_f32 v[122:123], v[122:123], v[106:107]
    v_lshlrev_b32_e64 v108, 16, v38
    v_and_b32 v109, 0xffff0000, v38
    v_pk_add_f32 v[120:121], v[120:121], v[108:109]
    v_lshlrev_b32_e64 v110, 16, v39
    v_and_b32 v111, 0xffff0000, v39
    v_pk_add_f32 v[122:123], v[122:123], v[110:111]
    v_lshlrev_b32_e64 v112, 16, v40
    v_and_b32 v113, 0xffff0000, v40
    v_pk_add_f32 v[120:121], v[120:121], v[112:113]
    v_lshlrev_b32_e64 v114, 16, v41
    v_and_b32 v115, 0xffff0000, v41
    v_pk_add_f32 v[122:123], v[122:123], v[114:115]
    v_lshlrev_b32_e64 v116, 16, v42
    v_and_b32 v117, 0xffff0000, v42
    v_pk_add_f32 v[120:121], v[120:121], v[116:117]
    v_lshlrev_b32_e64 v118, 16, v43
    v_and_b32 v119, 0xffff0000, v43
    v_pk_add_f32 v[122:123], v[122:123], v[118:119]
    v_pk_add_f32 v[120:121], v[120:121], v[122:123]
    v_add_f32 v124, v120, v121
    s_nop 1
    v_add_f32_dpp v124, v124, v124 quad_perm:[1,0,3,2] row_mask:0xf bank_mask:0xf
    s_nop 1
    v_add_f32_dpp v124, v124, v124 quad_perm:[2,3,0,1] row_mask:0xf bank_mask:0xf
    s_nop 1
    v_add_f32_dpp v124, v124, v124 row_half_mirror row_mask:0xf bank_mask:0xf
    v_mul_f32 v124, 0x3ae38e39, v124
    v_sub_f32 v128, 0, v124
    v_mov_b32 v129, v128
    v_mov_b32 v120, 0
    v_mov_b32 v121, 0
    v_mov_b32 v122, 0
    v_mov_b32 v123, 0
    v_pk_add_f32 v[130:131], v[48:49], v[128:129]
    v_pk_fma_f32 v[120:121], v[130:131], v[130:131], v[120:121]
    v_pk_add_f32 v[132:133], v[50:51], v[128:129]
    v_pk_fma_f32 v[122:123], v[132:133], v[132:133], v[122:123]
    v_pk_add_f32 v[130:131], v[52:53], v[128:129]
    v_pk_fma_f32 v[120:121], v[130:131], v[130:131], v[120:121]
    v_pk_add_f32 v[132:133], v[54:55], v[128:129]
    v_pk_fma_f32 v[122:123], v[132:133], v[132:133], v[122:123]
    v_pk_add_f32 v[130:131], v[56:57], v[128:129]
    v_pk_fma_f32 v[120:121], v[130:131], v[130:131], v[120:121]
    v_pk_add_f32 v[132:133], v[58:59], v[128:129]
    v_pk_fma_f32 v[122:123], v[132:133], v[132:133], v[122:123]
    v_pk_add_f32 v[130:131], v[60:61], v[128:129]
    v_pk_fma_f32 v[120:121], v[130:131], v[130:131], v[120:121]
    v_pk_add_f32 v[132:133], v[62:63], v[128:129]
    v_pk_fma_f32 v[122:123], v[132:133], v[132:133], v[122:123]
    v_pk_add_f32 v[130:131], v[64:65], v[128:129]
    v_pk_fma_f32 v[120:121], v[130:131], v[130:131], v[120:121]
    v_pk_add_f32 v[132:133], v[66:67], v[128:129]
    v_pk_fma_f32 v[122:123], v[132:133], v[132:133], v[122:123]
    v_pk_add_f32 v[130:131], v[68:69], v[128:129]
    v_pk_fma_f32 v[120:121], v[130:131], v[130:131], v[120:121]
    v_pk_add_f32 v[132:133], v[70:71], v[128:129]
    v_pk_fma_f32 v[122:123], v[132:133], v[132:133], v[122:123]
    v_pk_add_f32 v[130:131], v[72:73], v[128:129]
    v_pk_fma_f32 v[120:121], v[130:131], v[130:131], v[120:121]
    v_pk_add_f32 v[132:133], v[74:75], v[128:129]
    v_pk_fma_f32 v[122:123], v[132:133], v[132:133], v[122:123]
    v_pk_add_f32 v[130:131], v[76:77], v[128:129]
    v_pk_fma_f32 v[120:121], v[130:131], v[130:131], v[120:121]
    v_pk_add_f32 v[132:133], v[78:79], v[128:129]
    v_pk_fma_f32 v[122:123], v[132:133], v[132:133], v[122:123]
    v_pk_add_f32 v[130:131], v[80:81], v[128:129]
    v_pk_fma_f32 v[120:121], v[130:131], v[130:131], v[120:121]
    v_pk_add_f32 v[132:133], v[82:83], v[128:129]
    v_pk_fma_f32 v[122:123], v[132:133], v[132:133], v[122:123]
    v_pk_add_f32 v[130:131], v[84:85], v[128:129]
    v_pk_fma_f32 v[120:121], v[130:131], v[130:131], v[120:121]
    v_pk_add_f32 v[132:133], v[86:87], v[128:129]
    v_pk_fma_f32 v[122:123], v[132:133], v[132:133], v[122:123]
    v_pk_add_f32 v[130:131], v[88:89], v[128:129]
    v_pk_fma_f32 v[120:121], v[130:131], v[130:131], v[120:121]
    v_pk_add_f32 v[132:133], v[90:91], v[128:129]
    v_pk_fma_f32 v[122:123], v[132:133], v[132:133], v[122:123]
    v_pk_add_f32 v[130:131], v[92:93], v[128:129]
    v_pk_fma_f32 v[120:121], v[130:131], v[130:131], v[120:121]
    v_pk_add_f32 v[132:133], v[94:95], v[128:129]
    v_pk_fma_f32 v[122:123], v[132:133], v[132:133], v[122:123]
    v_pk_add_f32 v[130:131], v[96:97], v[128:129]
    v_pk_fma_f32 v[120:121], v[130:131], v[130:131], v[120:121]
    v_pk_add_f32 v[132:133], v[98:99], v[128:129]
    v_pk_fma_f32 v[122:123], v[132:133], v[132:133], v[122:123]
    v_pk_add_f32 v[130:131], v[100:101], v[128:129]
    v_pk_fma_f32 v[120:121], v[130:131], v[130:131], v[120:121]
    v_pk_add_f32 v[132:133], v[102:103], v[128:129]
    v_pk_fma_f32 v[122:123], v[132:133], v[132:133], v[122:123]
    v_pk_add_f32 v[130:131], v[104:105], v[128:129]
    v_pk_fma_f32 v[120:121], v[130:131], v[130:131], v[120:121]
    v_pk_add_f32 v[132:133], v[106:107], v[128:129]
    v_pk_fma_f32 v[122:123], v[132:133], v[132:133], v[122:123]
    v_pk_add_f32 v[130:131], v[108:109], v[128:129]
    v_pk_fma_f32 v[120:121], v[130:131], v[130:131], v[120:121]
    v_pk_add_f32 v[132:133], v[110:111], v[128:129]
    v_pk_fma_f32 v[122:123], v[132:133], v[132:133], v[122:123]
    v_pk_add_f32 v[130:131], v[112:113], v[128:129]
    v_pk_fma_f32 v[120:121], v[130:131], v[130:131], v[120:121]
    v_pk_add_f32 v[132:133], v[114:115], v[128:129]
    v_pk_fma_f32 v[122:123], v[132:133], v[132:133], v[122:123]
    v_pk_add_f32 v[130:131], v[116:117], v[128:129]
    v_pk_fma_f32 v[120:121], v[130:131], v[130:131], v[120:121]
    v_pk_add_f32 v[132:133], v[118:119], v[128:129]
    v_pk_fma_f32 v[122:123], v[132:133], v[132:133], v[122:123]
    v_pk_add_f32 v[120:121], v[120:121], v[122:123]
    v_add_f32 v126, v120, v121
    s_nop 1
    v_add_f32_dpp v126, v126, v126 quad_perm:[1,0,3,2] row_mask:0xf bank_mask:0xf
    s_nop 1
    v_add_f32_dpp v126, v126, v126 quad_perm:[2,3,0,1] row_mask:0xf bank_mask:0xf
    s_nop 1
    v_add_f32_dpp v126, v126, v126 row_half_mirror row_mask:0xf bank_mask:0xf
    v_mul_f32 v126, 0x3ae38e39, v126
    v_cvt_pk_bf16_f32 v124, v124, v126
    v_and_b32 v126, 0xffff0000, v124
    v_lshlrev_b32_e64 v124, 16, v124
    v_add_f32 v126, 0x3727c5ac, v126
    v_cvt_pk_bf16_f32 v126, v126, v126
    v_lshlrev_b32 v126, 16, v126
    v_sqrt_f32 v126, v126
    s_nop 0
    v_cvt_pk_bf16_f32 v126, v126, v126
    v_lshlrev_b32 v126, 16, v126
    v_rcp_f32 v126, v126
    v_sub_f32 v128, 0, v124
    v_mov_b32 v129, v128
    v_mov_b32 v127, v126
    v_pk_add_f32 v[48:49], v[48:49], v[128:129]
    v_cvt_pk_bf16_f32 v8, v48, v49
    v_lshlrev_b32_e64 v48, 16, v8
    v_and_b32 v49, 0xffff0000, v8
    v_pk_mul_f32 v[48:49], v[48:49], v[126:127]
    v_cvt_pk_bf16_f32 v8, v48, v49
    v_pk_add_f32 v[50:51], v[50:51], v[128:129]
    v_cvt_pk_bf16_f32 v9, v50, v51
    v_lshlrev_b32_e64 v50, 16, v9
    v_and_b32 v51, 0xffff0000, v9
    v_pk_mul_f32 v[50:51], v[50:51], v[126:127]
    v_cvt_pk_bf16_f32 v9, v50, v51
    v_pk_add_f32 v[52:53], v[52:53], v[128:129]
    v_cvt_pk_bf16_f32 v10, v52, v53
    v_lshlrev_b32_e64 v52, 16, v10
    v_and_b32 v53, 0xffff0000, v10
    v_pk_mul_f32 v[52:53], v[52:53], v[126:127]
    v_cvt_pk_bf16_f32 v10, v52, v53
    v_pk_add_f32 v[54:55], v[54:55], v[128:129]
    v_cvt_pk_bf16_f32 v11, v54, v55
    v_lshlrev_b32_e64 v54, 16, v11
    v_and_b32 v55, 0xffff0000, v11
    v_pk_mul_f32 v[54:55], v[54:55], v[126:127]
    v_cvt_pk_bf16_f32 v11, v54, v55
    buffer_store_dwordx4 v[8:11], v5, s[4:7], s41 offen sc1
    s_add_u32 s41, s41, 4096
    v_pk_add_f32 v[56:57], v[56:57], v[128:129]
    v_cvt_pk_bf16_f32 v12, v56, v57
    v_lshlrev_b32_e64 v56, 16, v12
    v_and_b32 v57, 0xffff0000, v12
    v_pk_mul_f32 v[56:57], v[56:57], v[126:127]
    v_cvt_pk_bf16_f32 v12, v56, v57
    v_pk_add_f32 v[58:59], v[58:59], v[128:129]
    v_cvt_pk_bf16_f32 v13, v58, v59
    v_lshlrev_b32_e64 v58, 16, v13
    v_and_b32 v59, 0xffff0000, v13
    v_pk_mul_f32 v[58:59], v[58:59], v[126:127]
    v_cvt_pk_bf16_f32 v13, v58, v59
    v_pk_add_f32 v[60:61], v[60:61], v[128:129]
    v_cvt_pk_bf16_f32 v14, v60, v61
    v_lshlrev_b32_e64 v60, 16, v14
    v_and_b32 v61, 0xffff0000, v14
    v_pk_mul_f32 v[60:61], v[60:61], v[126:127]
    v_cvt_pk_bf16_f32 v14, v60, v61
    v_pk_add_f32 v[62:63], v[62:63], v[128:129]
    v_cvt_pk_bf16_f32 v15, v62, v63
    v_lshlrev_b32_e64 v62, 16, v15
    v_and_b32 v63, 0xffff0000, v15
    v_pk_mul_f32 v[62:63], v[62:63], v[126:127]
    v_cvt_pk_bf16_f32 v15, v62, v63
    buffer_store_dwordx4 v[12:15], v5, s[4:7], s41 offen sc1
    s_add_u32 s41, s41, 4096
    v_pk_add_f32 v[64:65], v[64:65], v[128:129]
    v_cvt_pk_bf16_f32 v16, v64, v65
    v_lshlrev_b32_e64 v64, 16, v16
    v_and_b32 v65, 0xffff0000, v16
    v_pk_mul_f32 v[64:65], v[64:65], v[126:127]
    v_cvt_pk_bf16_f32 v16, v64, v65
    v_pk_add_f32 v[66:67], v[66:67], v[128:129]
    v_cvt_pk_bf16_f32 v17, v66, v67
    v_lshlrev_b32_e64 v66, 16, v17
    v_and_b32 v67, 0xffff0000, v17
    v_pk_mul_f32 v[66:67], v[66:67], v[126:127]
    v_cvt_pk_bf16_f32 v17, v66, v67
    v_pk_add_f32 v[68:69], v[68:69], v[128:129]
    v_cvt_pk_bf16_f32 v18, v68, v69
    v_lshlrev_b32_e64 v68, 16, v18
    v_and_b32 v69, 0xffff0000, v18
    v_pk_mul_f32 v[68:69], v[68:69], v[126:127]
    v_cvt_pk_bf16_f32 v18, v68, v69
    v_pk_add_f32 v[70:71], v[70:71], v[128:129]
    v_cvt_pk_bf16_f32 v19, v70, v71
    v_lshlrev_b32_e64 v70, 16, v19
    v_and_b32 v71, 0xffff0000, v19
    v_pk_mul_f32 v[70:71], v[70:71], v[126:127]
    v_cvt_pk_bf16_f32 v19, v70, v71
    buffer_store_dwordx4 v[16:19], v5, s[4:7], s41 offen sc1
    s_add_u32 s41, s41, 4096
    v_pk_add_f32 v[72:73], v[72:73], v[128:129]
    v_cvt_pk_bf16_f32 v20, v72, v73
    v_lshlrev_b32_e64 v72, 16, v20
    v_and_b32 v73, 0xffff0000, v20
    v_pk_mul_f32 v[72:73], v[72:73], v[126:127]
    v_cvt_pk_bf16_f32 v20, v72, v73
    v_pk_add_f32 v[74:75], v[74:75], v[128:129]
    v_cvt_pk_bf16_f32 v21, v74, v75
    v_lshlrev_b32_e64 v74, 16, v21
    v_and_b32 v75, 0xffff0000, v21
    v_pk_mul_f32 v[74:75], v[74:75], v[126:127]
    v_cvt_pk_bf16_f32 v21, v74, v75
    v_pk_add_f32 v[76:77], v[76:77], v[128:129]
    v_cvt_pk_bf16_f32 v22, v76, v77
    v_lshlrev_b32_e64 v76, 16, v22
    v_and_b32 v77, 0xffff0000, v22
    v_pk_mul_f32 v[76:77], v[76:77], v[126:127]
    v_cvt_pk_bf16_f32 v22, v76, v77
    v_pk_add_f32 v[78:79], v[78:79], v[128:129]
    v_cvt_pk_bf16_f32 v23, v78, v79
    v_lshlrev_b32_e64 v78, 16, v23
    v_and_b32 v79, 0xffff0000, v23
    v_pk_mul_f32 v[78:79], v[78:79], v[126:127]
    v_cvt_pk_bf16_f32 v23, v78, v79
    buffer_store_dwordx4 v[20:23], v5, s[4:7], s41 offen sc1
    s_add_u32 s41, s41, 4096
    v_pk_add_f32 v[80:81], v[80:81], v[128:129]
    v_cvt_pk_bf16_f32 v24, v80, v81
    v_lshlrev_b32_e64 v80, 16, v24
    v_and_b32 v81, 0xffff0000, v24
    v_pk_mul_f32 v[80:81], v[80:81], v[126:127]
    v_cvt_pk_bf16_f32 v24, v80, v81
    v_pk_add_f32 v[82:83], v[82:83], v[128:129]
    v_cvt_pk_bf16_f32 v25, v82, v83
    v_lshlrev_b32_e64 v82, 16, v25
    v_and_b32 v83, 0xffff0000, v25
    v_pk_mul_f32 v[82:83], v[82:83], v[126:127]
    v_cvt_pk_bf16_f32 v25, v82, v83
    v_pk_add_f32 v[84:85], v[84:85], v[128:129]
    v_cvt_pk_bf16_f32 v26, v84, v85
    v_lshlrev_b32_e64 v84, 16, v26
    v_and_b32 v85, 0xffff0000, v26
    v_pk_mul_f32 v[84:85], v[84:85], v[126:127]
    v_cvt_pk_bf16_f32 v26, v84, v85
    v_pk_add_f32 v[86:87], v[86:87], v[128:129]
    v_cvt_pk_bf16_f32 v27, v86, v87
    v_lshlrev_b32_e64 v86, 16, v27
    v_and_b32 v87, 0xffff0000, v27
    v_pk_mul_f32 v[86:87], v[86:87], v[126:127]
    v_cvt_pk_bf16_f32 v27, v86, v87
    buffer_store_dwordx4 v[24:27], v5, s[4:7], s41 offen sc1
    s_add_u32 s41, s41, 4096
    v_pk_add_f32 v[88:89], v[88:89], v[128:129]
    v_cvt_pk_bf16_f32 v28, v88, v89
    v_lshlrev_b32_e64 v88, 16, v28
    v_and_b32 v89, 0xffff0000, v28
    v_pk_mul_f32 v[88:89], v[88:89], v[126:127]
    v_cvt_pk_bf16_f32 v28, v88, v89
    v_pk_add_f32 v[90:91], v[90:91], v[128:129]
    v_cvt_pk_bf16_f32 v29, v90, v91
    v_lshlrev_b32_e64 v90, 16, v29
    v_and_b32 v91, 0xffff0000, v29
    v_pk_mul_f32 v[90:91], v[90:91], v[126:127]
    v_cvt_pk_bf16_f32 v29, v90, v91
    v_pk_add_f32 v[92:93], v[92:93], v[128:129]
    v_cvt_pk_bf16_f32 v30, v92, v93
    v_lshlrev_b32_e64 v92, 16, v30
    v_and_b32 v93, 0xffff0000, v30
    v_pk_mul_f32 v[92:93], v[92:93], v[126:127]
    v_cvt_pk_bf16_f32 v30, v92, v93
    v_pk_add_f32 v[94:95], v[94:95], v[128:129]
    v_cvt_pk_bf16_f32 v31, v94, v95
    v_lshlrev_b32_e64 v94, 16, v31
    v_and_b32 v95, 0xffff0000, v31
    v_pk_mul_f32 v[94:95], v[94:95], v[126:127]
    v_cvt_pk_bf16_f32 v31, v94, v95
    buffer_store_dwordx4 v[28:31], v5, s[4:7], s41 offen sc1
    s_add_u32 s41, s41, 4096
    v_pk_add_f32 v[96:97], v[96:97], v[128:129]
    v_cvt_pk_bf16_f32 v32, v96, v97
    v_lshlrev_b32_e64 v96, 16, v32
    v_and_b32 v97, 0xffff0000, v32
    v_pk_mul_f32 v[96:97], v[96:97], v[126:127]
    v_cvt_pk_bf16_f32 v32, v96, v97
    v_pk_add_f32 v[98:99], v[98:99], v[128:129]
    v_cvt_pk_bf16_f32 v33, v98, v99
    v_lshlrev_b32_e64 v98, 16, v33
    v_and_b32 v99, 0xffff0000, v33
    v_pk_mul_f32 v[98:99], v[98:99], v[126:127]
    v_cvt_pk_bf16_f32 v33, v98, v99
    v_pk_add_f32 v[100:101], v[100:101], v[128:129]
    v_cvt_pk_bf16_f32 v34, v100, v101
    v_lshlrev_b32_e64 v100, 16, v34
    v_and_b32 v101, 0xffff0000, v34
    v_pk_mul_f32 v[100:101], v[100:101], v[126:127]
    v_cvt_pk_bf16_f32 v34, v100, v101
    v_pk_add_f32 v[102:103], v[102:103], v[128:129]
    v_cvt_pk_bf16_f32 v35, v102, v103
    v_lshlrev_b32_e64 v102, 16, v35
    v_and_b32 v103, 0xffff0000, v35
    v_pk_mul_f32 v[102:103], v[102:103], v[126:127]
    v_cvt_pk_bf16_f32 v35, v102, v103
    buffer_store_dwordx4 v[32:35], v5, s[4:7], s41 offen sc1
    s_add_u32 s41, s41, 4096
    v_pk_add_f32 v[104:105], v[104:105], v[128:129]
    v_cvt_pk_bf16_f32 v36, v104, v105
    v_lshlrev_b32_e64 v104, 16, v36
    v_and_b32 v105, 0xffff0000, v36
    v_pk_mul_f32 v[104:105], v[104:105], v[126:127]
    v_cvt_pk_bf16_f32 v36, v104, v105
    v_pk_add_f32 v[106:107], v[106:107], v[128:129]
    v_cvt_pk_bf16_f32 v37, v106, v107
    v_lshlrev_b32_e64 v106, 16, v37
    v_and_b32 v107, 0xffff0000, v37
    v_pk_mul_f32 v[106:107], v[106:107], v[126:127]
    v_cvt_pk_bf16_f32 v37, v106, v107
    v_pk_add_f32 v[108:109], v[108:109], v[128:129]
    v_cvt_pk_bf16_f32 v38, v108, v109
    v_lshlrev_b32_e64 v108, 16, v38
    v_and_b32 v109, 0xffff0000, v38
    v_pk_mul_f32 v[108:109], v[108:109], v[126:127]
    v_cvt_pk_bf16_f32 v38, v108, v109
    v_pk_add_f32 v[110:111], v[110:111], v[128:129]
    v_cvt_pk_bf16_f32 v39, v110, v111
    v_lshlrev_b32_e64 v110, 16, v39
    v_and_b32 v111, 0xffff0000, v39
    v_pk_mul_f32 v[110:111], v[110:111], v[126:127]
    v_cvt_pk_bf16_f32 v39, v110, v111
    buffer_store_dwordx4 v[36:39], v5, s[4:7], s41 offen sc1
    s_add_u32 s41, s41, 4096
    v_pk_add_f32 v[112:113], v[112:113], v[128:129]
    v_cvt_pk_bf16_f32 v40, v112, v113
    v_lshlrev_b32_e64 v112, 16, v40
    v_and_b32 v113, 0xffff0000, v40
    v_pk_mul_f32 v[112:113], v[112:113], v[126:127]
    v_cvt_pk_bf16_f32 v40, v112, v113
    v_pk_add_f32 v[114:115], v[114:115], v[128:129]
    v_cvt_pk_bf16_f32 v41, v114, v115
    v_lshlrev_b32_e64 v114, 16, v41
    v_and_b32 v115, 0xffff0000, v41
    v_pk_mul_f32 v[114:115], v[114:115], v[126:127]
    v_cvt_pk_bf16_f32 v41, v114, v115
    v_pk_add_f32 v[116:117], v[116:117], v[128:129]
    v_cvt_pk_bf16_f32 v42, v116, v117
    v_lshlrev_b32_e64 v116, 16, v42
    v_and_b32 v117, 0xffff0000, v42
    v_pk_mul_f32 v[116:117], v[116:117], v[126:127]
    v_cvt_pk_bf16_f32 v42, v116, v117
    v_pk_add_f32 v[118:119], v[118:119], v[128:129]
    v_cvt_pk_bf16_f32 v43, v118, v119
    v_lshlrev_b32_e64 v118, 16, v43
    v_and_b32 v119, 0xffff0000, v43
    v_pk_mul_f32 v[118:119], v[118:119], v[126:127]
    v_cvt_pk_bf16_f32 v43, v118, v119
    buffer_store_dwordx4 v[40:43], v5, s[4:7], s41 offen sc1
    s_add_u32 s41, s41, 4096
    s_lshr_b32 s40, s22, 3
    s_lshl_b32 s40, s40, 2
    s_add_u32 s40, s40, 128
    s_waitcnt vmcnt(0)
    s_barrier
    s_cmp_lg_u32 s17, 0
    s_cbranch_scc1 SG_50
    v_mov_b32 v250, s40
    v_mov_b32 v251, 1
    s_mov_b64 exec, 1
    buffer_atomic_add v251, v250, s[8:11], 0 offen
    s_mov_b64 exec, -1
SG_50:
    s_branch NEXT
DO_KV:
    s_load_dwordx2 s[12:13], s[0:1], 24
    s_waitcnt lgkmcnt(0)
    s_and_b32 s13, s13, 0xffff
    s_mov_b32 s14, 4718592
    s_mov_b32 s15, 0x00020000
    s_load_dwordx2 s[60:61], s[0:1], 32
    s_waitcnt lgkmcnt(0)
    s_nop 0
    s_and_b32 s61, s61, 0xffff
    s_mov_b32 s62, 4718592
    s_mov_b32 s63, 0x00020000
    s_mov_b32 s26, 8192
    s_mov_b32 s24, 36864
    s_mul_i32 s23, s21, 294912
    s_add_u32 s23, s23, 0
    s_lshl_b32 s30, s22, 8
    s_add_u32 s31, s30, 128
    s_mov_b32 s32, s30
    s_mov_b32 s33, s31
    v_mbcnt_lo_u32_b32 v8, -1, 0
    v_mbcnt_hi_u32_b32 v8, -1, v8
    s_lshr_b32 s35, s17, 1
    s_and_b32 s36, s17, 1
    v_lshlrev_b32_e64 v0, 4, v8
    s_mul_i32 s40, s35, 16384
    v_add_u32 v1, s40, v0
    v_lshrrev_b32 v9, 5, v8
    v_bfe_u32 v10, v8, 2, 2
    v_lshl_add_u32 v9, v9, 3, v10
    v_lshlrev_b32 v2, 7, v9
    v_lshrrev_b32 v10, 1, v10
    v_xor_b32_e64 v10, s36, v10
    v_lshl_add_u32 v2, v10, 6, v2
    v_bfe_u32 v10, v8, 4, 1
    v_lshl_add_u32 v2, v10, 5, v2
    v_and_b32_e64 v11, 3, v8
    v_lshl_add_u32 v2, v11, 3, v2
    v_add_u32 v2, 32768, v2
    v_lshrrev_b32_e64 v9, 3, v8
    v_mul_lo_u32 v3, v9, s26
    v_bfe_u32 v9, v8, 4, 1
    v_lshlrev_b32 v9, 2, v9
    v_and_b32 v11, 7, v8
    v_xor_b32_e64 v9, v9, v11
    v_lshl_add_u32 v3, v9, 4, v3
    v_lshlrev_b32 v4, 10, v10
    v_and_b32 v11, 15, v8
    v_lshl_add_u32 v4, v11, 4, v4
    v_lshrrev_b32_e64 v9, 5, v8
    v_lshl_add_u32 v4, v9, 8, v4
    s_bitcmp1_b32 s98, s21
    s_cbranch_scc1 LNW_51
    s_lshl_b32 s40, s21, 2
    s_add_u32 s40, s40, 128
    v_mov_b32 v252, 163832
    s_cmp_lg_u32 s17, 0
    s_cbranch_scc1 LNB_54
    v_mov_b32 v250, s40
    s_mov_b32 s41, 0
    v_mov_b32 v253, 0
LNP_52:
    buffer_load_dword v251, v250, s[8:11], 0 offen sc1
    s_waitcnt vmcnt(0)
    v_cmp_le_u32 vcc, 8, v251
    s_cbranch_vccnz LNO_53
    v_cmp_eq_u32 vcc, 0, v251
    s_sleep 12
    s_cbranch_vccz LNP_52x
    s_sleep 30
LNP_52x:
    s_add_u32 s41, s41, 1
    s_cmp_lt_u32 s41, 40
    s_cbranch_scc1 LNP_52
    s_sub_u32 s19, s19, 64
    s_cselect_b32 s19, 0, s19
    s_cbranch_scc1 LNO_53
    v_mov_b32 v253, 1
LNO_53:
    ds_write_b32 v252, v253
    s_waitcnt lgkmcnt(0)
LNB_54:
    s_barrier
    ds_read_b32 v253, v252
    s_waitcnt lgkmcnt(0)
    v_readfirstlane_b32 s41, v253
    s_barrier
    s_cmp_eq_u32 s41, 1
    s_cbranch_scc1 LN_HELP
    s_bitset1_b32 s98, s21
LNW_51:
    s_lshl_b32 s40, s17, 1
    s_mul_i32 s40, s40, s24
    s_add_u32 s34, s23, s40
    s_and_b32 s40, s17, 0
    s_lshl_b32 s40, s40, 11
    s_add_u32 s34, s34, s40
    s_lshl_b32 s40, s17, 3
    s_mul_i32 s25, s40, s26
    s_mov_b32 s28, 0
    s_lshl_b32 s44, s17, 13
    s_add_u32 s44, s44, s28
    s_lshl_b32 s45, s17, 10
    s_add_u32 s45, s45, s28
    s_add_u32 s45, s45, 32768
    s_lshl_b32 s42, s26, 5
    s_add_u32 m0, s44, 0
    s_mov_b32 s40, s34
    buffer_load_dwordx4 v0, s[4:7], s40 offen lds
    buffer_load_dwordx4 v0, s[4:7], s40 offen offset:1024 lds
    buffer_load_dwordx4 v0, s[4:7], s40 offen offset:2048 lds
    buffer_load_dwordx4 v0, s[4:7], s40 offen offset:3072 lds
    s_add_u32 m0, s44, 4096
    s_add_u32 s40, s34, s24
    buffer_load_dwordx4 v0, s[4:7], s40 offen lds
    buffer_load_dwordx4 v0, s[4:7], s40 offen offset:1024 lds
    buffer_load_dwordx4 v0, s[4:7], s40 offen offset:2048 lds
    buffer_load_dwordx4 v0, s[4:7], s40 offen offset:3072 lds
    s_add_u32 m0, s45, 0
    s_add_u32 s41, s25, s30
    buffer_load_dwordx4 v3, s[12:15], s41 offen lds
    s_add_u32 m0, s45, 4096
    s_add_u32 s41, s41, s42
    buffer_load_dwordx4 v3, s[12:15], s41 offen lds
    s_add_u32 m0, s45, 8192
    s_add_u32 s41, s25, s31
    buffer_load_dwordx4 v3, s[12:15], s41 offen lds
    s_add_u32 m0, s45, 12288
    s_add_u32 s41, s41, s42
    buffer_load_dwordx4 v3, s[12:15], s41 offen lds
    s_add_u32 m0, s45, 16384
    s_add_u32 s41, s25, s32
    buffer_load_dwordx4 v3, s[60:63], s41 offen lds
    s_add_u32 m0, s45, 20480
    s_add_u32 s41, s41, s42
    buffer_load_dwordx4 v3, s[60:63], s41 offen lds
    s_add_u32 m0, s45, 24576
    s_add_u32 s41, s25, s33
    buffer_load_dwordx4 v3, s[60:63], s41 offen lds
    s_add_u32 m0, s45, 28672
    s_add_u32 s41, s41, s42
    buffer_load_dwordx4 v3, s[60:63], s41 offen lds
    s_add_u32 s34, s34, 4096
    s_lshl_b32 s43, s26, 6
    s_add_u32 s25, s25, s43
    s_xor_b32 s28, s28, 65536
    s_lshl_b32 s44, s17, 13
    s_add_u32 s44, s44, s28
    s_lshl_b32 s45, s17, 10
    s_add_u32 s45, s45, s28
    s_add_u32 s45, s45, 32768
    s_lshl_b32 s42, s26, 5
    s_add_u32 m0, s44, 0
    s_mov_b32 s40, s34
    s_nop 0
    buffer_load_dwordx4 v0, s[4:7], s40 offen lds
    buffer_load_dwordx4 v0, s[4:7], s40 offen offset:1024 lds
    buffer_load_dwordx4 v0, s[4:7], s40 offen offset:2048 lds
    buffer_load_dwordx4 v0, s[4:7], s40 offen offset:3072 lds
    s_add_u32 m0, s44, 4096
    s_add_u32 s40, s34, s24
    buffer_load_dwordx4 v0, s[4:7], s40 offen lds
    buffer_load_dwordx4 v0, s[4:7], s40 offen offset:1024 lds
    buffer_load_dwordx4 v0, s[4:7], s40 offen offset:2048 lds
    buffer_load_dwordx4 v0, s[4:7], s40 offen offset:3072 lds
    s_add_u32 m0, s45, 0
    s_add_u32 s41, s25, s30
    buffer_load_dwordx4 v3, s[12:15], s41 offen lds
    s_add_u32 m0, s45, 4096
    s_add_u32 s41, s41, s42
    buffer_load_dwordx4 v3, s[12:15], s41 offen lds
    s_add_u32 m0, s45, 8192
    s_add_u32 s41, s25, s31
    buffer_load_dwordx4 v3, s[12:15], s41 offen lds
    s_add_u32 m0, s45, 12288
    s_add_u32 s41, s41, s42
    buffer_load_dwordx4 v3, s[12:15], s41 offen lds
    s_add_u32 m0, s45, 16384
    s_add_u32 s41, s25, s32
    buffer_load_dwordx4 v3, s[60:63], s41 offen lds
    s_add_u32 m0, s45, 20480
    s_add_u32 s41, s41, s42
    buffer_load_dwordx4 v3, s[60:63], s41 offen lds
    s_add_u32 m0, s45, 24576
    s_add_u32 s41, s25, s33
    buffer_load_dwordx4 v3, s[60:63], s41 offen lds
    s_add_u32 m0, s45, 28672
    s_add_u32 s41, s41, s42
    buffer_load_dwordx4 v3, s[60:63], s41 offen lds
    s_add_u32 s34, s34, 4096
    s_lshl_b32 s43, s26, 6
    s_add_u32 s25, s25, s43
    s_xor_b32 s28, s28, 65536
    v_accvgpr_write_b32 a0, 0
    v_accvgpr_write_b32 a1, 0
    v_accvgpr_write_b32 a2, 0
    v_accvgpr_write_b32 a3, 0
    v_accvgpr_write_b32 a4, 0
    v_accvgpr_write_b32 a5, 0
    v_accvgpr_write_b32 a6, 0
    v_accvgpr_write_b32 a7, 0
    v_accvgpr_write_b32 a8, 0
    v_accvgpr_write_b32 a9, 0
    v_accvgpr_write_b32 a10, 0
    v_accvgpr_write_b32 a11, 0
    v_accvgpr_write_b32 a12, 0
    v_accvgpr_write_b32 a13, 0
    v_accvgpr_write_b32 a14, 0
    v_accvgpr_write_b32 a15, 0
    v_accvgpr_write_b32 a16, 0
    v_accvgpr_write_b32 a17, 0
    v_accvgpr_write_b32 a18, 0
    v_accvgpr_write_b32 a19, 0
    v_accvgpr_write_b32 a20, 0
    v_accvgpr_write_b32 a21, 0
    v_accvgpr_write_b32 a22, 0
    v_accvgpr_write_b32 a23, 0
    v_accvgpr_write_b32 a24, 0
    v_accvgpr_write_b32 a25, 0
    v_accvgpr_write_b32 a26, 0
    v_accvgpr_write_b32 a27, 0
    v_accvgpr_write_b32 a28, 0
    v_accvgpr_write_b32 a29, 0
    v_accvgpr_write_b32 a30, 0
    v_accvgpr_write_b32 a31, 0
    v_accvgpr_write_b32 a32, 0
    v_accvgpr_write_b32 a33, 0
    v_accvgpr_write_b32 a34, 0
    v_accvgpr_write_b32 a35, 0
    v_accvgpr_write_b32 a36, 0
    v_accvgpr_write_b32 a37, 0
    v_accvgpr_write_b32 a38, 0
    v_accvgpr_write_b32 a39, 0
    v_accvgpr_write_b32 a40, 0
    v_accvgpr_write_b32 a41, 0
    v_accvgpr_write_b32 a42, 0
    v_accvgpr_write_b32 a43, 0
    v_accvgpr_write_b32 a44, 0
    v_accvgpr_write_b32 a45, 0
    v_accvgpr_write_b32 a46, 0
    v_accvgpr_write_b32 a47, 0
    v_accvgpr_write_b32 a48, 0
    v_accvgpr_write_b32 a49, 0
    v_accvgpr_write_b32 a50, 0
    v_accvgpr_write_b32 a51, 0
    v_accvgpr_write_b32 a52, 0
    v_accvgpr_write_b32 a53, 0
    v_accvgpr_write_b32 a54, 0
    v_accvgpr_write_b32 a55, 0
    v_accvgpr_write_b32 a56, 0
    v_accvgpr_write_b32 a57, 0
    v_accvgpr_write_b32 a58, 0
    v_accvgpr_write_b32 a59, 0
    v_accvgpr_write_b32 a60, 0
    v_accvgpr_write_b32 a61, 0
    v_accvgpr_write_b32 a62, 0
    v_accvgpr_write_b32 a63, 0
    v_accvgpr_write_b32 a64, 0
    v_accvgpr_write_b32 a65, 0
    v_accvgpr_write_b32 a66, 0
    v_accvgpr_write_b32 a67, 0
    v_accvgpr_write_b32 a68, 0
    v_accvgpr_write_b32 a69, 0
    v_accvgpr_write_b32 a70, 0
    v_accvgpr_write_b32 a71, 0
    v_accvgpr_write_b32 a72, 0
    v_accvgpr_write_b32 a73, 0
    v_accvgpr_write_b32 a74, 0
    v_accvgpr_write_b32 a75, 0
    v_accvgpr_write_b32 a76, 0
    v_accvgpr_write_b32 a77, 0
    v_accvgpr_write_b32 a78, 0
    v_accvgpr_write_b32 a79, 0
    v_accvgpr_write_b32 a80, 0
    v_accvgpr_write_b32 a81, 0
    v_accvgpr_write_b32 a82, 0
    v_accvgpr_write_b32 a83, 0
    v_accvgpr_write_b32 a84, 0
    v_accvgpr_write_b32 a85, 0
    v_accvgpr_write_b32 a86, 0
    v_accvgpr_write_b32 a87, 0
    v_accvgpr_write_b32 a88, 0
    v_accvgpr_write_b32 a89, 0
    v_accvgpr_write_b32 a90, 0
    v_accvgpr_write_b32 a91, 0
    v_accvgpr_write_b32 a92, 0
    v_accvgpr_write_b32 a93, 0
    v_accvgpr_write_b32 a94, 0
    v_accvgpr_write_b32 a95, 0
    v_accvgpr_write_b32 a96, 0
    v_accvgpr_write_b32 a97, 0
    v_accvgpr_write_b32 a98, 0
    v_accvgpr_write_b32 a99, 0
    v_accvgpr_write_b32 a100, 0
    v_accvgpr_write_b32 a101, 0
    v_accvgpr_write_b32 a102, 0
    v_accvgpr_write_b32 a103, 0
    v_accvgpr_write_b32 a104, 0
    v_accvgpr_write_b32 a105, 0
    v_accvgpr_write_b32 a106, 0
    v_accvgpr_write_b32 a107, 0
    v_accvgpr_write_b32 a108, 0
    v_accvgpr_write_b32 a109, 0
    v_accvgpr_write_b32 a110, 0
    v_accvgpr_write_b32 a111, 0
    v_accvgpr_write_b32 a112, 0
    v_accvgpr_write_b32 a113, 0
    v_accvgpr_write_b32 a114, 0
    v_accvgpr_write_b32 a115, 0
    v_accvgpr_write_b32 a116, 0
    v_accvgpr_write_b32 a117, 0
    v_accvgpr_write_b32 a118, 0
    v_accvgpr_write_b32 a119, 0
    v_accvgpr_write_b32 a120, 0
    v_accvgpr_write_b32 a121, 0
    v_accvgpr_write_b32 a122, 0
    v_accvgpr_write_b32 a123, 0
    v_accvgpr_write_b32 a124, 0
    v_accvgpr_write_b32 a125, 0
    v_accvgpr_write_b32 a126, 0
    v_accvgpr_write_b32 a127, 0
    v_accvgpr_write_b32 a128, 0
    v_accvgpr_write_b32 a129, 0
    v_accvgpr_write_b32 a130, 0
    v_accvgpr_write_b32 a131, 0
    v_accvgpr_write_b32 a132, 0
    v_accvgpr_write_b32 a133, 0
    v_accvgpr_write_b32 a134, 0
    v_accvgpr_write_b32 a135, 0
    v_accvgpr_write_b32 a136, 0
    v_accvgpr_write_b32 a137, 0
    v_accvgpr_write_b32 a138, 0
    v_accvgpr_write_b32 a139, 0
    v_accvgpr_write_b32 a140, 0
    v_accvgpr_write_b32 a141, 0
    v_accvgpr_write_b32 a142, 0
    v_accvgpr_write_b32 a143, 0
    v_accvgpr_write_b32 a144, 0
    v_accvgpr_write_b32 a145, 0
    v_accvgpr_write_b32 a146, 0
    v_accvgpr_write_b32 a147, 0
    v_accvgpr_write_b32 a148, 0
    v_accvgpr_write_b32 a149, 0
    v_accvgpr_write_b32 a150, 0
    v_accvgpr_write_b32 a151, 0
    v_accvgpr_write_b32 a152, 0
    v_accvgpr_write_b32 a153, 0
    v_accvgpr_write_b32 a154, 0
    v_accvgpr_write_b32 a155, 0
    v_accvgpr_write_b32 a156, 0
    v_accvgpr_write_b32 a157, 0
    v_accvgpr_write_b32 a158, 0
    v_accvgpr_write_b32 a159, 0
    v_accvgpr_write_b32 a160, 0
    v_accvgpr_write_b32 a161, 0
    v_accvgpr_write_b32 a162, 0
    v_accvgpr_write_b32 a163, 0
    v_accvgpr_write_b32 a164, 0
    v_accvgpr_write_b32 a165, 0
    v_accvgpr_write_b32 a166, 0
    v_accvgpr_write_b32 a167, 0
    v_accvgpr_write_b32 a168, 0
    v_accvgpr_write_b32 a169, 0
    v_accvgpr_write_b32 a170, 0
    v_accvgpr_write_b32 a171, 0
    v_accvgpr_write_b32 a172, 0
    v_accvgpr_write_b32 a173, 0
    v_accvgpr_write_b32 a174, 0
    v_accvgpr_write_b32 a175, 0
    v_accvgpr_write_b32 a176, 0
    v_accvgpr_write_b32 a177, 0
    v_accvgpr_write_b32 a178, 0
    v_accvgpr_write_b32 a179, 0
    v_accvgpr_write_b32 a180, 0
    v_accvgpr_write_b32 a181, 0
    v_accvgpr_write_b32 a182, 0
    v_accvgpr_write_b32 a183, 0
    v_accvgpr_write_b32 a184, 0
    v_accvgpr_write_b32 a185, 0
    v_accvgpr_write_b32 a186, 0
    v_accvgpr_write_b32 a187, 0
    v_accvgpr_write_b32 a188, 0
    v_accvgpr_write_b32 a189, 0
    v_accvgpr_write_b32 a190, 0
    v_accvgpr_write_b32 a191, 0
    v_accvgpr_write_b32 a192, 0
    v_accvgpr_write_b32 a193, 0
    v_accvgpr_write_b32 a194, 0
    v_accvgpr_write_b32 a195, 0
    v_accvgpr_write_b32 a196, 0
    v_accvgpr_write_b32 a197, 0
    v_accvgpr_write_b32 a198, 0
    v_accvgpr_write_b32 a199, 0
    v_accvgpr_write_b32 a200, 0
    v_accvgpr_write_b32 a201, 0
    v_accvgpr_write_b32 a202, 0
    v_accvgpr_write_b32 a203, 0
    v_accvgpr_write_b32 a204, 0
    v_accvgpr_write_b32 a205, 0
    v_accvgpr_write_b32 a206, 0
    v_accvgpr_write_b32 a207, 0
    v_accvgpr_write_b32 a208, 0
    v_accvgpr_write_b32 a209, 0
    v_accvgpr_write_b32 a210, 0
    v_accvgpr_write_b32 a211, 0
    v_accvgpr_write_b32 a212, 0
    v_accvgpr_write_b32 a213, 0
    v_accvgpr_write_b32 a214, 0
    v_accvgpr_write_b32 a215, 0
    v_accvgpr_write_b32 a216, 0
    v_accvgpr_write_b32 a217, 0
    v_accvgpr_write_b32 a218, 0
    v_accvgpr_write_b32 a219, 0
    v_accvgpr_write_b32 a220, 0
    v_accvgpr_write_b32 a221, 0
    v_accvgpr_write_b32 a222, 0
    v_accvgpr_write_b32 a223, 0
    v_accvgpr_write_b32 a224, 0
    v_accvgpr_write_b32 a225, 0
    v_accvgpr_write_b32 a226, 0
    v_accvgpr_write_b32 a227, 0
    v_accvgpr_write_b32 a228, 0
    v_accvgpr_write_b32 a229, 0
    v_accvgpr_write_b32 a230, 0
    v_accvgpr_write_b32 a231, 0
    v_accvgpr_write_b32 a232, 0
    v_accvgpr_write_b32 a233, 0
    v_accvgpr_write_b32 a234, 0
    v_accvgpr_write_b32 a235, 0
    v_accvgpr_write_b32 a236, 0
    v_accvgpr_write_b32 a237, 0
    v_accvgpr_write_b32 a238, 0
    v_accvgpr_write_b32 a239, 0
    v_accvgpr_write_b32 a240, 0
    v_accvgpr_write_b32 a241, 0
    v_accvgpr_write_b32 a242, 0
    v_accvgpr_write_b32 a243, 0
    v_accvgpr_write_b32 a244, 0
    v_accvgpr_write_b32 a245, 0
    v_accvgpr_write_b32 a246, 0
    v_accvgpr_write_b32 a247, 0
    v_accvgpr_write_b32 a248, 0
    v_accvgpr_write_b32 a249, 0
    v_accvgpr_write_b32 a250, 0
    v_accvgpr_write_b32 a251, 0
    v_accvgpr_write_b32 a252, 0
    v_accvgpr_write_b32 a253, 0
    v_accvgpr_write_b32 a254, 0
    v_accvgpr_write_b32 a255, 0
    s_waitcnt vmcnt(16)
    s_barrier
    ds_read_b128 v[16:19], v1 offset:0
    ds_read_b64_tr_b16 v[32:33], v2 offset:0
    ds_read_b64_tr_b16 v[34:35], v2 offset:512
    ds_read_b64_tr_b16 v[36:37], v2 offset:8192
    ds_read_b64_tr_b16 v[38:39], v2 offset:8704
    ds_read_b64_tr_b16 v[40:41], v2 offset:16384
    ds_read_b64_tr_b16 v[42:43], v2 offset:16896
    ds_read_b64_tr_b16 v[44:45], v2 offset:24576
    ds_read_b64_tr_b16 v[46:47], v2 offset:25088
    ds_read_b128 v[20:23], v1 offset:4096
    ds_read_b128 v[24:27], v1 offset:8192
    ds_read_b128 v[28:31], v1 offset:12288
    s_mov_b32 s27, 0
KV_LOOP:
    s_waitcnt lgkmcnt(0)
    v_mfma_f32_32x32x16_bf16 a[0:15], v[32:35], v[16:19], a[0:15]
    ds_read_b128 v[48:51], v1 offset:1024
    v_mfma_f32_32x32x16_bf16 a[16:31], v[36:39], v[16:19], a[16:31]
    ds_read_b64_tr_b16 v[64:65], v2 offset:2048
    v_mfma_f32_32x32x16_bf16 a[32:47], v[16:19], v[40:43], a[32:47]
    ds_read_b64_tr_b16 v[66:67], v2 offset:2560
    v_mfma_f32_32x32x16_bf16 a[48:63], v[16:19], v[44:47], a[48:63]
    ds_read_b64_tr_b16 v[68:69], v2 offset:10240
    v_mfma_f32_32x32x16_bf16 a[64:79], v[32:35], v[20:23], a[64:79]
    ds_read_b64_tr_b16 v[70:71], v2 offset:10752
    v_mfma_f32_32x32x16_bf16 a[80:95], v[36:39], v[20:23], a[80:95]
    ds_read_b64_tr_b16 v[72:73], v2 offset:18432
    v_mfma_f32_32x32x16_bf16 a[96:111], v[20:23], v[40:43], a[96:111]
    ds_read_b64_tr_b16 v[74:75], v2 offset:18944
    v_mfma_f32_32x32x16_bf16 a[112:127], v[20:23], v[44:47], a[112:127]
    ds_read_b64_tr_b16 v[76:77], v2 offset:26624
    v_mfma_f32_32x32x16_bf16 a[128:143], v[32:35], v[24:27], a[128:143]
    ds_read_b64_tr_b16 v[78:79], v2 offset:27136
    v_mfma_f32_32x32x16_bf16 a[144:159], v[36:39], v[24:27], a[144:159]
    ds_read_b128 v[52:55], v1 offset:5120
    v_mfma_f32_32x32x16_bf16 a[160:175], v[24:27], v[40:43], a[160:175]
    ds_read_b128 v[56:59], v1 offset:9216
    v_mfma_f32_32x32x16_bf16 a[176:191], v[24:27], v[44:47], a[176:191]
    ds_read_b128 v[60:63], v1 offset:13312
    v_mfma_f32_32x32x16_bf16 a[192:207], v[32:35], v[28:31], a[192:207]
    v_mfma_f32_32x32x16_bf16 a[208:223], v[36:39], v[28:31], a[208:223]
    v_mfma_f32_32x32x16_bf16 a[224:239], v[28:31], v[40:43], a[224:239]
    v_mfma_f32_32x32x16_bf16 a[240:255], v[28:31], v[44:47], a[240:255]
    s_waitcnt lgkmcnt(0)
    v_mfma_f32_32x32x16_bf16 a[0:15], v[64:67], v[48:51], a[0:15]
    ds_read_b128 v[16:19], v1 offset:2048
    v_mfma_f32_32x32x16_bf16 a[16:31], v[68:71], v[48:51], a[16:31]
    ds_read_b64_tr_b16 v[32:33], v2 offset:4096
    v_mfma_f32_32x32x16_bf16 a[32:47], v[48:51], v[72:75], a[32:47]
    ds_read_b64_tr_b16 v[34:35], v2 offset:4608
    v_mfma_f32_32x32x16_bf16 a[48:63], v[48:51], v[76:79], a[48:63]
    ds_read_b64_tr_b16 v[36:37], v2 offset:12288
    v_mfma_f32_32x32x16_bf16 a[64:79], v[64:67], v[52:55], a[64:79]
    ds_read_b64_tr_b16 v[38:39], v2 offset:12800
    v_mfma_f32_32x32x16_bf16 a[80:95], v[68:71], v[52:55], a[80:95]
    ds_read_b64_tr_b16 v[40:41], v2 offset:20480
    v_mfma_f32_32x32x16_bf16 a[96:111], v[52:55], v[72:75], a[96:111]
    ds_read_b64_tr_b16 v[42:43], v2 offset:20992
    v_mfma_f32_32x32x16_bf16 a[112:127], v[52:55], v[76:79], a[112:127]
    ds_read_b64_tr_b16 v[44:45], v2 offset:28672
    v_mfma_f32_32x32x16_bf16 a[128:143], v[64:67], v[56:59], a[128:143]
    ds_read_b64_tr_b16 v[46:47], v2 offset:29184
    v_mfma_f32_32x32x16_bf16 a[144:159], v[68:71], v[56:59], a[144:159]
    ds_read_b128 v[20:23], v1 offset:6144
    v_mfma_f32_32x32x16_bf16 a[160:175], v[56:59], v[72:75], a[160:175]
    ds_read_b128 v[24:27], v1 offset:10240
    v_mfma_f32_32x32x16_bf16 a[176:191], v[56:59], v[76:79], a[176:191]
    ds_read_b128 v[28:31], v1 offset:14336
    v_mfma_f32_32x32x16_bf16 a[192:207], v[64:67], v[60:63], a[192:207]
    v_mfma_f32_32x32x16_bf16 a[208:223], v[68:71], v[60:63], a[208:223]
    v_mfma_f32_32x32x16_bf16 a[224:239], v[60:63], v[72:75], a[224:239]
    v_mfma_f32_32x32x16_bf16 a[240:255], v[60:63], v[76:79], a[240:255]
    s_waitcnt lgkmcnt(0)
    v_mfma_f32_32x32x16_bf16 a[0:15], v[32:35], v[16:19], a[0:15]
    ds_read_b128 v[48:51], v1 offset:3072
    v_mfma_f32_32x32x16_bf16 a[16:31], v[36:39], v[16:19], a[16:31]
    ds_read_b64_tr_b16 v[64:65], v2 offset:6144
    v_mfma_f32_32x32x16_bf16 a[32:47], v[16:19], v[40:43], a[32:47]
    ds_read_b64_tr_b16 v[66:67], v2 offset:6656
    v_mfma_f32_32x32x16_bf16 a[48:63], v[16:19], v[44:47], a[48:63]
    ds_read_b64_tr_b16 v[68:69], v2 offset:14336
    v_mfma_f32_32x32x16_bf16 a[64:79], v[32:35], v[20:23], a[64:79]
    ds_read_b64_tr_b16 v[70:71], v2 offset:14848
    v_mfma_f32_32x32x16_bf16 a[80:95], v[36:39], v[20:23], a[80:95]
    ds_read_b64_tr_b16 v[72:73], v2 offset:22528
    v_mfma_f32_32x32x16_bf16 a[96:111], v[20:23], v[40:43], a[96:111]
    ds_read_b64_tr_b16 v[74:75], v2 offset:23040
    v_mfma_f32_32x32x16_bf16 a[112:127], v[20:23], v[44:47], a[112:127]
    ds_read_b64_tr_b16 v[76:77], v2 offset:30720
    v_mfma_f32_32x32x16_bf16 a[128:143], v[32:35], v[24:27], a[128:143]
    ds_read_b64_tr_b16 v[78:79], v2 offset:31232
    v_mfma_f32_32x32x16_bf16 a[144:159], v[36:39], v[24:27], a[144:159]
    ds_read_b128 v[52:55], v1 offset:7168
    v_mfma_f32_32x32x16_bf16 a[160:175], v[24:27], v[40:43], a[160:175]
    ds_read_b128 v[56:59], v1 offset:11264
    v_mfma_f32_32x32x16_bf16 a[176:191], v[24:27], v[44:47], a[176:191]
    ds_read_b128 v[60:63], v1 offset:15360
    v_mfma_f32_32x32x16_bf16 a[192:207], v[32:35], v[28:31], a[192:207]
    v_mfma_f32_32x32x16_bf16 a[208:223], v[36:39], v[28:31], a[208:223]
    v_mfma_f32_32x32x16_bf16 a[224:239], v[28:31], v[40:43], a[224:239]
    v_mfma_f32_32x32x16_bf16 a[240:255], v[28:31], v[44:47], a[240:255]
    s_waitcnt vmcnt(0) lgkmcnt(0)
    s_barrier
    v_xor_b32 v1, 65536, v1
    v_xor_b32 v2, 65536, v2
    s_cmp_ge_u32 s27, 7
    s_cbranch_scc1 KV_NODMA
    s_lshl_b32 s44, s17, 13
    s_add_u32 s44, s44, s28
    s_lshl_b32 s45, s17, 10
    s_add_u32 s45, s45, s28
    s_add_u32 s45, s45, 32768
    s_lshl_b32 s42, s26, 5
    v_mfma_f32_32x32x16_bf16 a[0:15], v[64:67], v[48:51], a[0:15]
    ds_read_b128 v[16:19], v1 offset:0
    s_add_u32 m0, s44, 0
    s_mov_b32 s40, s34
    buffer_load_dwordx4 v0, s[4:7], s40 offen lds
    v_mfma_f32_32x32x16_bf16 a[16:31], v[68:71], v[48:51], a[16:31]
    ds_read_b64_tr_b16 v[32:33], v2 offset:0
    buffer_load_dwordx4 v0, s[4:7], s40 offen offset:1024 lds
    v_mfma_f32_32x32x16_bf16 a[32:47], v[48:51], v[72:75], a[32:47]
    ds_read_b64_tr_b16 v[34:35], v2 offset:512
    buffer_load_dwordx4 v0, s[4:7], s40 offen offset:2048 lds
    v_mfma_f32_32x32x16_bf16 a[48:63], v[48:51], v[76:79], a[48:63]
    ds_read_b64_tr_b16 v[36:37], v2 offset:8192
    buffer_load_dwordx4 v0, s[4:7], s40 offen offset:3072 lds
    v_mfma_f32_32x32x16_bf16 a[64:79], v[64:67], v[52:55], a[64:79]
    ds_read_b64_tr_b16 v[38:39], v2 offset:8704
    s_add_u32 m0, s44, 4096
    s_add_u32 s40, s34, s24
    buffer_load_dwordx4 v0, s[4:7], s40 offen lds
    v_mfma_f32_32x32x16_bf16 a[80:95], v[68:71], v[52:55], a[80:95]
    ds_read_b64_tr_b16 v[40:41], v2 offset:16384
    buffer_load_dwordx4 v0, s[4:7], s40 offen offset:1024 lds
    v_mfma_f32_32x32x16_bf16 a[96:111], v[52:55], v[72:75], a[96:111]
    ds_read_b64_tr_b16 v[42:43], v2 offset:16896
    buffer_load_dwordx4 v0, s[4:7], s40 offen offset:2048 lds
    v_mfma_f32_32x32x16_bf16 a[112:127], v[52:55], v[76:79], a[112:127]
    ds_read_b64_tr_b16 v[44:45], v2 offset:24576
    buffer_load_dwordx4 v0, s[4:7], s40 offen offset:3072 lds
    v_mfma_f32_32x32x16_bf16 a[128:143], v[64:67], v[56:59], a[128:143]
    ds_read_b64_tr_b16 v[46:47], v2 offset:25088
    s_add_u32 m0, s45, 0
    s_add_u32 s41, s25, s30
    buffer_load_dwordx4 v3, s[12:15], s41 offen lds
    v_mfma_f32_32x32x16_bf16 a[144:159], v[68:71], v[56:59], a[144:159]
    ds_read_b128 v[20:23], v1 offset:4096
    s_add_u32 m0, s45, 4096
    s_add_u32 s41, s41, s42
    buffer_load_dwordx4 v3, s[12:15], s41 offen lds
    v_mfma_f32_32x32x16_bf16 a[160:175], v[56:59], v[72:75], a[160:175]
    ds_read_b128 v[24:27], v1 offset:8192
    s_add_u32 m0, s45, 8192
    s_add_u32 s41, s25, s31
    buffer_load_dwordx4 v3, s[12:15], s41 offen lds
    v_mfma_f32_32x32x16_bf16 a[176:191], v[56:59], v[76:79], a[176:191]
    ds_read_b128 v[28:31], v1 offset:12288
    s_add_u32 m0, s45, 12288
    s_add_u32 s41, s41, s42
    buffer_load_dwordx4 v3, s[12:15], s41 offen lds
    v_mfma_f32_32x32x16_bf16 a[192:207], v[64:67], v[60:63], a[192:207]
    s_add_u32 m0, s45, 16384
    s_add_u32 s41, s25, s32
    buffer_load_dwordx4 v3, s[60:63], s41 offen lds
    v_mfma_f32_32x32x16_bf16 a[208:223], v[68:71], v[60:63], a[208:223]
    s_add_u32 m0, s45, 20480
    s_add_u32 s41, s41, s42
    buffer_load_dwordx4 v3, s[60:63], s41 offen lds
    v_mfma_f32_32x32x16_bf16 a[224:239], v[60:63], v[72:75], a[224:239]
    s_add_u32 m0, s45, 24576
    s_add_u32 s41, s25, s33
    buffer_load_dwordx4 v3, s[60:63], s41 offen lds
    v_mfma_f32_32x32x16_bf16 a[240:255], v[60:63], v[76:79], a[240:255]
    s_add_u32 m0, s45, 28672
    s_add_u32 s41, s41, s42
    buffer_load_dwordx4 v3, s[60:63], s41 offen lds
    s_add_u32 s34, s34, 4096
    s_lshl_b32 s43, s26, 6
    s_add_u32 s25, s25, s43
    s_xor_b32 s28, s28, 65536
    s_add_u32 s27, s27, 1
    s_branch KV_LOOP
KV_NODMA:
    s_cmp_ge_u32 s27, 8
    s_cbranch_scc1 KV_FIN
    v_mfma_f32_32x32x16_bf16 a[0:15], v[64:67], v[48:51], a[0:15]
    ds_read_b128 v[16:19], v1 offset:0
    v_mfma_f32_32x32x16_bf16 a[16:31], v[68:71], v[48:51], a[16:31]
    ds_read_b64_tr_b16 v[32:33], v2 offset:0
    v_mfma_f32_32x32x16_bf16 a[32:47], v[48:51], v[72:75], a[32:47]
    ds_read_b64_tr_b16 v[34:35], v2 offset:512
    v_mfma_f32_32x32x16_bf16 a[48:63], v[48:51], v[76:79], a[48:63]
    ds_read_b64_tr_b16 v[36:37], v2 offset:8192
    v_mfma_f32_32x32x16_bf16 a[64:79], v[64:67], v[52:55], a[64:79]
    ds_read_b64_tr_b16 v[38:39], v2 offset:8704
    v_mfma_f32_32x32x16_bf16 a[80:95], v[68:71], v[52:55], a[80:95]
    ds_read_b64_tr_b16 v[40:41], v2 offset:16384
    v_mfma_f32_32x32x16_bf16 a[96:111], v[52:55], v[72:75], a[96:111]
    ds_read_b64_tr_b16 v[42:43], v2 offset:16896
    v_mfma_f32_32x32x16_bf16 a[112:127], v[52:55], v[76:79], a[112:127]
    ds_read_b64_tr_b16 v[44:45], v2 offset:24576
    v_mfma_f32_32x32x16_bf16 a[128:143], v[64:67], v[56:59], a[128:143]
    ds_read_b64_tr_b16 v[46:47], v2 offset:25088
    v_mfma_f32_32x32x16_bf16 a[144:159], v[68:71], v[56:59], a[144:159]
    ds_read_b128 v[20:23], v1 offset:4096
    v_mfma_f32_32x32x16_bf16 a[160:175], v[56:59], v[72:75], a[160:175]
    ds_read_b128 v[24:27], v1 offset:8192
    v_mfma_f32_32x32x16_bf16 a[176:191], v[56:59], v[76:79], a[176:191]
    ds_read_b128 v[28:31], v1 offset:12288
    v_mfma_f32_32x32x16_bf16 a[192:207], v[64:67], v[60:63], a[192:207]
    v_mfma_f32_32x32x16_bf16 a[208:223], v[68:71], v[60:63], a[208:223]
    v_mfma_f32_32x32x16_bf16 a[224:239], v[60:63], v[72:75], a[224:239]
    v_mfma_f32_32x32x16_bf16 a[240:255], v[60:63], v[76:79], a[240:255]
    s_add_u32 s27, s27, 1
    s_branch KV_LOOP
KV_FIN:
    v_mfma_f32_32x32x16_bf16 a[0:15], v[64:67], v[48:51], a[0:15]
    v_mfma_f32_32x32x16_bf16 a[16:31], v[68:71], v[48:51], a[16:31]
    v_mfma_f32_32x32x16_bf16 a[32:47], v[48:51], v[72:75], a[32:47]
    v_mfma_f32_32x32x16_bf16 a[48:63], v[48:51], v[76:79], a[48:63]
    v_mfma_f32_32x32x16_bf16 a[64:79], v[64:67], v[52:55], a[64:79]
    v_mfma_f32_32x32x16_bf16 a[80:95], v[68:71], v[52:55], a[80:95]
    v_mfma_f32_32x32x16_bf16 a[96:111], v[52:55], v[72:75], a[96:111]
    v_mfma_f32_32x32x16_bf16 a[112:127], v[52:55], v[76:79], a[112:127]
    v_mfma_f32_32x32x16_bf16 a[128:143], v[64:67], v[56:59], a[128:143]
    v_mfma_f32_32x32x16_bf16 a[144:159], v[68:71], v[56:59], a[144:159]
    v_mfma_f32_32x32x16_bf16 a[160:175], v[56:59], v[72:75], a[160:175]
    v_mfma_f32_32x32x16_bf16 a[176:191], v[56:59], v[76:79], a[176:191]
    v_mfma_f32_32x32x16_bf16 a[192:207], v[64:67], v[60:63], a[192:207]
    v_mfma_f32_32x32x16_bf16 a[208:223], v[68:71], v[60:63], a[208:223]
    v_mfma_f32_32x32x16_bf16 a[224:239], v[60:63], v[72:75], a[224:239]
    v_mfma_f32_32x32x16_bf16 a[240:255], v[60:63], v[76:79], a[240:255]
    s_nop 15
    s_lshl_b32 s38, s21, 3
    s_lshl_b32 s40, s35, 2
    s_add_u32 s38, s38, s40
    s_lshl_b32 s40, s22, 6
    s_add_u32 s38, s38, s40
    s_lshl_b32 s38, s38, 13
    s_lshl_b32 s40, s36, 11
    s_add_u32 s38, s38, s40
    s_add_u32 s41, s38, 4194304
    v_accvgpr_read_b32 v80, a0
    v_accvgpr_read_b32 v81, a1
    v_accvgpr_read_b32 v82, a2
    v_accvgpr_read_b32 v83, a3
    v_accvgpr_read_b32 v84, a4
    v_accvgpr_read_b32 v85, a5
    v_accvgpr_read_b32 v86, a6
    v_accvgpr_read_b32 v87, a7
    v_accvgpr_read_b32 v88, a8
    v_accvgpr_read_b32 v89, a9
    v_accvgpr_read_b32 v90, a10
    v_accvgpr_read_b32 v91, a11
    v_accvgpr_read_b32 v92, a12
    v_accvgpr_read_b32 v93, a13
    v_accvgpr_read_b32 v94, a14
    v_accvgpr_read_b32 v95, a15
    v_cvt_pk_bf16_f32 v96, v80, v81
    v_cvt_pk_bf16_f32 v97, v82, v83
    v_cvt_pk_bf16_f32 v98, v84, v85
    v_cvt_pk_bf16_f32 v99, v86, v87
    v_cvt_pk_bf16_f32 v100, v88, v89
    v_cvt_pk_bf16_f32 v101, v90, v91
    v_cvt_pk_bf16_f32 v102, v92, v93
    v_cvt_pk_bf16_f32 v103, v94, v95
    s_nop 0
    v_permlane32_swap_b32 v96, v98
    v_permlane32_swap_b32 v97, v99
    v_permlane32_swap_b32 v100, v102
    v_permlane32_swap_b32 v101, v103
    s_nop 0
    buffer_store_dwordx4 v[96:99], v0, s[4:7], s41 offen offset:0 sc1
    buffer_store_dwordx4 v[100:103], v0, s[4:7], s41 offen offset:1024 sc1
    s_add_u32 s41, s38, 4198400
    v_accvgpr_read_b32 v112, a16
    v_accvgpr_read_b32 v113, a17
    v_accvgpr_read_b32 v114, a18
    v_accvgpr_read_b32 v115, a19
    v_accvgpr_read_b32 v116, a20
    v_accvgpr_read_b32 v117, a21
    v_accvgpr_read_b32 v118, a22
    v_accvgpr_read_b32 v119, a23
    v_accvgpr_read_b32 v120, a24
    v_accvgpr_read_b32 v121, a25
    v_accvgpr_read_b32 v122, a26
    v_accvgpr_read_b32 v123, a27
    v_accvgpr_read_b32 v124, a28
    v_accvgpr_read_b32 v125, a29
    v_accvgpr_read_b32 v126, a30
    v_accvgpr_read_b32 v127, a31
    v_cvt_pk_bf16_f32 v128, v112, v113
    v_cvt_pk_bf16_f32 v129, v114, v115
    v_cvt_pk_bf16_f32 v130, v116, v117
    v_cvt_pk_bf16_f32 v131, v118, v119
    v_cvt_pk_bf16_f32 v132, v120, v121
    v_cvt_pk_bf16_f32 v133, v122, v123
    v_cvt_pk_bf16_f32 v134, v124, v125
    v_cvt_pk_bf16_f32 v135, v126, v127
    s_nop 0
    v_permlane32_swap_b32 v128, v130
    v_permlane32_swap_b32 v129, v131
    v_permlane32_swap_b32 v132, v134
    v_permlane32_swap_b32 v133, v135
    s_nop 0
    buffer_store_dwordx4 v[128:131], v0, s[4:7], s41 offen offset:0 sc1
    buffer_store_dwordx4 v[132:135], v0, s[4:7], s41 offen offset:1024 sc1
    s_add_u32 s41, s38, 20971520
    v_accvgpr_read_b32 v80, a32
    v_accvgpr_read_b32 v81, a33
    v_accvgpr_read_b32 v82, a34
    v_accvgpr_read_b32 v83, a35
    v_accvgpr_read_b32 v84, a36
    v_accvgpr_read_b32 v85, a37
    v_accvgpr_read_b32 v86, a38
    v_accvgpr_read_b32 v87, a39
    v_accvgpr_read_b32 v88, a40
    v_accvgpr_read_b32 v89, a41
    v_accvgpr_read_b32 v90, a42
    v_accvgpr_read_b32 v91, a43
    v_accvgpr_read_b32 v92, a44
    v_accvgpr_read_b32 v93, a45
    v_accvgpr_read_b32 v94, a46
    v_accvgpr_read_b32 v95, a47
    v_cvt_pk_bf16_f32 v96, v80, v81
    v_cvt_pk_bf16_f32 v97, v82, v83
    v_cvt_pk_bf16_f32 v100, v84, v85
    v_cvt_pk_bf16_f32 v101, v86, v87
    v_cvt_pk_bf16_f32 v98, v88, v89
    v_cvt_pk_bf16_f32 v99, v90, v91
    v_cvt_pk_bf16_f32 v102, v92, v93
    v_cvt_pk_bf16_f32 v103, v94, v95
    buffer_store_dwordx4 v[96:99], v4, s[4:7], s41 offen offset:0 sc1
    buffer_store_dwordx4 v[100:103], v4, s[4:7], s41 offen offset:512 sc1
    s_add_u32 s41, s38, 20975616
    v_accvgpr_read_b32 v112, a48
    v_accvgpr_read_b32 v113, a49
    v_accvgpr_read_b32 v114, a50
    v_accvgpr_read_b32 v115, a51
    v_accvgpr_read_b32 v116, a52
    v_accvgpr_read_b32 v117, a53
    v_accvgpr_read_b32 v118, a54
    v_accvgpr_read_b32 v119, a55
    v_accvgpr_read_b32 v120, a56
    v_accvgpr_read_b32 v121, a57
    v_accvgpr_read_b32 v122, a58
    v_accvgpr_read_b32 v123, a59
    v_accvgpr_read_b32 v124, a60
    v_accvgpr_read_b32 v125, a61
    v_accvgpr_read_b32 v126, a62
    v_accvgpr_read_b32 v127, a63
    v_cvt_pk_bf16_f32 v128, v112, v113
    v_cvt_pk_bf16_f32 v129, v114, v115
    v_cvt_pk_bf16_f32 v132, v116, v117
    v_cvt_pk_bf16_f32 v133, v118, v119
    v_cvt_pk_bf16_f32 v130, v120, v121
    v_cvt_pk_bf16_f32 v131, v122, v123
    v_cvt_pk_bf16_f32 v134, v124, v125
    v_cvt_pk_bf16_f32 v135, v126, v127
    buffer_store_dwordx4 v[128:131], v4, s[4:7], s41 offen offset:0 sc1
    buffer_store_dwordx4 v[132:135], v4, s[4:7], s41 offen offset:512 sc1
    s_add_u32 s41, s38, 4202496
    v_accvgpr_read_b32 v80, a64
    v_accvgpr_read_b32 v81, a65
    v_accvgpr_read_b32 v82, a66
    v_accvgpr_read_b32 v83, a67
    v_accvgpr_read_b32 v84, a68
    v_accvgpr_read_b32 v85, a69
    v_accvgpr_read_b32 v86, a70
    v_accvgpr_read_b32 v87, a71
    v_accvgpr_read_b32 v88, a72
    v_accvgpr_read_b32 v89, a73
    v_accvgpr_read_b32 v90, a74
    v_accvgpr_read_b32 v91, a75
    v_accvgpr_read_b32 v92, a76
    v_accvgpr_read_b32 v93, a77
    v_accvgpr_read_b32 v94, a78
    v_accvgpr_read_b32 v95, a79
    v_cvt_pk_bf16_f32 v96, v80, v81
    v_cvt_pk_bf16_f32 v97, v82, v83
    v_cvt_pk_bf16_f32 v98, v84, v85
    v_cvt_pk_bf16_f32 v99, v86, v87
    v_cvt_pk_bf16_f32 v100, v88, v89
    v_cvt_pk_bf16_f32 v101, v90, v91
    v_cvt_pk_bf16_f32 v102, v92, v93
    v_cvt_pk_bf16_f32 v103, v94, v95
    s_nop 0
    v_permlane32_swap_b32 v96, v98
    v_permlane32_swap_b32 v97, v99
    v_permlane32_swap_b32 v100, v102
    v_permlane32_swap_b32 v101, v103
    s_nop 0
    buffer_store_dwordx4 v[96:99], v0, s[4:7], s41 offen offset:0 sc1
    buffer_store_dwordx4 v[100:103], v0, s[4:7], s41 offen offset:1024 sc1
    s_add_u32 s41, s38, 4206592
    v_accvgpr_read_b32 v112, a80
    v_accvgpr_read_b32 v113, a81
    v_accvgpr_read_b32 v114, a82
    v_accvgpr_read_b32 v115, a83
    v_accvgpr_read_b32 v116, a84
    v_accvgpr_read_b32 v117, a85
    v_accvgpr_read_b32 v118, a86
    v_accvgpr_read_b32 v119, a87
    v_accvgpr_read_b32 v120, a88
    v_accvgpr_read_b32 v121, a89
    v_accvgpr_read_b32 v122, a90
    v_accvgpr_read_b32 v123, a91
    v_accvgpr_read_b32 v124, a92
    v_accvgpr_read_b32 v125, a93
    v_accvgpr_read_b32 v126, a94
    v_accvgpr_read_b32 v127, a95
    v_cvt_pk_bf16_f32 v128, v112, v113
    v_cvt_pk_bf16_f32 v129, v114, v115
    v_cvt_pk_bf16_f32 v130, v116, v117
    v_cvt_pk_bf16_f32 v131, v118, v119
    v_cvt_pk_bf16_f32 v132, v120, v121
    v_cvt_pk_bf16_f32 v133, v122, v123
    v_cvt_pk_bf16_f32 v134, v124, v125
    v_cvt_pk_bf16_f32 v135, v126, v127
    s_nop 0
    v_permlane32_swap_b32 v128, v130
    v_permlane32_swap_b32 v129, v131
    v_permlane32_swap_b32 v132, v134
    v_permlane32_swap_b32 v133, v135
    s_nop 0
    buffer_store_dwordx4 v[128:131], v0, s[4:7], s41 offen offset:0 sc1
    buffer_store_dwordx4 v[132:135], v0, s[4:7], s41 offen offset:1024 sc1
    s_add_u32 s41, s38, 20979712
    v_accvgpr_read_b32 v80, a96
    v_accvgpr_read_b32 v81, a97
    v_accvgpr_read_b32 v82, a98
    v_accvgpr_read_b32 v83, a99
    v_accvgpr_read_b32 v84, a100
    v_accvgpr_read_b32 v85, a101
    v_accvgpr_read_b32 v86, a102
    v_accvgpr_read_b32 v87, a103
    v_accvgpr_read_b32 v88, a104
    v_accvgpr_read_b32 v89, a105
    v_accvgpr_read_b32 v90, a106
    v_accvgpr_read_b32 v91, a107
    v_accvgpr_read_b32 v92, a108
    v_accvgpr_read_b32 v93, a109
    v_accvgpr_read_b32 v94, a110
    v_accvgpr_read_b32 v95, a111
    v_cvt_pk_bf16_f32 v96, v80, v81
    v_cvt_pk_bf16_f32 v97, v82, v83
    v_cvt_pk_bf16_f32 v100, v84, v85
    v_cvt_pk_bf16_f32 v101, v86, v87
    v_cvt_pk_bf16_f32 v98, v88, v89
    v_cvt_pk_bf16_f32 v99, v90, v91
    v_cvt_pk_bf16_f32 v102, v92, v93
    v_cvt_pk_bf16_f32 v103, v94, v95
    buffer_store_dwordx4 v[96:99], v4, s[4:7], s41 offen offset:0 sc1
    buffer_store_dwordx4 v[100:103], v4, s[4:7], s41 offen offset:512 sc1
    s_add_u32 s41, s38, 20983808
    v_accvgpr_read_b32 v112, a112
    v_accvgpr_read_b32 v113, a113
    v_accvgpr_read_b32 v114, a114
    v_accvgpr_read_b32 v115, a115
    v_accvgpr_read_b32 v116, a116
    v_accvgpr_read_b32 v117, a117
    v_accvgpr_read_b32 v118, a118
    v_accvgpr_read_b32 v119, a119
    v_accvgpr_read_b32 v120, a120
    v_accvgpr_read_b32 v121, a121
    v_accvgpr_read_b32 v122, a122
    v_accvgpr_read_b32 v123, a123
    v_accvgpr_read_b32 v124, a124
    v_accvgpr_read_b32 v125, a125
    v_accvgpr_read_b32 v126, a126
    v_accvgpr_read_b32 v127, a127
    v_cvt_pk_bf16_f32 v128, v112, v113
    v_cvt_pk_bf16_f32 v129, v114, v115
    v_cvt_pk_bf16_f32 v132, v116, v117
    v_cvt_pk_bf16_f32 v133, v118, v119
    v_cvt_pk_bf16_f32 v130, v120, v121
    v_cvt_pk_bf16_f32 v131, v122, v123
    v_cvt_pk_bf16_f32 v134, v124, v125
    v_cvt_pk_bf16_f32 v135, v126, v127
    buffer_store_dwordx4 v[128:131], v4, s[4:7], s41 offen offset:0 sc1
    buffer_store_dwordx4 v[132:135], v4, s[4:7], s41 offen offset:512 sc1
    s_add_u32 s41, s38, 4210688
    v_accvgpr_read_b32 v80, a128
    v_accvgpr_read_b32 v81, a129
    v_accvgpr_read_b32 v82, a130
    v_accvgpr_read_b32 v83, a131
    v_accvgpr_read_b32 v84, a132
    v_accvgpr_read_b32 v85, a133
    v_accvgpr_read_b32 v86, a134
    v_accvgpr_read_b32 v87, a135
    v_accvgpr_read_b32 v88, a136
    v_accvgpr_read_b32 v89, a137
    v_accvgpr_read_b32 v90, a138
    v_accvgpr_read_b32 v91, a139
    v_accvgpr_read_b32 v92, a140
    v_accvgpr_read_b32 v93, a141
    v_accvgpr_read_b32 v94, a142
    v_accvgpr_read_b32 v95, a143
    v_cvt_pk_bf16_f32 v96, v80, v81
    v_cvt_pk_bf16_f32 v97, v82, v83
    v_cvt_pk_bf16_f32 v98, v84, v85
    v_cvt_pk_bf16_f32 v99, v86, v87
    v_cvt_pk_bf16_f32 v100, v88, v89
    v_cvt_pk_bf16_f32 v101, v90, v91
    v_cvt_pk_bf16_f32 v102, v92, v93
    v_cvt_pk_bf16_f32 v103, v94, v95
    s_nop 0
    v_permlane32_swap_b32 v96, v98
    v_permlane32_swap_b32 v97, v99
    v_permlane32_swap_b32 v100, v102
    v_permlane32_swap_b32 v101, v103
    s_nop 0
    buffer_store_dwordx4 v[96:99], v0, s[4:7], s41 offen offset:0 sc1
    buffer_store_dwordx4 v[100:103], v0, s[4:7], s41 offen offset:1024 sc1
    s_add_u32 s41, s38, 4214784
    v_accvgpr_read_b32 v112, a144
    v_accvgpr_read_b32 v113, a145
    v_accvgpr_read_b32 v114, a146
    v_accvgpr_read_b32 v115, a147
    v_accvgpr_read_b32 v116, a148
    v_accvgpr_read_b32 v117, a149
    v_accvgpr_read_b32 v118, a150
    v_accvgpr_read_b32 v119, a151
    v_accvgpr_read_b32 v120, a152
    v_accvgpr_read_b32 v121, a153
    v_accvgpr_read_b32 v122, a154
    v_accvgpr_read_b32 v123, a155
    v_accvgpr_read_b32 v124, a156
    v_accvgpr_read_b32 v125, a157
    v_accvgpr_read_b32 v126, a158
    v_accvgpr_read_b32 v127, a159
    v_cvt_pk_bf16_f32 v128, v112, v113
    v_cvt_pk_bf16_f32 v129, v114, v115
    v_cvt_pk_bf16_f32 v130, v116, v117
    v_cvt_pk_bf16_f32 v131, v118, v119
    v_cvt_pk_bf16_f32 v132, v120, v121
    v_cvt_pk_bf16_f32 v133, v122, v123
    v_cvt_pk_bf16_f32 v134, v124, v125
    v_cvt_pk_bf16_f32 v135, v126, v127
    s_nop 0
    v_permlane32_swap_b32 v128, v130
    v_permlane32_swap_b32 v129, v131
    v_permlane32_swap_b32 v132, v134
    v_permlane32_swap_b32 v133, v135
    s_nop 0
    buffer_store_dwordx4 v[128:131], v0, s[4:7], s41 offen offset:0 sc1
    buffer_store_dwordx4 v[132:135], v0, s[4:7], s41 offen offset:1024 sc1
    s_add_u32 s41, s38, 20987904
    v_accvgpr_read_b32 v80, a160
    v_accvgpr_read_b32 v81, a161
    v_accvgpr_read_b32 v82, a162
    v_accvgpr_read_b32 v83, a163
    v_accvgpr_read_b32 v84, a164
    v_accvgpr_read_b32 v85, a165
    v_accvgpr_read_b32 v86, a166
    v_accvgpr_read_b32 v87, a167
    v_accvgpr_read_b32 v88, a168
    v_accvgpr_read_b32 v89, a169
    v_accvgpr_read_b32 v90, a170
    v_accvgpr_read_b32 v91, a171
    v_accvgpr_read_b32 v92, a172
    v_accvgpr_read_b32 v93, a173
    v_accvgpr_read_b32 v94, a174
    v_accvgpr_read_b32 v95, a175
    v_cvt_pk_bf16_f32 v96, v80, v81
    v_cvt_pk_bf16_f32 v97, v82, v83
    v_cvt_pk_bf16_f32 v100, v84, v85
    v_cvt_pk_bf16_f32 v101, v86, v87
    v_cvt_pk_bf16_f32 v98, v88, v89
    v_cvt_pk_bf16_f32 v99, v90, v91
    v_cvt_pk_bf16_f32 v102, v92, v93
    v_cvt_pk_bf16_f32 v103, v94, v95
    buffer_store_dwordx4 v[96:99], v4, s[4:7], s41 offen offset:0 sc1
    buffer_store_dwordx4 v[100:103], v4, s[4:7], s41 offen offset:512 sc1
    s_add_u32 s41, s38, 20992000
    v_accvgpr_read_b32 v112, a176
    v_accvgpr_read_b32 v113, a177
    v_accvgpr_read_b32 v114, a178
    v_accvgpr_read_b32 v115, a179
    v_accvgpr_read_b32 v116, a180
    v_accvgpr_read_b32 v117, a181
    v_accvgpr_read_b32 v118, a182
    v_accvgpr_read_b32 v119, a183
    v_accvgpr_read_b32 v120, a184
    v_accvgpr_read_b32 v121, a185
    v_accvgpr_read_b32 v122, a186
    v_accvgpr_read_b32 v123, a187
    v_accvgpr_read_b32 v124, a188
    v_accvgpr_read_b32 v125, a189
    v_accvgpr_read_b32 v126, a190
    v_accvgpr_read_b32 v127, a191
    v_cvt_pk_bf16_f32 v128, v112, v113
    v_cvt_pk_bf16_f32 v129, v114, v115
    v_cvt_pk_bf16_f32 v132, v116, v117
    v_cvt_pk_bf16_f32 v133, v118, v119
    v_cvt_pk_bf16_f32 v130, v120, v121
    v_cvt_pk_bf16_f32 v131, v122, v123
    v_cvt_pk_bf16_f32 v134, v124, v125
    v_cvt_pk_bf16_f32 v135, v126, v127
    buffer_store_dwordx4 v[128:131], v4, s[4:7], s41 offen offset:0 sc1
    buffer_store_dwordx4 v[132:135], v4, s[4:7], s41 offen offset:512 sc1
    s_add_u32 s41, s38, 4218880
    v_accvgpr_read_b32 v80, a192
    v_accvgpr_read_b32 v81, a193
    v_accvgpr_read_b32 v82, a194
    v_accvgpr_read_b32 v83, a195
    v_accvgpr_read_b32 v84, a196
    v_accvgpr_read_b32 v85, a197
    v_accvgpr_read_b32 v86, a198
    v_accvgpr_read_b32 v87, a199
    v_accvgpr_read_b32 v88, a200
    v_accvgpr_read_b32 v89, a201
    v_accvgpr_read_b32 v90, a202
    v_accvgpr_read_b32 v91, a203
    v_accvgpr_read_b32 v92, a204
    v_accvgpr_read_b32 v93, a205
    v_accvgpr_read_b32 v94, a206
    v_accvgpr_read_b32 v95, a207
    v_cvt_pk_bf16_f32 v96, v80, v81
    v_cvt_pk_bf16_f32 v97, v82, v83
    v_cvt_pk_bf16_f32 v98, v84, v85
    v_cvt_pk_bf16_f32 v99, v86, v87
    v_cvt_pk_bf16_f32 v100, v88, v89
    v_cvt_pk_bf16_f32 v101, v90, v91
    v_cvt_pk_bf16_f32 v102, v92, v93
    v_cvt_pk_bf16_f32 v103, v94, v95
    s_nop 0
    v_permlane32_swap_b32 v96, v98
    v_permlane32_swap_b32 v97, v99
    v_permlane32_swap_b32 v100, v102
    v_permlane32_swap_b32 v101, v103
    s_nop 0
    buffer_store_dwordx4 v[96:99], v0, s[4:7], s41 offen offset:0 sc1
    buffer_store_dwordx4 v[100:103], v0, s[4:7], s41 offen offset:1024 sc1
    s_add_u32 s41, s38, 4222976
    v_accvgpr_read_b32 v112, a208
    v_accvgpr_read_b32 v113, a209
    v_accvgpr_read_b32 v114, a210
    v_accvgpr_read_b32 v115, a211
    v_accvgpr_read_b32 v116, a212
    v_accvgpr_read_b32 v117, a213
    v_accvgpr_read_b32 v118, a214
    v_accvgpr_read_b32 v119, a215
    v_accvgpr_read_b32 v120, a216
    v_accvgpr_read_b32 v121, a217
    v_accvgpr_read_b32 v122, a218
    v_accvgpr_read_b32 v123, a219
    v_accvgpr_read_b32 v124, a220
    v_accvgpr_read_b32 v125, a221
    v_accvgpr_read_b32 v126, a222
    v_accvgpr_read_b32 v127, a223
    v_cvt_pk_bf16_f32 v128, v112, v113
    v_cvt_pk_bf16_f32 v129, v114, v115
    v_cvt_pk_bf16_f32 v130, v116, v117
    v_cvt_pk_bf16_f32 v131, v118, v119
    v_cvt_pk_bf16_f32 v132, v120, v121
    v_cvt_pk_bf16_f32 v133, v122, v123
    v_cvt_pk_bf16_f32 v134, v124, v125
    v_cvt_pk_bf16_f32 v135, v126, v127
    s_nop 0
    v_permlane32_swap_b32 v128, v130
    v_permlane32_swap_b32 v129, v131
    v_permlane32_swap_b32 v132, v134
    v_permlane32_swap_b32 v133, v135
    s_nop 0
    buffer_store_dwordx4 v[128:131], v0, s[4:7], s41 offen offset:0 sc1
    buffer_store_dwordx4 v[132:135], v0, s[4:7], s41 offen offset:1024 sc1
    s_add_u32 s41, s38, 20996096
    v_accvgpr_read_b32 v80, a224
    v_accvgpr_read_b32 v81, a225
    v_accvgpr_read_b32 v82, a226
    v_accvgpr_read_b32 v83, a227
    v_accvgpr_read_b32 v84, a228
    v_accvgpr_read_b32 v85, a229
    v_accvgpr_read_b32 v86, a230
    v_accvgpr_read_b32 v87, a231
    v_accvgpr_read_b32 v88, a232
    v_accvgpr_read_b32 v89, a233
    v_accvgpr_read_b32 v90, a234
    v_accvgpr_read_b32 v91, a235
    v_accvgpr_read_b32 v92, a236
    v_accvgpr_read_b32 v93, a237
    v_accvgpr_read_b32 v94, a238
    v_accvgpr_read_b32 v95, a239
    v_cvt_pk_bf16_f32 v96, v80, v81
    v_cvt_pk_bf16_f32 v97, v82, v83
    v_cvt_pk_bf16_f32 v100, v84, v85
    v_cvt_pk_bf16_f32 v101, v86, v87
    v_cvt_pk_bf16_f32 v98, v88, v89
    v_cvt_pk_bf16_f32 v99, v90, v91
    v_cvt_pk_bf16_f32 v102, v92, v93
    v_cvt_pk_bf16_f32 v103, v94, v95
    buffer_store_dwordx4 v[96:99], v4, s[4:7], s41 offen offset:0 sc1
    buffer_store_dwordx4 v[100:103], v4, s[4:7], s41 offen offset:512 sc1
    s_add_u32 s41, s38, 21000192
    v_accvgpr_read_b32 v112, a240
    v_accvgpr_read_b32 v113, a241
    v_accvgpr_read_b32 v114, a242
    v_accvgpr_read_b32 v115, a243
    v_accvgpr_read_b32 v116, a244
    v_accvgpr_read_b32 v117, a245
    v_accvgpr_read_b32 v118, a246
    v_accvgpr_read_b32 v119, a247
    v_accvgpr_read_b32 v120, a248
    v_accvgpr_read_b32 v121, a249
    v_accvgpr_read_b32 v122, a250
    v_accvgpr_read_b32 v123, a251
    v_accvgpr_read_b32 v124, a252
    v_accvgpr_read_b32 v125, a253
    v_accvgpr_read_b32 v126, a254
    v_accvgpr_read_b32 v127, a255
    v_cvt_pk_bf16_f32 v128, v112, v113
    v_cvt_pk_bf16_f32 v129, v114, v115
    v_cvt_pk_bf16_f32 v132, v116, v117
    v_cvt_pk_bf16_f32 v133, v118, v119
    v_cvt_pk_bf16_f32 v130, v120, v121
    v_cvt_pk_bf16_f32 v131, v122, v123
    v_cvt_pk_bf16_f32 v134, v124, v125
    v_cvt_pk_bf16_f32 v135, v126, v127
    buffer_store_dwordx4 v[128:131], v4, s[4:7], s41 offen offset:0 sc1
    buffer_store_dwordx4 v[132:135], v4, s[4:7], s41 offen offset:512 sc1
    s_lshl_b32 s40, s21, 8
    s_add_u32 s40, s40, s22
    s_lshl_b32 s40, s40, 2
    s_add_u32 s40, s40, 64552960
    s_waitcnt vmcnt(0)
    s_waitcnt vmcnt(0)
    s_barrier
    s_cmp_lg_u32 s17, 0
    s_cbranch_scc1 SF_55
    v_mov_b32_e64 v250, 1
    buffer_store_dword v250, off, s[4:7], s40 sc1
SF_55:
    s_branch NEXT
DO_KV0:
    s_load_dwordx2 s[12:13], s[0:1], 24
    s_waitcnt lgkmcnt(0)
    s_and_b32 s13, s13, 0xffff
    s_mov_b32 s14, 4718592
    s_mov_b32 s15, 0x00020000
    s_load_dwordx2 s[60:61], s[0:1], 32
    s_waitcnt lgkmcnt(0)
    s_and_b32 s61, s61, 0xffff
    s_mov_b32 s62, 4718592
    s_mov_b32 s63, 0x00020000
    s_mov_b32 s21, 0
    s_mov_b32 s26, 8192
    s_mov_b32 s24, 36864
    s_mul_i32 s23, s37, 73728
    s_add_u32 s23, s23, 0
    s_lshl_b32 s30, s22, 8
    s_add_u32 s31, s30, 128
    s_mov_b32 s32, s30
    s_mov_b32 s33, s31
    v_mbcnt_lo_u32_b32 v8, -1, 0
    v_mbcnt_hi_u32_b32 v8, -1, v8
    s_lshr_b32 s35, s17, 1
    s_and_b32 s36, s17, 1
    v_lshlrev_b32_e64 v0, 4, v8
    s_mul_i32 s40, s35, 4096
    v_add_u32 v1, s40, v0
    v_lshrrev_b32 v9, 5, v8
    v_bfe_u32 v10, v8, 2, 2
    v_lshl_add_u32 v9, v9, 3, v10
    v_lshlrev_b32 v2, 7, v9
    v_lshrrev_b32 v10, 1, v10
    v_xor_b32_e64 v10, s36, v10
    v_lshl_add_u32 v2, v10, 6, v2
    v_bfe_u32 v10, v8, 4, 1
    v_lshl_add_u32 v2, v10, 5, v2
    v_and_b32_e64 v11, 3, v8
    v_lshl_add_u32 v2, v11, 3, v2
    v_add_u32 v2, 32768, v2
    v_lshrrev_b32_e64 v9, 3, v8
    v_mul_lo_u32 v3, v9, s26
    v_bfe_u32 v9, v8, 4, 1
    v_lshlrev_b32 v9, 2, v9
    v_and_b32 v11, 7, v8
    v_xor_b32_e64 v9, v9, v11
    v_lshl_add_u32 v3, v9, 4, v3
    v_lshlrev_b32 v4, 10, v10
    v_and_b32 v11, 15, v8
    v_lshl_add_u32 v4, v11, 4, v4
    v_lshrrev_b32_e64 v9, 5, v8
    v_lshl_add_u32 v4, v9, 8, v4
    s_bitcmp1_b32 s98, s21
    s_cbranch_scc1 LNW_56
    s_lshl_b32 s40, s21, 2
    s_add_u32 s40, s40, 128
    v_mov_b32 v252, 163832
    s_cmp_lg_u32 s17, 0
    s_cbranch_scc1 LNB_59
    v_mov_b32 v250, s40
    s_mov_b32 s41, 0
    v_mov_b32 v253, 0
LNP_57:
    buffer_load_dword v251, v250, s[8:11], 0 offen sc1
    s_waitcnt vmcnt(0)
    v_cmp_le_u32 vcc, 8, v251
    s_cbranch_vccnz LNO_58
    v_cmp_eq_u32 vcc, 0, v251
    s_sleep 12
    s_cbranch_vccz LNP_57x
    s_sleep 30
LNP_57x:
    s_add_u32 s41, s41, 1
    s_cmp_lt_u32 s41, 40
    s_cbranch_scc1 LNP_57
    s_sub_u32 s19, s19, 64
    s_cselect_b32 s19, 0, s19
    s_cbranch_scc1 LNO_58
    v_mov_b32 v253, 1
LNO_58:
    ds_write_b32 v252, v253
    s_waitcnt lgkmcnt(0)
LNB_59:
    s_barrier
    ds_read_b32 v253, v252
    s_waitcnt lgkmcnt(0)
    v_readfirstlane_b32 s41, v253
    s_barrier
    s_cmp_eq_u32 s41, 1
    s_cbranch_scc1 LN_HELP
    s_bitset1_b32 s98, s21
LNW_56:
    s_lshr_b32 s40, s17, 1
    s_mul_i32 s40, s40, s24
    s_add_u32 s34, s23, s40
    s_and_b32 s40, s17, 1
    s_lshl_b32 s40, s40, 11
    s_add_u32 s34, s34, s40
    s_lshl_b32 s40, s17, 3
    s_mul_i32 s25, s40, s26
    s_mov_b32 s28, 0
    s_lshl_b32 s44, s17, 11
    s_add_u32 s44, s44, s28
    s_lshl_b32 s45, s17, 10
    s_add_u32 s45, s45, s28
    s_add_u32 s45, s45, 32768
    s_lshl_b32 s42, s26, 5
    s_mov_b32 m0, s44
    s_nop 0
    buffer_load_dwordx4 v0, s[4:7], s34 offen lds
    buffer_load_dwordx4 v0, s[4:7], s34 offen offset:1024 lds
    s_add_u32 m0, s45, 0
    s_add_u32 s41, s25, s30
    buffer_load_dwordx4 v3, s[12:15], s41 offen lds
    s_add_u32 m0, s45, 4096
    s_add_u32 s41, s41, s42
    buffer_load_dwordx4 v3, s[12:15], s41 offen lds
    s_add_u32 m0, s45, 8192
    s_add_u32 s41, s25, s31
    buffer_load_dwordx4 v3, s[12:15], s41 offen lds
    s_add_u32 m0, s45, 12288
    s_add_u32 s41, s41, s42
    buffer_load_dwordx4 v3, s[12:15], s41 offen lds
    s_add_u32 m0, s45, 16384
    s_add_u32 s41, s25, s32
    buffer_load_dwordx4 v3, s[60:63], s41 offen lds
    s_add_u32 m0, s45, 20480
    s_add_u32 s41, s41, s42
    buffer_load_dwordx4 v3, s[60:63], s41 offen lds
    s_add_u32 m0, s45, 24576
    s_add_u32 s41, s25, s33
    buffer_load_dwordx4 v3, s[60:63], s41 offen lds
    s_add_u32 m0, s45, 28672
    s_add_u32 s41, s41, s42
    buffer_load_dwordx4 v3, s[60:63], s41 offen lds
    s_add_u32 s34, s34, 4096
    s_lshl_b32 s43, s26, 6
    s_add_u32 s25, s25, s43
    s_xor_b32 s28, s28, 65536
    s_lshl_b32 s44, s17, 11
    s_add_u32 s44, s44, s28
    s_lshl_b32 s45, s17, 10
    s_add_u32 s45, s45, s28
    s_add_u32 s45, s45, 32768
    s_lshl_b32 s42, s26, 5
    s_mov_b32 m0, s44
    s_nop 0
    buffer_load_dwordx4 v0, s[4:7], s34 offen lds
    buffer_load_dwordx4 v0, s[4:7], s34 offen offset:1024 lds
    s_add_u32 m0, s45, 0
    s_add_u32 s41, s25, s30
    buffer_load_dwordx4 v3, s[12:15], s41 offen lds
    s_add_u32 m0, s45, 4096
    s_add_u32 s41, s41, s42
    buffer_load_dwordx4 v3, s[12:15], s41 offen lds
    s_add_u32 m0, s45, 8192
    s_add_u32 s41, s25, s31
    buffer_load_dwordx4 v3, s[12:15], s41 offen lds
    s_add_u32 m0, s45, 12288
    s_add_u32 s41, s41, s42
    buffer_load_dwordx4 v3, s[12:15], s41 offen lds
    s_add_u32 m0, s45, 16384
    s_add_u32 s41, s25, s32
    buffer_load_dwordx4 v3, s[60:63], s41 offen lds
    s_add_u32 m0, s45, 20480
    s_add_u32 s41, s41, s42
    buffer_load_dwordx4 v3, s[60:63], s41 offen lds
    s_add_u32 m0, s45, 24576
    s_add_u32 s41, s25, s33
    buffer_load_dwordx4 v3, s[60:63], s41 offen lds
    s_add_u32 m0, s45, 28672
    s_add_u32 s41, s41, s42
    buffer_load_dwordx4 v3, s[60:63], s41 offen lds
    s_add_u32 s34, s34, 4096
    s_lshl_b32 s43, s26, 6
    s_add_u32 s25, s25, s43
    s_nop 0
    s_xor_b32 s28, s28, 65536
    v_accvgpr_write_b32 a0, 0
    v_accvgpr_write_b32 a1, 0
    v_accvgpr_write_b32 a2, 0
    v_accvgpr_write_b32 a3, 0
    v_accvgpr_write_b32 a4, 0
    v_accvgpr_write_b32 a5, 0
    v_accvgpr_write_b32 a6, 0
    v_accvgpr_write_b32 a7, 0
    v_accvgpr_write_b32 a8, 0
    v_accvgpr_write_b32 a9, 0
    v_accvgpr_write_b32 a10, 0
    v_accvgpr_write_b32 a11, 0
    v_accvgpr_write_b32 a12, 0
    v_accvgpr_write_b32 a13, 0
    v_accvgpr_write_b32 a14, 0
    v_accvgpr_write_b32 a15, 0
    v_accvgpr_write_b32 a16, 0
    v_accvgpr_write_b32 a17, 0
    v_accvgpr_write_b32 a18, 0
    v_accvgpr_write_b32 a19, 0
    v_accvgpr_write_b32 a20, 0
    v_accvgpr_write_b32 a21, 0
    v_accvgpr_write_b32 a22, 0
    v_accvgpr_write_b32 a23, 0
    v_accvgpr_write_b32 a24, 0
    v_accvgpr_write_b32 a25, 0
    v_accvgpr_write_b32 a26, 0
    v_accvgpr_write_b32 a27, 0
    v_accvgpr_write_b32 a28, 0
    v_accvgpr_write_b32 a29, 0
    v_accvgpr_write_b32 a30, 0
    v_accvgpr_write_b32 a31, 0
    v_accvgpr_write_b32 a32, 0
    v_accvgpr_write_b32 a33, 0
    v_accvgpr_write_b32 a34, 0
    v_accvgpr_write_b32 a35, 0
    v_accvgpr_write_b32 a36, 0
    v_accvgpr_write_b32 a37, 0
    v_accvgpr_write_b32 a38, 0
    v_accvgpr_write_b32 a39, 0
    v_accvgpr_write_b32 a40, 0
    v_accvgpr_write_b32 a41, 0
    v_accvgpr_write_b32 a42, 0
    v_accvgpr_write_b32 a43, 0
    v_accvgpr_write_b32 a44, 0
    v_accvgpr_write_b32 a45, 0
    v_accvgpr_write_b32 a46, 0
    v_accvgpr_write_b32 a47, 0
    v_accvgpr_write_b32 a48, 0
    v_accvgpr_write_b32 a49, 0
    v_accvgpr_write_b32 a50, 0
    v_accvgpr_write_b32 a51, 0
    v_accvgpr_write_b32 a52, 0
    v_accvgpr_write_b32 a53, 0
    v_accvgpr_write_b32 a54, 0
    v_accvgpr_write_b32 a55, 0
    v_accvgpr_write_b32 a56, 0
    v_accvgpr_write_b32 a57, 0
    v_accvgpr_write_b32 a58, 0
    v_accvgpr_write_b32 a59, 0
    v_accvgpr_write_b32 a60, 0
    v_accvgpr_write_b32 a61, 0
    v_accvgpr_write_b32 a62, 0
    v_accvgpr_write_b32 a63, 0
    s_waitcnt vmcnt(10)
    s_barrier
    ds_read_b128 v[16:19], v1 offset:0
    ds_read_b64_tr_b16 v[32:33], v2 offset:0
    ds_read_b64_tr_b16 v[34:35], v2 offset:512
    ds_read_b64_tr_b16 v[36:37], v2 offset:8192
    ds_read_b64_tr_b16 v[38:39], v2 offset:8704
    ds_read_b64_tr_b16 v[40:41], v2 offset:16384
    ds_read_b64_tr_b16 v[42:43], v2 offset:16896
    ds_read_b64_tr_b16 v[44:45], v2 offset:24576
    ds_read_b64_tr_b16 v[46:47], v2 offset:25088
    s_mov_b32 s27, 0
K0_LOOP:
    s_waitcnt lgkmcnt(0)
    v_mfma_f32_32x32x16_bf16 a[0:15], v[32:35], v[16:19], a[0:15]
    ds_read_b128 v[48:51], v1 offset:1024
    ds_read_b64_tr_b16 v[64:65], v2 offset:2048
    ds_read_b64_tr_b16 v[66:67], v2 offset:2560
    v_mfma_f32_32x32x16_bf16 a[16:31], v[36:39], v[16:19], a[16:31]
    ds_read_b64_tr_b16 v[68:69], v2 offset:10240
    ds_read_b64_tr_b16 v[70:71], v2 offset:10752
    ds_read_b64_tr_b16 v[72:73], v2 offset:18432
    v_mfma_f32_32x32x16_bf16 a[32:47], v[16:19], v[40:43], a[32:47]
    ds_read_b64_tr_b16 v[74:75], v2 offset:18944
    ds_read_b64_tr_b16 v[76:77], v2 offset:26624
    ds_read_b64_tr_b16 v[78:79], v2 offset:27136
    v_mfma_f32_32x32x16_bf16 a[48:63], v[16:19], v[44:47], a[48:63]
    s_waitcnt lgkmcnt(0)
    v_mfma_f32_32x32x16_bf16 a[0:15], v[64:67], v[48:51], a[0:15]
    ds_read_b128 v[16:19], v1 offset:2048
    ds_read_b64_tr_b16 v[32:33], v2 offset:4096
    ds_read_b64_tr_b16 v[34:35], v2 offset:4608
    v_mfma_f32_32x32x16_bf16 a[16:31], v[68:71], v[48:51], a[16:31]
    ds_read_b64_tr_b16 v[36:37], v2 offset:12288
    ds_read_b64_tr_b16 v[38:39], v2 offset:12800
    ds_read_b64_tr_b16 v[40:41], v2 offset:20480
    v_mfma_f32_32x32x16_bf16 a[32:47], v[48:51], v[72:75], a[32:47]
    ds_read_b64_tr_b16 v[42:43], v2 offset:20992
    ds_read_b64_tr_b16 v[44:45], v2 offset:28672
    ds_read_b64_tr_b16 v[46:47], v2 offset:29184
    v_mfma_f32_32x32x16_bf16 a[48:63], v[48:51], v[76:79], a[48:63]
    s_waitcnt lgkmcnt(0)
    v_mfma_f32_32x32x16_bf16 a[0:15], v[32:35], v[16:19], a[0:15]
    ds_read_b128 v[48:51], v1 offset:3072
    ds_read_b64_tr_b16 v[64:65], v2 offset:6144
    ds_read_b64_tr_b16 v[66:67], v2 offset:6656
    v_mfma_f32_32x32x16_bf16 a[16:31], v[36:39], v[16:19], a[16:31]
    ds_read_b64_tr_b16 v[68:69], v2 offset:14336
    ds_read_b64_tr_b16 v[70:71], v2 offset:14848
    ds_read_b64_tr_b16 v[72:73], v2 offset:22528
    v_mfma_f32_32x32x16_bf16 a[32:47], v[16:19], v[40:43], a[32:47]
    ds_read_b64_tr_b16 v[74:75], v2 offset:23040
    ds_read_b64_tr_b16 v[76:77], v2 offset:30720
    ds_read_b64_tr_b16 v[78:79], v2 offset:31232
    v_mfma_f32_32x32x16_bf16 a[48:63], v[16:19], v[44:47], a[48:63]
    s_waitcnt vmcnt(0) lgkmcnt(0)
    s_barrier
    v_xor_b32 v1, 65536, v1
    v_xor_b32 v2, 65536, v2
    s_cmp_ge_u32 s27, 7
    s_cbranch_scc1 K0_NODMA
    s_lshl_b32 s44, s17, 11
    s_add_u32 s44, s44, s28
    s_lshl_b32 s45, s17, 10
    s_add_u32 s45, s45, s28
    s_add_u32 s45, s45, 32768
    s_lshl_b32 s42, s26, 5
    v_mfma_f32_32x32x16_bf16 a[0:15], v[64:67], v[48:51], a[0:15]
    ds_read_b128 v[16:19], v1 offset:0
    ds_read_b64_tr_b16 v[32:33], v2 offset:0
    ds_read_b64_tr_b16 v[34:35], v2 offset:512
    s_mov_b32 m0, s44
    s_nop 0
    buffer_load_dwordx4 v0, s[4:7], s34 offen lds
    buffer_load_dwordx4 v0, s[4:7], s34 offen offset:1024 lds
    s_add_u32 m0, s45, 0
    s_add_u32 s41, s25, s30
    buffer_load_dwordx4 v3, s[12:15], s41 offen lds
    v_mfma_f32_32x32x16_bf16 a[16:31], v[68:71], v[48:51], a[16:31]
    ds_read_b64_tr_b16 v[36:37], v2 offset:8192
    ds_read_b64_tr_b16 v[38:39], v2 offset:8704
    ds_read_b64_tr_b16 v[40:41], v2 offset:16384
    s_add_u32 m0, s45, 4096
    s_add_u32 s41, s41, s42
    buffer_load_dwordx4 v3, s[12:15], s41 offen lds
    s_add_u32 m0, s45, 8192
    s_add_u32 s41, s25, s31
    buffer_load_dwordx4 v3, s[12:15], s41 offen lds
    s_add_u32 m0, s45, 12288
    s_add_u32 s41, s41, s42
    buffer_load_dwordx4 v3, s[12:15], s41 offen lds
    v_mfma_f32_32x32x16_bf16 a[32:47], v[48:51], v[72:75], a[32:47]
    ds_read_b64_tr_b16 v[42:43], v2 offset:16896
    ds_read_b64_tr_b16 v[44:45], v2 offset:24576
    ds_read_b64_tr_b16 v[46:47], v2 offset:25088
    s_add_u32 m0, s45, 16384
    s_add_u32 s41, s25, s32
    buffer_load_dwordx4 v3, s[60:63], s41 offen lds
    s_add_u32 m0, s45, 20480
    s_add_u32 s41, s41, s42
    buffer_load_dwordx4 v3, s[60:63], s41 offen lds
    s_add_u32 m0, s45, 24576
    s_add_u32 s41, s25, s33
    buffer_load_dwordx4 v3, s[60:63], s41 offen lds
    v_mfma_f32_32x32x16_bf16 a[48:63], v[48:51], v[76:79], a[48:63]
    s_add_u32 m0, s45, 28672
    s_add_u32 s41, s41, s42
    buffer_load_dwordx4 v3, s[60:63], s41 offen lds
    s_add_u32 s34, s34, 4096
    s_lshl_b32 s43, s26, 6
    s_add_u32 s25, s25, s43
    s_xor_b32 s28, s28, 65536
    s_add_u32 s27, s27, 1
    s_branch K0_LOOP
K0_NODMA:
    s_cmp_ge_u32 s27, 8
    s_cbranch_scc1 K0_FIN
    v_mfma_f32_32x32x16_bf16 a[0:15], v[64:67], v[48:51], a[0:15]
    ds_read_b128 v[16:19], v1 offset:0
    ds_read_b64_tr_b16 v[32:33], v2 offset:0
    ds_read_b64_tr_b16 v[34:35], v2 offset:512
    v_mfma_f32_32x32x16_bf16 a[16:31], v[68:71], v[48:51], a[16:31]
    ds_read_b64_tr_b16 v[36:37], v2 offset:8192
    ds_read_b64_tr_b16 v[38:39], v2 offset:8704
    ds_read_b64_tr_b16 v[40:41], v2 offset:16384
    v_mfma_f32_32x32x16_bf16 a[32:47], v[48:51], v[72:75], a[32:47]
    ds_read_b64_tr_b16 v[42:43], v2 offset:16896
    ds_read_b64_tr_b16 v[44:45], v2 offset:24576
    ds_read_b64_tr_b16 v[46:47], v2 offset:25088
    v_mfma_f32_32x32x16_bf16 a[48:63], v[48:51], v[76:79], a[48:63]
    s_add_u32 s27, s27, 1
    s_branch K0_LOOP
K0_FIN:
    v_mfma_f32_32x32x16_bf16 a[0:15], v[64:67], v[48:51], a[0:15]
    v_mfma_f32_32x32x16_bf16 a[16:31], v[68:71], v[48:51], a[16:31]
    v_mfma_f32_32x32x16_bf16 a[32:47], v[48:51], v[72:75], a[32:47]
    v_mfma_f32_32x32x16_bf16 a[48:63], v[48:51], v[76:79], a[48:63]
    s_nop 15
    s_lshl_b32 s38, s37, 1
    s_add_u32 s38, s38, s35
    s_lshl_b32 s40, s22, 6
    s_add_u32 s38, s38, s40
    s_lshl_b32 s38, s38, 13
    s_lshl_b32 s40, s36, 11
    s_add_u32 s38, s38, s40
    s_add_u32 s41, s38, 4194304
    v_accvgpr_read_b32 v80, a0
    v_accvgpr_read_b32 v81, a1
    v_accvgpr_read_b32 v82, a2
    v_accvgpr_read_b32 v83, a3
    v_accvgpr_read_b32 v84, a4
    v_accvgpr_read_b32 v85, a5
    v_accvgpr_read_b32 v86, a6
    v_accvgpr_read_b32 v87, a7
    v_accvgpr_read_b32 v88, a8
    v_accvgpr_read_b32 v89, a9
    v_accvgpr_read_b32 v90, a10
    v_accvgpr_read_b32 v91, a11
    v_accvgpr_read_b32 v92, a12
    v_accvgpr_read_b32 v93, a13
    v_accvgpr_read_b32 v94, a14
    v_accvgpr_read_b32 v95, a15
    v_cvt_pk_bf16_f32 v96, v80, v81
    v_cvt_pk_bf16_f32 v97, v82, v83
    v_cvt_pk_bf16_f32 v98, v84, v85
    v_cvt_pk_bf16_f32 v99, v86, v87
    v_cvt_pk_bf16_f32 v100, v88, v89
    v_cvt_pk_bf16_f32 v101, v90, v91
    v_cvt_pk_bf16_f32 v102, v92, v93
    v_cvt_pk_bf16_f32 v103, v94, v95
    s_nop 0
    v_permlane32_swap_b32 v96, v98
    v_permlane32_swap_b32 v97, v99
    v_permlane32_swap_b32 v100, v102
    v_permlane32_swap_b32 v101, v103
    s_nop 0
    buffer_store_dwordx4 v[96:99], v0, s[4:7], s41 offen offset:0 sc1
    buffer_store_dwordx4 v[100:103], v0, s[4:7], s41 offen offset:1024 sc1
    s_add_u32 s41, s38, 4198400
    v_accvgpr_read_b32 v112, a16
    v_accvgpr_read_b32 v113, a17
    v_accvgpr_read_b32 v114, a18
    v_accvgpr_read_b32 v115, a19
    v_accvgpr_read_b32 v116, a20
    v_accvgpr_read_b32 v117, a21
    v_accvgpr_read_b32 v118, a22
    v_accvgpr_read_b32 v119, a23
    v_accvgpr_read_b32 v120, a24
    v_accvgpr_read_b32 v121, a25
    v_accvgpr_read_b32 v122, a26
    v_accvgpr_read_b32 v123, a27
    v_accvgpr_read_b32 v124, a28
    v_accvgpr_read_b32 v125, a29
    v_accvgpr_read_b32 v126, a30
    v_accvgpr_read_b32 v127, a31
    v_cvt_pk_bf16_f32 v128, v112, v113
    v_cvt_pk_bf16_f32 v129, v114, v115
    v_cvt_pk_bf16_f32 v130, v116, v117
    v_cvt_pk_bf16_f32 v131, v118, v119
    v_cvt_pk_bf16_f32 v132, v120, v121
    v_cvt_pk_bf16_f32 v133, v122, v123
    v_cvt_pk_bf16_f32 v134, v124, v125
    v_cvt_pk_bf16_f32 v135, v126, v127
    s_nop 0
    v_permlane32_swap_b32 v128, v130
    v_permlane32_swap_b32 v129, v131
    v_permlane32_swap_b32 v132, v134
    v_permlane32_swap_b32 v133, v135
    s_nop 0
    buffer_store_dwordx4 v[128:131], v0, s[4:7], s41 offen offset:0 sc1
    buffer_store_dwordx4 v[132:135], v0, s[4:7], s41 offen offset:1024 sc1
    s_add_u32 s41, s38, 20971520
    v_accvgpr_read_b32 v80, a32
    v_accvgpr_read_b32 v81, a33
    v_accvgpr_read_b32 v82, a34
    v_accvgpr_read_b32 v83, a35
    v_accvgpr_read_b32 v84, a36
    v_accvgpr_read_b32 v85, a37
    v_accvgpr_read_b32 v86, a38
    v_accvgpr_read_b32 v87, a39
    v_accvgpr_read_b32 v88, a40
    v_accvgpr_read_b32 v89, a41
    v_accvgpr_read_b32 v90, a42
    v_accvgpr_read_b32 v91, a43
    v_accvgpr_read_b32 v92, a44
    v_accvgpr_read_b32 v93, a45
    v_accvgpr_read_b32 v94, a46
    v_accvgpr_read_b32 v95, a47
    v_cvt_pk_bf16_f32 v96, v80, v81
    v_cvt_pk_bf16_f32 v97, v82, v83
    v_cvt_pk_bf16_f32 v100, v84, v85
    v_cvt_pk_bf16_f32 v101, v86, v87
    v_cvt_pk_bf16_f32 v98, v88, v89
    v_cvt_pk_bf16_f32 v99, v90, v91
    v_cvt_pk_bf16_f32 v102, v92, v93
    v_cvt_pk_bf16_f32 v103, v94, v95
    buffer_store_dwordx4 v[96:99], v4, s[4:7], s41 offen offset:0 sc1
    buffer_store_dwordx4 v[100:103], v4, s[4:7], s41 offen offset:512 sc1
    s_add_u32 s41, s38, 20975616
    v_accvgpr_read_b32 v112, a48
    v_accvgpr_read_b32 v113, a49
    v_accvgpr_read_b32 v114, a50
    v_accvgpr_read_b32 v115, a51
    v_accvgpr_read_b32 v116, a52
    v_accvgpr_read_b32 v117, a53
    v_accvgpr_read_b32 v118, a54
    v_accvgpr_read_b32 v119, a55
    v_accvgpr_read_b32 v120, a56
    v_accvgpr_read_b32 v121, a57
    v_accvgpr_read_b32 v122, a58
    v_accvgpr_read_b32 v123, a59
    v_accvgpr_read_b32 v124, a60
    v_accvgpr_read_b32 v125, a61
    v_accvgpr_read_b32 v126, a62
    v_accvgpr_read_b32 v127, a63
    v_cvt_pk_bf16_f32 v128, v112, v113
    v_cvt_pk_bf16_f32 v129, v114, v115
    v_cvt_pk_bf16_f32 v132, v116, v117
    v_cvt_pk_bf16_f32 v133, v118, v119
    v_cvt_pk_bf16_f32 v130, v120, v121
    v_cvt_pk_bf16_f32 v131, v122, v123
    v_cvt_pk_bf16_f32 v134, v124, v125
    v_cvt_pk_bf16_f32 v135, v126, v127
    buffer_store_dwordx4 v[128:131], v4, s[4:7], s41 offen offset:0 sc1
    buffer_store_dwordx4 v[132:135], v4, s[4:7], s41 offen offset:512 sc1
    s_lshl_b32 s41, s22, 2
    s_add_u32 s41, s41, s37
    s_lshl_b32 s40, s21, 8
    s_add_u32 s40, s40, s41
    s_lshl_b32 s40, s40, 2
    s_add_u32 s40, s40, 64561152
    s_waitcnt vmcnt(0)
    s_waitcnt vmcnt(0)
    s_barrier
    s_cmp_lg_u32 s17, 0
    s_cbranch_scc1 SF_60
    v_mov_b32_e64 v250, 1
    buffer_store_dword v250, off, s[4:7], s40 sc1
SF_60:
    s_branch NEXT
DO_QG:
    s_cmp_eq_u32 s37, 1
    s_cbranch_scc1 QG_gu_61
    s_load_dwordx2 s[12:13], s[0:1], 16
    s_waitcnt lgkmcnt(0)
    s_and_b32 s13, s13, 0xffff
    s_mov_b32 s14, 4718592
    s_mov_b32 s15, 0x00020000
    s_load_dwordx2 s[60:61], s[0:1], 16
    s_waitcnt lgkmcnt(0)
    s_and_b32 s61, s61, 0xffff
    s_mov_b32 s62, 4718592
    s_mov_b32 s63, 0x00020000
    s_mov_b32 s26, 8192
    s_lshl_b32 s30, s22, 9
    s_add_u32 s31, s30, 128
    s_add_u32 s32, s30, 256
    s_add_u32 s33, s30, 384
    s_branch QG_c_62
QG_gu_61:
    s_load_dwordx2 s[12:13], s[0:1], 64
    s_waitcnt lgkmcnt(0)
    s_and_b32 s13, s13, 0xffff
    s_mov_b32 s14, 5308416
    s_mov_b32 s15, 0x00020000
    s_load_dwordx2 s[60:61], s[0:1], 72
    s_waitcnt lgkmcnt(0)
    s_and_b32 s61, s61, 0xffff
    s_mov_b32 s62, 5308416
    s_mov_b32 s63, 0x00020000
    s_mov_b32 s26, 9216
    s_lshl_b32 s30, s22, 8
    s_add_u32 s31, s30, 128
    s_mov_b32 s32, s30
    s_mov_b32 s33, s31
QG_c_62:
    s_mov_b32 s24, 36864
    s_mul_i32 s23, s21, 294912
    s_add_u32 s23, s23, 0
    v_mbcnt_lo_u32_b32 v8, -1, 0
    v_mbcnt_hi_u32_b32 v8, -1, v8
    s_lshr_b32 s35, s17, 1
    s_and_b32 s36, s17, 1
    v_lshlrev_b32 v0, 4, v8
    s_mul_i32 s40, s35, 16384
    v_add_u32 v1, s40, v0
    v_lshrrev_b32 v9, 5, v8
    v_bfe_u32 v10, v8, 2, 2
    v_lshl_add_u32 v9, v9, 3, v10
    v_lshlrev_b32 v2, 7, v9
    v_lshrrev_b32 v10, 1, v10
    v_xor_b32_e64 v10, s36, v10
    v_lshl_add_u32 v2, v10, 6, v2
    v_bfe_u32 v10, v8, 4, 1
    v_lshl_add_u32 v2, v10, 5, v2
    v_and_b32_e64 v11, 3, v8
    v_lshl_add_u32 v2, v11, 3, v2
    v_add_u32 v2, 32768, v2
    v_lshrrev_b32_e64 v9, 3, v8
    v_mul_lo_u32 v3, v9, s26
    v_bfe_u32 v9, v8, 4, 1
    v_lshlrev_b32 v9, 2, v9
    v_and_b32 v11, 7, v8
    v_xor_b32_e64 v9, v9, v11
    v_lshl_add_u32 v3, v9, 4, v3
    v_lshlrev_b32 v4, 10, v10
    v_and_b32 v11, 15, v8
    v_lshl_add_u32 v4, v11, 4, v4
    v_lshrrev_b32_e64 v9, 5, v8
    v_lshl_add_u32 v4, v9, 8, v4
    s_bitcmp1_b32 s98, s21
    s_cbranch_scc1 LNW_63
    s_lshl_b32 s40, s21, 2
    s_add_u32 s40, s40, 128
    v_mov_b32 v252, 163832
    s_cmp_lg_u32 s17, 0
    s_cbranch_scc1 LNB_66
    v_mov_b32 v250, s40
    s_mov_b32 s41, 0
    v_mov_b32 v253, 0
LNP_64:
    buffer_load_dword v251, v250, s[8:11], 0 offen sc1
    s_waitcnt vmcnt(0)
    v_cmp_le_u32 vcc, 8, v251
    s_cbranch_vccnz LNO_65
    v_cmp_eq_u32 vcc, 0, v251
    s_sleep 12
    s_cbranch_vccz LNP_64x
    s_sleep 30
LNP_64x:
    s_add_u32 s41, s41, 1
    s_cmp_lt_u32 s41, 40
    s_cbranch_scc1 LNP_64
    s_sub_u32 s19, s19, 64
    s_cselect_b32 s19, 0, s19
    s_cbranch_scc1 LNO_65
    v_mov_b32 v253, 1
LNO_65:
    ds_write_b32 v252, v253
    s_waitcnt lgkmcnt(0)
LNB_66:
    s_barrier
    ds_read_b32 v253, v252
    s_waitcnt lgkmcnt(0)
    v_readfirstlane_b32 s41, v253
    s_barrier
    s_cmp_eq_u32 s41, 1
    s_cbranch_scc1 LN_HELP
    s_bitset1_b32 s98, s21
LNW_63:
    s_lshl_b32 s40, s17, 1
    s_mul_i32 s40, s40, s24
    s_add_u32 s34, s23, s40
    s_and_b32 s40, s17, 0
    s_lshl_b32 s40, s40, 11
    s_add_u32 s34, s34, s40
    s_lshl_b32 s40, s17, 3
    s_mul_i32 s25, s40, s26
    s_mov_b32 s28, 0
    s_lshl_b32 s44, s17, 13
    s_add_u32 s44, s44, s28
    s_lshl_b32 s45, s17, 10
    s_add_u32 s45, s45, s28
    s_add_u32 s45, s45, 32768
    s_lshl_b32 s42, s26, 5
    s_add_u32 m0, s44, 0
    s_mov_b32 s40, s34
    buffer_load_dwordx4 v0, s[4:7], s40 offen lds
    buffer_load_dwordx4 v0, s[4:7], s40 offen offset:1024 lds
    buffer_load_dwordx4 v0, s[4:7], s40 offen offset:2048 lds
    buffer_load_dwordx4 v0, s[4:7], s40 offen offset:3072 lds
    s_add_u32 m0, s44, 4096
    s_add_u32 s40, s34, s24
    buffer_load_dwordx4 v0, s[4:7], s40 offen lds
    buffer_load_dwordx4 v0, s[4:7], s40 offen offset:1024 lds
    buffer_load_dwordx4 v0, s[4:7], s40 offen offset:2048 lds
    buffer_load_dwordx4 v0, s[4:7], s40 offen offset:3072 lds
    s_add_u32 m0, s45, 0
    s_add_u32 s41, s25, s30
    buffer_load_dwordx4 v3, s[12:15], s41 offen lds
    s_add_u32 m0, s45, 4096
    s_add_u32 s41, s41, s42
    buffer_load_dwordx4 v3, s[12:15], s41 offen lds
    s_add_u32 m0, s45, 8192
    s_add_u32 s41, s25, s31
    buffer_load_dwordx4 v3, s[12:15], s41 offen lds
    s_add_u32 m0, s45, 12288
    s_add_u32 s41, s41, s42
    buffer_load_dwordx4 v3, s[12:15], s41 offen lds
    s_add_u32 m0, s45, 16384
    s_add_u32 s41, s25, s32
    buffer_load_dwordx4 v3, s[60:63], s41 offen lds
    s_add_u32 m0, s45, 20480
    s_add_u32 s41, s41, s42
    buffer_load_dwordx4 v3, s[60:63], s41 offen lds
    s_add_u32 m0, s45, 24576
    s_add_u32 s41, s25, s33
    buffer_load_dwordx4 v3, s[60:63], s41 offen lds
    s_add_u32 m0, s45, 28672
    s_add_u32 s41, s41, s42
    buffer_load_dwordx4 v3, s[60:63], s41 offen lds
    s_add_u32 s34, s34, 4096
    s_lshl_b32 s43, s26, 6
    s_add_u32 s25, s25, s43
    s_xor_b32 s28, s28, 65536
    s_lshl_b32 s44, s17, 13
    s_add_u32 s44, s44, s28
    s_lshl_b32 s45, s17, 10
    s_add_u32 s45, s45, s28
    s_add_u32 s45, s45, 32768
    s_lshl_b32 s42, s26, 5
    s_add_u32 m0, s44, 0
    s_mov_b32 s40, s34
    s_nop 0
    buffer_load_dwordx4 v0, s[4:7], s40 offen lds
    buffer_load_dwordx4 v0, s[4:7], s40 offen offset:1024 lds
    buffer_load_dwordx4 v0, s[4:7], s40 offen offset:2048 lds
    buffer_load_dwordx4 v0, s[4:7], s40 offen offset:3072 lds
    s_add_u32 m0, s44, 4096
    s_add_u32 s40, s34, s24
    buffer_load_dwordx4 v0, s[4:7], s40 offen lds
    buffer_load_dwordx4 v0, s[4:7], s40 offen offset:1024 lds
    buffer_load_dwordx4 v0, s[4:7], s40 offen offset:2048 lds
    buffer_load_dwordx4 v0, s[4:7], s40 offen offset:3072 lds
    s_add_u32 m0, s45, 0
    s_add_u32 s41, s25, s30
    buffer_load_dwordx4 v3, s[12:15], s41 offen lds
    s_add_u32 m0, s45, 4096
    s_add_u32 s41, s41, s42
    buffer_load_dwordx4 v3, s[12:15], s41 offen lds
    s_add_u32 m0, s45, 8192
    s_add_u32 s41, s25, s31
    buffer_load_dwordx4 v3, s[12:15], s41 offen lds
    s_add_u32 m0, s45, 12288
    s_add_u32 s41, s41, s42
    buffer_load_dwordx4 v3, s[12:15], s41 offen lds
    s_add_u32 m0, s45, 16384
    s_add_u32 s41, s25, s32
    buffer_load_dwordx4 v3, s[60:63], s41 offen lds
    s_add_u32 m0, s45, 20480
    s_add_u32 s41, s41, s42
    buffer_load_dwordx4 v3, s[60:63], s41 offen lds
    s_add_u32 m0, s45, 24576
    s_add_u32 s41, s25, s33
    buffer_load_dwordx4 v3, s[60:63], s41 offen lds
    s_add_u32 m0, s45, 28672
    s_add_u32 s41, s41, s42
    buffer_load_dwordx4 v3, s[60:63], s41 offen lds
    s_add_u32 s34, s34, 4096
    s_lshl_b32 s43, s26, 6
    s_add_u32 s25, s25, s43
    s_xor_b32 s28, s28, 65536
    v_accvgpr_write_b32 a0, 0
    v_accvgpr_write_b32 a1, 0
    v_accvgpr_write_b32 a2, 0
    v_accvgpr_write_b32 a3, 0
    v_accvgpr_write_b32 a4, 0
    v_accvgpr_write_b32 a5, 0
    v_accvgpr_write_b32 a6, 0
    v_accvgpr_write_b32 a7, 0
    v_accvgpr_write_b32 a8, 0
    v_accvgpr_write_b32 a9, 0
    v_accvgpr_write_b32 a10, 0
    v_accvgpr_write_b32 a11, 0
    v_accvgpr_write_b32 a12, 0
    v_accvgpr_write_b32 a13, 0
    v_accvgpr_write_b32 a14, 0
    v_accvgpr_write_b32 a15, 0
    v_accvgpr_write_b32 a16, 0
    v_accvgpr_write_b32 a17, 0
    v_accvgpr_write_b32 a18, 0
    v_accvgpr_write_b32 a19, 0
    v_accvgpr_write_b32 a20, 0
    v_accvgpr_write_b32 a21, 0
    v_accvgpr_write_b32 a22, 0
    v_accvgpr_write_b32 a23, 0
    v_accvgpr_write_b32 a24, 0
    v_accvgpr_write_b32 a25, 0
    v_accvgpr_write_b32 a26, 0
    v_accvgpr_write_b32 a27, 0
    v_accvgpr_write_b32 a28, 0
    v_accvgpr_write_b32 a29, 0
    v_accvgpr_write_b32 a30, 0
    v_accvgpr_write_b32 a31, 0
    v_accvgpr_write_b32 a32, 0
    v_accvgpr_write_b32 a33, 0
    v_accvgpr_write_b32 a34, 0
    v_accvgpr_write_b32 a35, 0
    v_accvgpr_write_b32 a36, 0
    v_accvgpr_write_b32 a37, 0
    v_accvgpr_write_b32 a38, 0
    v_accvgpr_write_b32 a39, 0
    v_accvgpr_write_b32 a40, 0
    v_accvgpr_write_b32 a41, 0
    v_accvgpr_write_b32 a42, 0
    v_accvgpr_write_b32 a43, 0
    v_accvgpr_write_b32 a44, 0
    v_accvgpr_write_b32 a45, 0
    v_accvgpr_write_b32 a46, 0
    v_accvgpr_write_b32 a47, 0
    v_accvgpr_write_b32 a48, 0
    v_accvgpr_write_b32 a49, 0
    v_accvgpr_write_b32 a50, 0
    v_accvgpr_write_b32 a51, 0
    v_accvgpr_write_b32 a52, 0
    v_accvgpr_write_b32 a53, 0
    v_accvgpr_write_b32 a54, 0
    v_accvgpr_write_b32 a55, 0
    v_accvgpr_write_b32 a56, 0
    v_accvgpr_write_b32 a57, 0
    v_accvgpr_write_b32 a58, 0
    v_accvgpr_write_b32 a59, 0
    v_accvgpr_write_b32 a60, 0
    v_accvgpr_write_b32 a61, 0
    v_accvgpr_write_b32 a62, 0
    v_accvgpr_write_b32 a63, 0
    v_accvgpr_write_b32 a64, 0
    v_accvgpr_write_b32 a65, 0
    v_accvgpr_write_b32 a66, 0
    v_accvgpr_write_b32 a67, 0
    v_accvgpr_write_b32 a68, 0
    v_accvgpr_write_b32 a69, 0
    v_accvgpr_write_b32 a70, 0
    v_accvgpr_write_b32 a71, 0
    v_accvgpr_write_b32 a72, 0
    v_accvgpr_write_b32 a73, 0
    v_accvgpr_write_b32 a74, 0
    v_accvgpr_write_b32 a75, 0
    v_accvgpr_write_b32 a76, 0
    v_accvgpr_write_b32 a77, 0
    v_accvgpr_write_b32 a78, 0
    v_accvgpr_write_b32 a79, 0
    v_accvgpr_write_b32 a80, 0
    v_accvgpr_write_b32 a81, 0
    v_accvgpr_write_b32 a82, 0
    v_accvgpr_write_b32 a83, 0
    v_accvgpr_write_b32 a84, 0
    v_accvgpr_write_b32 a85, 0
    v_accvgpr_write_b32 a86, 0
    v_accvgpr_write_b32 a87, 0
    v_accvgpr_write_b32 a88, 0
    v_accvgpr_write_b32 a89, 0
    v_accvgpr_write_b32 a90, 0
    v_accvgpr_write_b32 a91, 0
    v_accvgpr_write_b32 a92, 0
    v_accvgpr_write_b32 a93, 0
    v_accvgpr_write_b32 a94, 0
    v_accvgpr_write_b32 a95, 0
    v_accvgpr_write_b32 a96, 0
    v_accvgpr_write_b32 a97, 0
    v_accvgpr_write_b32 a98, 0
    v_accvgpr_write_b32 a99, 0
    v_accvgpr_write_b32 a100, 0
    v_accvgpr_write_b32 a101, 0
    v_accvgpr_write_b32 a102, 0
    v_accvgpr_write_b32 a103, 0
    v_accvgpr_write_b32 a104, 0
    v_accvgpr_write_b32 a105, 0
    v_accvgpr_write_b32 a106, 0
    v_accvgpr_write_b32 a107, 0
    v_accvgpr_write_b32 a108, 0
    v_accvgpr_write_b32 a109, 0
    v_accvgpr_write_b32 a110, 0
    v_accvgpr_write_b32 a111, 0
    v_accvgpr_write_b32 a112, 0
    v_accvgpr_write_b32 a113, 0
    v_accvgpr_write_b32 a114, 0
    v_accvgpr_write_b32 a115, 0
    v_accvgpr_write_b32 a116, 0
    v_accvgpr_write_b32 a117, 0
    v_accvgpr_write_b32 a118, 0
    v_accvgpr_write_b32 a119, 0
    v_accvgpr_write_b32 a120, 0
    v_accvgpr_write_b32 a121, 0
    v_accvgpr_write_b32 a122, 0
    v_accvgpr_write_b32 a123, 0
    v_accvgpr_write_b32 a124, 0
    v_accvgpr_write_b32 a125, 0
    v_accvgpr_write_b32 a126, 0
    v_accvgpr_write_b32 a127, 0
    v_accvgpr_write_b32 a128, 0
    v_accvgpr_write_b32 a129, 0
    v_accvgpr_write_b32 a130, 0
    v_accvgpr_write_b32 a131, 0
    v_accvgpr_write_b32 a132, 0
    v_accvgpr_write_b32 a133, 0
    v_accvgpr_write_b32 a134, 0
    v_accvgpr_write_b32 a135, 0
    v_accvgpr_write_b32 a136, 0
    v_accvgpr_write_b32 a137, 0
    v_accvgpr_write_b32 a138, 0
    v_accvgpr_write_b32 a139, 0
    v_accvgpr_write_b32 a140, 0
    v_accvgpr_write_b32 a141, 0
    v_accvgpr_write_b32 a142, 0
    v_accvgpr_write_b32 a143, 0
    v_accvgpr_write_b32 a144, 0
    v_accvgpr_write_b32 a145, 0
    v_accvgpr_write_b32 a146, 0
    v_accvgpr_write_b32 a147, 0
    v_accvgpr_write_b32 a148, 0
    v_accvgpr_write_b32 a149, 0
    v_accvgpr_write_b32 a150, 0
    v_accvgpr_write_b32 a151, 0
    v_accvgpr_write_b32 a152, 0
    v_accvgpr_write_b32 a153, 0
    v_accvgpr_write_b32 a154, 0
    v_accvgpr_write_b32 a155, 0
    v_accvgpr_write_b32 a156, 0
    v_accvgpr_write_b32 a157, 0
    v_accvgpr_write_b32 a158, 0
    v_accvgpr_write_b32 a159, 0
    v_accvgpr_write_b32 a160, 0
    v_accvgpr_write_b32 a161, 0
    v_accvgpr_write_b32 a162, 0
    v_accvgpr_write_b32 a163, 0
    v_accvgpr_write_b32 a164, 0
    v_accvgpr_write_b32 a165, 0
    v_accvgpr_write_b32 a166, 0
    v_accvgpr_write_b32 a167, 0
    v_accvgpr_write_b32 a168, 0
    v_accvgpr_write_b32 a169, 0
    v_accvgpr_write_b32 a170, 0
    v_accvgpr_write_b32 a171, 0
    v_accvgpr_write_b32 a172, 0
    v_accvgpr_write_b32 a173, 0
    v_accvgpr_write_b32 a174, 0
    v_accvgpr_write_b32 a175, 0
    v_accvgpr_write_b32 a176, 0
    v_accvgpr_write_b32 a177, 0
    v_accvgpr_write_b32 a178, 0
    v_accvgpr_write_b32 a179, 0
    v_accvgpr_write_b32 a180, 0
    v_accvgpr_write_b32 a181, 0
    v_accvgpr_write_b32 a182, 0
    v_accvgpr_write_b32 a183, 0
    v_accvgpr_write_b32 a184, 0
    v_accvgpr_write_b32 a185, 0
    v_accvgpr_write_b32 a186, 0
    v_accvgpr_write_b32 a187, 0
    v_accvgpr_write_b32 a188, 0
    v_accvgpr_write_b32 a189, 0
    v_accvgpr_write_b32 a190, 0
    v_accvgpr_write_b32 a191, 0
    v_accvgpr_write_b32 a192, 0
    v_accvgpr_write_b32 a193, 0
    v_accvgpr_write_b32 a194, 0
    v_accvgpr_write_b32 a195, 0
    v_accvgpr_write_b32 a196, 0
    v_accvgpr_write_b32 a197, 0
    v_accvgpr_write_b32 a198, 0
    v_accvgpr_write_b32 a199, 0
    v_accvgpr_write_b32 a200, 0
    v_accvgpr_write_b32 a201, 0
    v_accvgpr_write_b32 a202, 0
    v_accvgpr_write_b32 a203, 0
    v_accvgpr_write_b32 a204, 0
    v_accvgpr_write_b32 a205, 0
    v_accvgpr_write_b32 a206, 0
    v_accvgpr_write_b32 a207, 0
    v_accvgpr_write_b32 a208, 0
    v_accvgpr_write_b32 a209, 0
    v_accvgpr_write_b32 a210, 0
    v_accvgpr_write_b32 a211, 0
    v_accvgpr_write_b32 a212, 0
    v_accvgpr_write_b32 a213, 0
    v_accvgpr_write_b32 a214, 0
    v_accvgpr_write_b32 a215, 0
    v_accvgpr_write_b32 a216, 0
    v_accvgpr_write_b32 a217, 0
    v_accvgpr_write_b32 a218, 0
    v_accvgpr_write_b32 a219, 0
    v_accvgpr_write_b32 a220, 0
    v_accvgpr_write_b32 a221, 0
    v_accvgpr_write_b32 a222, 0
    v_accvgpr_write_b32 a223, 0
    v_accvgpr_write_b32 a224, 0
    v_accvgpr_write_b32 a225, 0
    v_accvgpr_write_b32 a226, 0
    v_accvgpr_write_b32 a227, 0
    v_accvgpr_write_b32 a228, 0
    v_accvgpr_write_b32 a229, 0
    v_accvgpr_write_b32 a230, 0
    v_accvgpr_write_b32 a231, 0
    v_accvgpr_write_b32 a232, 0
    v_accvgpr_write_b32 a233, 0
    v_accvgpr_write_b32 a234, 0
    v_accvgpr_write_b32 a235, 0
    v_accvgpr_write_b32 a236, 0
    v_accvgpr_write_b32 a237, 0
    v_accvgpr_write_b32 a238, 0
    v_accvgpr_write_b32 a239, 0
    v_accvgpr_write_b32 a240, 0
    v_accvgpr_write_b32 a241, 0
    v_accvgpr_write_b32 a242, 0
    v_accvgpr_write_b32 a243, 0
    v_accvgpr_write_b32 a244, 0
    v_accvgpr_write_b32 a245, 0
    v_accvgpr_write_b32 a246, 0
    v_accvgpr_write_b32 a247, 0
    v_accvgpr_write_b32 a248, 0
    v_accvgpr_write_b32 a249, 0
    v_accvgpr_write_b32 a250, 0
    v_accvgpr_write_b32 a251, 0
    v_accvgpr_write_b32 a252, 0
    v_accvgpr_write_b32 a253, 0
    v_accvgpr_write_b32 a254, 0
    v_accvgpr_write_b32 a255, 0
    s_waitcnt vmcnt(16)
    s_barrier
    ds_read_b128 v[16:19], v1 offset:0
    ds_read_b64_tr_b16 v[32:33], v2 offset:0
    ds_read_b64_tr_b16 v[34:35], v2 offset:512
    ds_read_b64_tr_b16 v[36:37], v2 offset:8192
    ds_read_b64_tr_b16 v[38:39], v2 offset:8704
    ds_read_b64_tr_b16 v[40:41], v2 offset:16384
    ds_read_b64_tr_b16 v[42:43], v2 offset:16896
    ds_read_b64_tr_b16 v[44:45], v2 offset:24576
    ds_read_b64_tr_b16 v[46:47], v2 offset:25088
    ds_read_b128 v[20:23], v1 offset:4096
    ds_read_b128 v[24:27], v1 offset:8192
    ds_read_b128 v[28:31], v1 offset:12288
    s_mov_b32 s27, 0
QG_LOOP:
    s_waitcnt lgkmcnt(0)
    v_mfma_f32_32x32x16_bf16 a[0:15], v[32:35], v[16:19], a[0:15]
    ds_read_b128 v[48:51], v1 offset:1024
    v_mfma_f32_32x32x16_bf16 a[16:31], v[36:39], v[16:19], a[16:31]
    ds_read_b64_tr_b16 v[64:65], v2 offset:2048
    v_mfma_f32_32x32x16_bf16 a[32:47], v[40:43], v[16:19], a[32:47]
    ds_read_b64_tr_b16 v[66:67], v2 offset:2560
    v_mfma_f32_32x32x16_bf16 a[48:63], v[44:47], v[16:19], a[48:63]
    ds_read_b64_tr_b16 v[68:69], v2 offset:10240
    v_mfma_f32_32x32x16_bf16 a[64:79], v[32:35], v[20:23], a[64:79]
    ds_read_b64_tr_b16 v[70:71], v2 offset:10752
    v_mfma_f32_32x32x16_bf16 a[80:95], v[36:39], v[20:23], a[80:95]
    ds_read_b64_tr_b16 v[72:73], v2 offset:18432
    v_mfma_f32_32x32x16_bf16 a[96:111], v[40:43], v[20:23], a[96:111]
    ds_read_b64_tr_b16 v[74:75], v2 offset:18944
    v_mfma_f32_32x32x16_bf16 a[112:127], v[44:47], v[20:23], a[112:127]
    ds_read_b64_tr_b16 v[76:77], v2 offset:26624
    v_mfma_f32_32x32x16_bf16 a[128:143], v[32:35], v[24:27], a[128:143]
    ds_read_b64_tr_b16 v[78:79], v2 offset:27136
    v_mfma_f32_32x32x16_bf16 a[144:159], v[36:39], v[24:27], a[144:159]
    ds_read_b128 v[52:55], v1 offset:5120
    v_mfma_f32_32x32x16_bf16 a[160:175], v[40:43], v[24:27], a[160:175]
    ds_read_b128 v[56:59], v1 offset:9216
    v_mfma_f32_32x32x16_bf16 a[176:191], v[44:47], v[24:27], a[176:191]
    ds_read_b128 v[60:63], v1 offset:13312
    v_mfma_f32_32x32x16_bf16 a[192:207], v[32:35], v[28:31], a[192:207]
    v_mfma_f32_32x32x16_bf16 a[208:223], v[36:39], v[28:31], a[208:223]
    v_mfma_f32_32x32x16_bf16 a[224:239], v[40:43], v[28:31], a[224:239]
    v_mfma_f32_32x32x16_bf16 a[240:255], v[44:47], v[28:31], a[240:255]
    s_waitcnt lgkmcnt(0)
    v_mfma_f32_32x32x16_bf16 a[0:15], v[64:67], v[48:51], a[0:15]
    ds_read_b128 v[16:19], v1 offset:2048
    v_mfma_f32_32x32x16_bf16 a[16:31], v[68:71], v[48:51], a[16:31]
    ds_read_b64_tr_b16 v[32:33], v2 offset:4096
    v_mfma_f32_32x32x16_bf16 a[32:47], v[72:75], v[48:51], a[32:47]
    ds_read_b64_tr_b16 v[34:35], v2 offset:4608
    v_mfma_f32_32x32x16_bf16 a[48:63], v[76:79], v[48:51], a[48:63]
    ds_read_b64_tr_b16 v[36:37], v2 offset:12288
    v_mfma_f32_32x32x16_bf16 a[64:79], v[64:67], v[52:55], a[64:79]
    ds_read_b64_tr_b16 v[38:39], v2 offset:12800
    v_mfma_f32_32x32x16_bf16 a[80:95], v[68:71], v[52:55], a[80:95]
    ds_read_b64_tr_b16 v[40:41], v2 offset:20480
    v_mfma_f32_32x32x16_bf16 a[96:111], v[72:75], v[52:55], a[96:111]
    ds_read_b64_tr_b16 v[42:43], v2 offset:20992
    v_mfma_f32_32x32x16_bf16 a[112:127], v[76:79], v[52:55], a[112:127]
    ds_read_b64_tr_b16 v[44:45], v2 offset:28672
    v_mfma_f32_32x32x16_bf16 a[128:143], v[64:67], v[56:59], a[128:143]
    ds_read_b64_tr_b16 v[46:47], v2 offset:29184
    v_mfma_f32_32x32x16_bf16 a[144:159], v[68:71], v[56:59], a[144:159]
    ds_read_b128 v[20:23], v1 offset:6144
    v_mfma_f32_32x32x16_bf16 a[160:175], v[72:75], v[56:59], a[160:175]
    ds_read_b128 v[24:27], v1 offset:10240
    v_mfma_f32_32x32x16_bf16 a[176:191], v[76:79], v[56:59], a[176:191]
    ds_read_b128 v[28:31], v1 offset:14336
    v_mfma_f32_32x32x16_bf16 a[192:207], v[64:67], v[60:63], a[192:207]
    v_mfma_f32_32x32x16_bf16 a[208:223], v[68:71], v[60:63], a[208:223]
    v_mfma_f32_32x32x16_bf16 a[224:239], v[72:75], v[60:63], a[224:239]
    v_mfma_f32_32x32x16_bf16 a[240:255], v[76:79], v[60:63], a[240:255]
    s_waitcnt lgkmcnt(0)
    v_mfma_f32_32x32x16_bf16 a[0:15], v[32:35], v[16:19], a[0:15]
    ds_read_b128 v[48:51], v1 offset:3072
    v_mfma_f32_32x32x16_bf16 a[16:31], v[36:39], v[16:19], a[16:31]
    ds_read_b64_tr_b16 v[64:65], v2 offset:6144
    v_mfma_f32_32x32x16_bf16 a[32:47], v[40:43], v[16:19], a[32:47]
    ds_read_b64_tr_b16 v[66:67], v2 offset:6656
    v_mfma_f32_32x32x16_bf16 a[48:63], v[44:47], v[16:19], a[48:63]
    ds_read_b64_tr_b16 v[68:69], v2 offset:14336
    v_mfma_f32_32x32x16_bf16 a[64:79], v[32:35], v[20:23], a[64:79]
    ds_read_b64_tr_b16 v[70:71], v2 offset:14848
    v_mfma_f32_32x32x16_bf16 a[80:95], v[36:39], v[20:23], a[80:95]
    ds_read_b64_tr_b16 v[72:73], v2 offset:22528
    v_mfma_f32_32x32x16_bf16 a[96:111], v[40:43], v[20:23], a[96:111]
    ds_read_b64_tr_b16 v[74:75], v2 offset:23040
    v_mfma_f32_32x32x16_bf16 a[112:127], v[44:47], v[20:23], a[112:127]
    ds_read_b64_tr_b16 v[76:77], v2 offset:30720
    v_mfma_f32_32x32x16_bf16 a[128:143], v[32:35], v[24:27], a[128:143]
    ds_read_b64_tr_b16 v[78:79], v2 offset:31232
    v_mfma_f32_32x32x16_bf16 a[144:159], v[36:39], v[24:27], a[144:159]
    ds_read_b128 v[52:55], v1 offset:7168
    v_mfma_f32_32x32x16_bf16 a[160:175], v[40:43], v[24:27], a[160:175]
    ds_read_b128 v[56:59], v1 offset:11264
    v_mfma_f32_32x32x16_bf16 a[176:191], v[44:47], v[24:27], a[176:191]
    ds_read_b128 v[60:63], v1 offset:15360
    v_mfma_f32_32x32x16_bf16 a[192:207], v[32:35], v[28:31], a[192:207]
    v_mfma_f32_32x32x16_bf16 a[208:223], v[36:39], v[28:31], a[208:223]
    v_mfma_f32_32x32x16_bf16 a[224:239], v[40:43], v[28:31], a[224:239]
    v_mfma_f32_32x32x16_bf16 a[240:255], v[44:47], v[28:31], a[240:255]
    s_waitcnt vmcnt(0) lgkmcnt(0)
    s_barrier
    v_xor_b32 v1, 65536, v1
    v_xor_b32 v2, 65536, v2
    s_cmp_ge_u32 s27, 7
    s_cbranch_scc1 QG_NODMA
    s_lshl_b32 s44, s17, 13
    s_add_u32 s44, s44, s28
    s_lshl_b32 s45, s17, 10
    s_add_u32 s45, s45, s28
    s_add_u32 s45, s45, 32768
    s_lshl_b32 s42, s26, 5
    v_mfma_f32_32x32x16_bf16 a[0:15], v[64:67], v[48:51], a[0:15]
    ds_read_b128 v[16:19], v1 offset:0
    s_add_u32 m0, s44, 0
    s_mov_b32 s40, s34
    buffer_load_dwordx4 v0, s[4:7], s40 offen lds
    v_mfma_f32_32x32x16_bf16 a[16:31], v[68:71], v[48:51], a[16:31]
    ds_read_b64_tr_b16 v[32:33], v2 offset:0
    buffer_load_dwordx4 v0, s[4:7], s40 offen offset:1024 lds
    v_mfma_f32_32x32x16_bf16 a[32:47], v[72:75], v[48:51], a[32:47]
    ds_read_b64_tr_b16 v[34:35], v2 offset:512
    buffer_load_dwordx4 v0, s[4:7], s40 offen offset:2048 lds
    v_mfma_f32_32x32x16_bf16 a[48:63], v[76:79], v[48:51], a[48:63]
    ds_read_b64_tr_b16 v[36:37], v2 offset:8192
    buffer_load_dwordx4 v0, s[4:7], s40 offen offset:3072 lds
    v_mfma_f32_32x32x16_bf16 a[64:79], v[64:67], v[52:55], a[64:79]
    ds_read_b64_tr_b16 v[38:39], v2 offset:8704
    s_add_u32 m0, s44, 4096
    s_add_u32 s40, s34, s24
    buffer_load_dwordx4 v0, s[4:7], s40 offen lds
    v_mfma_f32_32x32x16_bf16 a[80:95], v[68:71], v[52:55], a[80:95]
    ds_read_b64_tr_b16 v[40:41], v2 offset:16384
    buffer_load_dwordx4 v0, s[4:7], s40 offen offset:1024 lds
    v_mfma_f32_32x32x16_bf16 a[96:111], v[72:75], v[52:55], a[96:111]
    ds_read_b64_tr_b16 v[42:43], v2 offset:16896
    buffer_load_dwordx4 v0, s[4:7], s40 offen offset:2048 lds
    v_mfma_f32_32x32x16_bf16 a[112:127], v[76:79], v[52:55], a[112:127]
    ds_read_b64_tr_b16 v[44:45], v2 offset:24576
    buffer_load_dwordx4 v0, s[4:7], s40 offen offset:3072 lds
    v_mfma_f32_32x32x16_bf16 a[128:143], v[64:67], v[56:59], a[128:143]
    ds_read_b64_tr_b16 v[46:47], v2 offset:25088
    s_add_u32 m0, s45, 0
    s_add_u32 s41, s25, s30
    buffer_load_dwordx4 v3, s[12:15], s41 offen lds
    v_mfma_f32_32x32x16_bf16 a[144:159], v[68:71], v[56:59], a[144:159]
    ds_read_b128 v[20:23], v1 offset:4096
    s_add_u32 m0, s45, 4096
    s_add_u32 s41, s41, s42
    buffer_load_dwordx4 v3, s[12:15], s41 offen lds
    v_mfma_f32_32x32x16_bf16 a[160:175], v[72:75], v[56:59], a[160:175]
    ds_read_b128 v[24:27], v1 offset:8192
    s_add_u32 m0, s45, 8192
    s_add_u32 s41, s25, s31
    buffer_load_dwordx4 v3, s[12:15], s41 offen lds
    v_mfma_f32_32x32x16_bf16 a[176:191], v[76:79], v[56:59], a[176:191]
    ds_read_b128 v[28:31], v1 offset:12288
    s_add_u32 m0, s45, 12288
    s_add_u32 s41, s41, s42
    buffer_load_dwordx4 v3, s[12:15], s41 offen lds
    v_mfma_f32_32x32x16_bf16 a[192:207], v[64:67], v[60:63], a[192:207]
    s_add_u32 m0, s45, 16384
    s_add_u32 s41, s25, s32
    buffer_load_dwordx4 v3, s[60:63], s41 offen lds
    v_mfma_f32_32x32x16_bf16 a[208:223], v[68:71], v[60:63], a[208:223]
    s_add_u32 m0, s45, 20480
    s_add_u32 s41, s41, s42
    buffer_load_dwordx4 v3, s[60:63], s41 offen lds
    v_mfma_f32_32x32x16_bf16 a[224:239], v[72:75], v[60:63], a[224:239]
    s_add_u32 m0, s45, 24576
    s_add_u32 s41, s25, s33
    buffer_load_dwordx4 v3, s[60:63], s41 offen lds
    v_mfma_f32_32x32x16_bf16 a[240:255], v[76:79], v[60:63], a[240:255]
    s_add_u32 m0, s45, 28672
    s_add_u32 s41, s41, s42
    buffer_load_dwordx4 v3, s[60:63], s41 offen lds
    s_add_u32 s34, s34, 4096
    s_lshl_b32 s43, s26, 6
    s_add_u32 s25, s25, s43
    s_xor_b32 s28, s28, 65536
    s_add_u32 s27, s27, 1
    s_branch QG_LOOP
QG_NODMA:
    s_cmp_ge_u32 s27, 8
    s_cbranch_scc1 QG_FIN
    v_mfma_f32_32x32x16_bf16 a[0:15], v[64:67], v[48:51], a[0:15]
    ds_read_b128 v[16:19], v1 offset:0
    v_mfma_f32_32x32x16_bf16 a[16:31], v[68:71], v[48:51], a[16:31]
    ds_read_b64_tr_b16 v[32:33], v2 offset:0
    v_mfma_f32_32x32x16_bf16 a[32:47], v[72:75], v[48:51], a[32:47]
    ds_read_b64_tr_b16 v[34:35], v2 offset:512
    v_mfma_f32_32x32x16_bf16 a[48:63], v[76:79], v[48:51], a[48:63]
    ds_read_b64_tr_b16 v[36:37], v2 offset:8192
    v_mfma_f32_32x32x16_bf16 a[64:79], v[64:67], v[52:55], a[64:79]
    ds_read_b64_tr_b16 v[38:39], v2 offset:8704
    v_mfma_f32_32x32x16_bf16 a[80:95], v[68:71], v[52:55], a[80:95]
    ds_read_b64_tr_b16 v[40:41], v2 offset:16384
    v_mfma_f32_32x32x16_bf16 a[96:111], v[72:75], v[52:55], a[96:111]
    ds_read_b64_tr_b16 v[42:43], v2 offset:16896
    v_mfma_f32_32x32x16_bf16 a[112:127], v[76:79], v[52:55], a[112:127]
    ds_read_b64_tr_b16 v[44:45], v2 offset:24576
    v_mfma_f32_32x32x16_bf16 a[128:143], v[64:67], v[56:59], a[128:143]
    ds_read_b64_tr_b16 v[46:47], v2 offset:25088
    v_mfma_f32_32x32x16_bf16 a[144:159], v[68:71], v[56:59], a[144:159]
    ds_read_b128 v[20:23], v1 offset:4096
    v_mfma_f32_32x32x16_bf16 a[160:175], v[72:75], v[56:59], a[160:175]
    ds_read_b128 v[24:27], v1 offset:8192
    v_mfma_f32_32x32x16_bf16 a[176:191], v[76:79], v[56:59], a[176:191]
    ds_read_b128 v[28:31], v1 offset:12288
    v_mfma_f32_32x32x16_bf16 a[192:207], v[64:67], v[60:63], a[192:207]
    v_mfma_f32_32x32x16_bf16 a[208:223], v[68:71], v[60:63], a[208:223]
    v_mfma_f32_32x32x16_bf16 a[224:239], v[72:75], v[60:63], a[224:239]
    v_mfma_f32_32x32x16_bf16 a[240:255], v[76:79], v[60:63], a[240:255]
    s_add_u32 s27, s27, 1
    s_branch QG_LOOP
QG_FIN:
    v_mfma_f32_32x32x16_bf16 a[0:15], v[64:67], v[48:51], a[0:15]
    v_mfma_f32_32x32x16_bf16 a[16:31], v[68:71], v[48:51], a[16:31]
    v_mfma_f32_32x32x16_bf16 a[32:47], v[72:75], v[48:51], a[32:47]
    v_mfma_f32_32x32x16_bf16 a[48:63], v[76:79], v[48:51], a[48:63]
    v_mfma_f32_32x32x16_bf16 a[64:79], v[64:67], v[52:55], a[64:79]
    v_mfma_f32_32x32x16_bf16 a[80:95], v[68:71], v[52:55], a[80:95]
    v_mfma_f32_32x32x16_bf16 a[96:111], v[72:75], v[52:55], a[96:111]
    v_mfma_f32_32x32x16_bf16 a[112:127], v[76:79], v[52:55], a[112:127]
    v_mfma_f32_32x32x16_bf16 a[128:143], v[64:67], v[56:59], a[128:143]
    v_mfma_f32_32x32x16_bf16 a[144:159], v[68:71], v[56:59], a[144:159]
    v_mfma_f32_32x32x16_bf16 a[160:175], v[72:75], v[56:59], a[160:175]
    v_mfma_f32_32x32x16_bf16 a[176:191], v[76:79], v[56:59], a[176:191]
    v_mfma_f32_32x32x16_bf16 a[192:207], v[64:67], v[60:63], a[192:207]
    v_mfma_f32_32x32x16_bf16 a[208:223], v[68:71], v[60:63], a[208:223]
    v_mfma_f32_32x32x16_bf16 a[224:239], v[72:75], v[60:63], a[224:239]
    v_mfma_f32_32x32x16_bf16 a[240:255], v[76:79], v[60:63], a[240:255]
    s_nop 15
    s_cmp_eq_u32 s37, 1
    s_cbranch_scc1 QG_egu_67
    s_lshl_b32 s38, s21, 3
    s_lshl_b32 s40, s35, 2
    s_add_u32 s38, s38, s40
    s_lshl_b32 s40, s22, 7
    s_add_u32 s38, s38, s40
    s_lshl_b32 s38, s38, 13
    s_lshl_b32 s40, s36, 11
    s_add_u32 s38, s38, s40
    s_add_u32 s41, s38, 37748736
    v_accvgpr_read_b32 v80, a0
    v_accvgpr_read_b32 v81, a1
    v_accvgpr_read_b32 v82, a2
    v_accvgpr_read_b32 v83, a3
    v_accvgpr_read_b32 v84, a4
    v_accvgpr_read_b32 v85, a5
    v_accvgpr_read_b32 v86, a6
    v_accvgpr_read_b32 v87, a7
    v_accvgpr_read_b32 v88, a8
    v_accvgpr_read_b32 v89, a9
    v_accvgpr_read_b32 v90, a10
    v_accvgpr_read_b32 v91, a11
    v_accvgpr_read_b32 v92, a12
    v_accvgpr_read_b32 v93, a13
    v_accvgpr_read_b32 v94, a14
    v_accvgpr_read_b32 v95, a15
    v_cvt_pk_bf16_f32 v96, v80, v81
    v_cvt_pk_bf16_f32 v97, v82, v83
    v_cvt_pk_bf16_f32 v98, v84, v85
    v_cvt_pk_bf16_f32 v99, v86, v87
    v_cvt_pk_bf16_f32 v100, v88, v89
    v_cvt_pk_bf16_f32 v101, v90, v91
    v_cvt_pk_bf16_f32 v102, v92, v93
    v_cvt_pk_bf16_f32 v103, v94, v95
    s_nop 0
    v_permlane32_swap_b32 v96, v98
    v_permlane32_swap_b32 v97, v99
    v_permlane32_swap_b32 v100, v102
    v_permlane32_swap_b32 v101, v103
    s_nop 0
    buffer_store_dwordx4 v[96:99], v0, s[4:7], s41 offen offset:0 sc1
    buffer_store_dwordx4 v[100:103], v0, s[4:7], s41 offen offset:1024 sc1
    s_add_u32 s41, s38, 37752832
    v_accvgpr_read_b32 v112, a16
    v_accvgpr_read_b32 v113, a17
    v_accvgpr_read_b32 v114, a18
    v_accvgpr_read_b32 v115, a19
    v_accvgpr_read_b32 v116, a20
    v_accvgpr_read_b32 v117, a21
    v_accvgpr_read_b32 v118, a22
    v_accvgpr_read_b32 v119, a23
    v_accvgpr_read_b32 v120, a24
    v_accvgpr_read_b32 v121, a25
    v_accvgpr_read_b32 v122, a26
    v_accvgpr_read_b32 v123, a27
    v_accvgpr_read_b32 v124, a28
    v_accvgpr_read_b32 v125, a29
    v_accvgpr_read_b32 v126, a30
    v_accvgpr_read_b32 v127, a31
    v_cvt_pk_bf16_f32 v128, v112, v113
    v_cvt_pk_bf16_f32 v129, v114, v115
    v_cvt_pk_bf16_f32 v130, v116, v117
    v_cvt_pk_bf16_f32 v131, v118, v119
    v_cvt_pk_bf16_f32 v132, v120, v121
    v_cvt_pk_bf16_f32 v133, v122, v123
    v_cvt_pk_bf16_f32 v134, v124, v125
    v_cvt_pk_bf16_f32 v135, v126, v127
    s_nop 0
    v_permlane32_swap_b32 v128, v130
    v_permlane32_swap_b32 v129, v131
    v_permlane32_swap_b32 v132, v134
    v_permlane32_swap_b32 v133, v135
    s_nop 0
    buffer_store_dwordx4 v[128:131], v0, s[4:7], s41 offen offset:0 sc1
    buffer_store_dwordx4 v[132:135], v0, s[4:7], s41 offen offset:1024 sc1
    s_add_u32 s41, s38, 38273024
    v_accvgpr_read_b32 v80, a32
    v_accvgpr_read_b32 v81, a33
    v_accvgpr_read_b32 v82, a34
    v_accvgpr_read_b32 v83, a35
    v_accvgpr_read_b32 v84, a36
    v_accvgpr_read_b32 v85, a37
    v_accvgpr_read_b32 v86, a38
    v_accvgpr_read_b32 v87, a39
    v_accvgpr_read_b32 v88, a40
    v_accvgpr_read_b32 v89, a41
    v_accvgpr_read_b32 v90, a42
    v_accvgpr_read_b32 v91, a43
    v_accvgpr_read_b32 v92, a44
    v_accvgpr_read_b32 v93, a45
    v_accvgpr_read_b32 v94, a46
    v_accvgpr_read_b32 v95, a47
    v_cvt_pk_bf16_f32 v96, v80, v81
    v_cvt_pk_bf16_f32 v97, v82, v83
    v_cvt_pk_bf16_f32 v98, v84, v85
    v_cvt_pk_bf16_f32 v99, v86, v87
    v_cvt_pk_bf16_f32 v100, v88, v89
    v_cvt_pk_bf16_f32 v101, v90, v91
    v_cvt_pk_bf16_f32 v102, v92, v93
    v_cvt_pk_bf16_f32 v103, v94, v95
    s_nop 0
    v_permlane32_swap_b32 v96, v98
    v_permlane32_swap_b32 v97, v99
    v_permlane32_swap_b32 v100, v102
    v_permlane32_swap_b32 v101, v103
    s_nop 0
    buffer_store_dwordx4 v[96:99], v0, s[4:7], s41 offen offset:0 sc1
    buffer_store_dwordx4 v[100:103], v0, s[4:7], s41 offen offset:1024 sc1
    s_add_u32 s41, s38, 38277120
    v_accvgpr_read_b32 v112, a48
    v_accvgpr_read_b32 v113, a49
    v_accvgpr_read_b32 v114, a50
    v_accvgpr_read_b32 v115, a51
    v_accvgpr_read_b32 v116, a52
    v_accvgpr_read_b32 v117, a53
    v_accvgpr_read_b32 v118, a54
    v_accvgpr_read_b32 v119, a55
    v_accvgpr_read_b32 v120, a56
    v_accvgpr_read_b32 v121, a57
    v_accvgpr_read_b32 v122, a58
    v_accvgpr_read_b32 v123, a59
    v_accvgpr_read_b32 v124, a60
    v_accvgpr_read_b32 v125, a61
    v_accvgpr_read_b32 v126, a62
    v_accvgpr_read_b32 v127, a63
    v_cvt_pk_bf16_f32 v128, v112, v113
    v_cvt_pk_bf16_f32 v129, v114, v115
    v_cvt_pk_bf16_f32 v130, v116, v117
    v_cvt_pk_bf16_f32 v131, v118, v119
    v_cvt_pk_bf16_f32 v132, v120, v121
    v_cvt_pk_bf16_f32 v133, v122, v123
    v_cvt_pk_bf16_f32 v134, v124, v125
    v_cvt_pk_bf16_f32 v135, v126, v127
    s_nop 0
    v_permlane32_swap_b32 v128, v130
    v_permlane32_swap_b32 v129, v131
    v_permlane32_swap_b32 v132, v134
    v_permlane32_swap_b32 v133, v135
    s_nop 0
    buffer_store_dwordx4 v[128:131], v0, s[4:7], s41 offen offset:0 sc1
    buffer_store_dwordx4 v[132:135], v0, s[4:7], s41 offen offset:1024 sc1
    s_add_u32 s41, s38, 37756928
    v_accvgpr_read_b32 v80, a64
    v_accvgpr_read_b32 v81, a65
    v_accvgpr_read_b32 v82, a66
    v_accvgpr_read_b32 v83, a67
    v_accvgpr_read_b32 v84, a68
    v_accvgpr_read_b32 v85, a69
    v_accvgpr_read_b32 v86, a70
    v_accvgpr_read_b32 v87, a71
    v_accvgpr_read_b32 v88, a72
    v_accvgpr_read_b32 v89, a73
    v_accvgpr_read_b32 v90, a74
    v_accvgpr_read_b32 v91, a75
    v_accvgpr_read_b32 v92, a76
    v_accvgpr_read_b32 v93, a77
    v_accvgpr_read_b32 v94, a78
    v_accvgpr_read_b32 v95, a79
    v_cvt_pk_bf16_f32 v96, v80, v81
    v_cvt_pk_bf16_f32 v97, v82, v83
    v_cvt_pk_bf16_f32 v98, v84, v85
    v_cvt_pk_bf16_f32 v99, v86, v87
    v_cvt_pk_bf16_f32 v100, v88, v89
    v_cvt_pk_bf16_f32 v101, v90, v91
    v_cvt_pk_bf16_f32 v102, v92, v93
    v_cvt_pk_bf16_f32 v103, v94, v95
    s_nop 0
    v_permlane32_swap_b32 v96, v98
    v_permlane32_swap_b32 v97, v99
    v_permlane32_swap_b32 v100, v102
    v_permlane32_swap_b32 v101, v103
    s_nop 0
    buffer_store_dwordx4 v[96:99], v0, s[4:7], s41 offen offset:0 sc1
    buffer_store_dwordx4 v[100:103], v0, s[4:7], s41 offen offset:1024 sc1
    s_add_u32 s41, s38, 37761024
    v_accvgpr_read_b32 v112, a80
    v_accvgpr_read_b32 v113, a81
    v_accvgpr_read_b32 v114, a82
    v_accvgpr_read_b32 v115, a83
    v_accvgpr_read_b32 v116, a84
    v_accvgpr_read_b32 v117, a85
    v_accvgpr_read_b32 v118, a86
    v_accvgpr_read_b32 v119, a87
    v_accvgpr_read_b32 v120, a88
    v_accvgpr_read_b32 v121, a89
    v_accvgpr_read_b32 v122, a90
    v_accvgpr_read_b32 v123, a91
    v_accvgpr_read_b32 v124, a92
    v_accvgpr_read_b32 v125, a93
    v_accvgpr_read_b32 v126, a94
    v_accvgpr_read_b32 v127, a95
    v_cvt_pk_bf16_f32 v128, v112, v113
    v_cvt_pk_bf16_f32 v129, v114, v115
    v_cvt_pk_bf16_f32 v130, v116, v117
    v_cvt_pk_bf16_f32 v131, v118, v119
    v_cvt_pk_bf16_f32 v132, v120, v121
    v_cvt_pk_bf16_f32 v133, v122, v123
    v_cvt_pk_bf16_f32 v134, v124, v125
    v_cvt_pk_bf16_f32 v135, v126, v127
    s_nop 0
    v_permlane32_swap_b32 v128, v130
    v_permlane32_swap_b32 v129, v131
    v_permlane32_swap_b32 v132, v134
    v_permlane32_swap_b32 v133, v135
    s_nop 0
    buffer_store_dwordx4 v[128:131], v0, s[4:7], s41 offen offset:0 sc1
    buffer_store_dwordx4 v[132:135], v0, s[4:7], s41 offen offset:1024 sc1
    s_add_u32 s41, s38, 38281216
    v_accvgpr_read_b32 v80, a96
    v_accvgpr_read_b32 v81, a97
    v_accvgpr_read_b32 v82, a98
    v_accvgpr_read_b32 v83, a99
    v_accvgpr_read_b32 v84, a100
    v_accvgpr_read_b32 v85, a101
    v_accvgpr_read_b32 v86, a102
    v_accvgpr_read_b32 v87, a103
    v_accvgpr_read_b32 v88, a104
    v_accvgpr_read_b32 v89, a105
    v_accvgpr_read_b32 v90, a106
    v_accvgpr_read_b32 v91, a107
    v_accvgpr_read_b32 v92, a108
    v_accvgpr_read_b32 v93, a109
    v_accvgpr_read_b32 v94, a110
    v_accvgpr_read_b32 v95, a111
    v_cvt_pk_bf16_f32 v96, v80, v81
    v_cvt_pk_bf16_f32 v97, v82, v83
    v_cvt_pk_bf16_f32 v98, v84, v85
    v_cvt_pk_bf16_f32 v99, v86, v87
    v_cvt_pk_bf16_f32 v100, v88, v89
    v_cvt_pk_bf16_f32 v101, v90, v91
    v_cvt_pk_bf16_f32 v102, v92, v93
    v_cvt_pk_bf16_f32 v103, v94, v95
    s_nop 0
    v_permlane32_swap_b32 v96, v98
    v_permlane32_swap_b32 v97, v99
    v_permlane32_swap_b32 v100, v102
    v_permlane32_swap_b32 v101, v103
    s_nop 0
    buffer_store_dwordx4 v[96:99], v0, s[4:7], s41 offen offset:0 sc1
    buffer_store_dwordx4 v[100:103], v0, s[4:7], s41 offen offset:1024 sc1
    s_add_u32 s41, s38, 38285312
    v_accvgpr_read_b32 v112, a112
    v_accvgpr_read_b32 v113, a113
    v_accvgpr_read_b32 v114, a114
    v_accvgpr_read_b32 v115, a115
    v_accvgpr_read_b32 v116, a116
    v_accvgpr_read_b32 v117, a117
    v_accvgpr_read_b32 v118, a118
    v_accvgpr_read_b32 v119, a119
    v_accvgpr_read_b32 v120, a120
    v_accvgpr_read_b32 v121, a121
    v_accvgpr_read_b32 v122, a122
    v_accvgpr_read_b32 v123, a123
    v_accvgpr_read_b32 v124, a124
    v_accvgpr_read_b32 v125, a125
    v_accvgpr_read_b32 v126, a126
    v_accvgpr_read_b32 v127, a127
    v_cvt_pk_bf16_f32 v128, v112, v113
    v_cvt_pk_bf16_f32 v129, v114, v115
    v_cvt_pk_bf16_f32 v130, v116, v117
    v_cvt_pk_bf16_f32 v131, v118, v119
    v_cvt_pk_bf16_f32 v132, v120, v121
    v_cvt_pk_bf16_f32 v133, v122, v123
    v_cvt_pk_bf16_f32 v134, v124, v125
    v_cvt_pk_bf16_f32 v135, v126, v127
    s_nop 0
    v_permlane32_swap_b32 v128, v130
    v_permlane32_swap_b32 v129, v131
    v_permlane32_swap_b32 v132, v134
    v_permlane32_swap_b32 v133, v135
    s_nop 0
    buffer_store_dwordx4 v[128:131], v0, s[4:7], s41 offen offset:0 sc1
    buffer_store_dwordx4 v[132:135], v0, s[4:7], s41 offen offset:1024 sc1
    s_add_u32 s41, s38, 37765120
    v_accvgpr_read_b32 v80, a128
    v_accvgpr_read_b32 v81, a129
    v_accvgpr_read_b32 v82, a130
    v_accvgpr_read_b32 v83, a131
    v_accvgpr_read_b32 v84, a132
    v_accvgpr_read_b32 v85, a133
    v_accvgpr_read_b32 v86, a134
    v_accvgpr_read_b32 v87, a135
    v_accvgpr_read_b32 v88, a136
    v_accvgpr_read_b32 v89, a137
    v_accvgpr_read_b32 v90, a138
    v_accvgpr_read_b32 v91, a139
    v_accvgpr_read_b32 v92, a140
    v_accvgpr_read_b32 v93, a141
    v_accvgpr_read_b32 v94, a142
    v_accvgpr_read_b32 v95, a143
    v_cvt_pk_bf16_f32 v96, v80, v81
    v_cvt_pk_bf16_f32 v97, v82, v83
    v_cvt_pk_bf16_f32 v98, v84, v85
    v_cvt_pk_bf16_f32 v99, v86, v87
    v_cvt_pk_bf16_f32 v100, v88, v89
    v_cvt_pk_bf16_f32 v101, v90, v91
    v_cvt_pk_bf16_f32 v102, v92, v93
    v_cvt_pk_bf16_f32 v103, v94, v95
    s_nop 0
    v_permlane32_swap_b32 v96, v98
    v_permlane32_swap_b32 v97, v99
    v_permlane32_swap_b32 v100, v102
    v_permlane32_swap_b32 v101, v103
    s_nop 0
    buffer_store_dwordx4 v[96:99], v0, s[4:7], s41 offen offset:0 sc1
    buffer_store_dwordx4 v[100:103], v0, s[4:7], s41 offen offset:1024 sc1
    s_add_u32 s41, s38, 37769216
    v_accvgpr_read_b32 v112, a144
    v_accvgpr_read_b32 v113, a145
    v_accvgpr_read_b32 v114, a146
    v_accvgpr_read_b32 v115, a147
    v_accvgpr_read_b32 v116, a148
    v_accvgpr_read_b32 v117, a149
    v_accvgpr_read_b32 v118, a150
    v_accvgpr_read_b32 v119, a151
    v_accvgpr_read_b32 v120, a152
    v_accvgpr_read_b32 v121, a153
    v_accvgpr_read_b32 v122, a154
    v_accvgpr_read_b32 v123, a155
    v_accvgpr_read_b32 v124, a156
    v_accvgpr_read_b32 v125, a157
    v_accvgpr_read_b32 v126, a158
    v_accvgpr_read_b32 v127, a159
    v_cvt_pk_bf16_f32 v128, v112, v113
    v_cvt_pk_bf16_f32 v129, v114, v115
    v_cvt_pk_bf16_f32 v130, v116, v117
    v_cvt_pk_bf16_f32 v131, v118, v119
    v_cvt_pk_bf16_f32 v132, v120, v121
    v_cvt_pk_bf16_f32 v133, v122, v123
    v_cvt_pk_bf16_f32 v134, v124, v125
    v_cvt_pk_bf16_f32 v135, v126, v127
    s_nop 0
    v_permlane32_swap_b32 v128, v130
    v_permlane32_swap_b32 v129, v131
    v_permlane32_swap_b32 v132, v134
    v_permlane32_swap_b32 v133, v135
    s_nop 0
    buffer_store_dwordx4 v[128:131], v0, s[4:7], s41 offen offset:0 sc1
    buffer_store_dwordx4 v[132:135], v0, s[4:7], s41 offen offset:1024 sc1
    s_add_u32 s41, s38, 38289408
    v_accvgpr_read_b32 v80, a160
    v_accvgpr_read_b32 v81, a161
    v_accvgpr_read_b32 v82, a162
    v_accvgpr_read_b32 v83, a163
    v_accvgpr_read_b32 v84, a164
    v_accvgpr_read_b32 v85, a165
    v_accvgpr_read_b32 v86, a166
    v_accvgpr_read_b32 v87, a167
    v_accvgpr_read_b32 v88, a168
    v_accvgpr_read_b32 v89, a169
    v_accvgpr_read_b32 v90, a170
    v_accvgpr_read_b32 v91, a171
    v_accvgpr_read_b32 v92, a172
    v_accvgpr_read_b32 v93, a173
    v_accvgpr_read_b32 v94, a174
    v_accvgpr_read_b32 v95, a175
    v_cvt_pk_bf16_f32 v96, v80, v81
    v_cvt_pk_bf16_f32 v97, v82, v83
    v_cvt_pk_bf16_f32 v98, v84, v85
    v_cvt_pk_bf16_f32 v99, v86, v87
    v_cvt_pk_bf16_f32 v100, v88, v89
    v_cvt_pk_bf16_f32 v101, v90, v91
    v_cvt_pk_bf16_f32 v102, v92, v93
    v_cvt_pk_bf16_f32 v103, v94, v95
    s_nop 0
    v_permlane32_swap_b32 v96, v98
    v_permlane32_swap_b32 v97, v99
    v_permlane32_swap_b32 v100, v102
    v_permlane32_swap_b32 v101, v103
    s_nop 0
    buffer_store_dwordx4 v[96:99], v0, s[4:7], s41 offen offset:0 sc1
    buffer_store_dwordx4 v[100:103], v0, s[4:7], s41 offen offset:1024 sc1
    s_add_u32 s41, s38, 38293504
    v_accvgpr_read_b32 v112, a176
    v_accvgpr_read_b32 v113, a177
    v_accvgpr_read_b32 v114, a178
    v_accvgpr_read_b32 v115, a179
    v_accvgpr_read_b32 v116, a180
    v_accvgpr_read_b32 v117, a181
    v_accvgpr_read_b32 v118, a182
    v_accvgpr_read_b32 v119, a183
    v_accvgpr_read_b32 v120, a184
    v_accvgpr_read_b32 v121, a185
    v_accvgpr_read_b32 v122, a186
    v_accvgpr_read_b32 v123, a187
    v_accvgpr_read_b32 v124, a188
    v_accvgpr_read_b32 v125, a189
    v_accvgpr_read_b32 v126, a190
    v_accvgpr_read_b32 v127, a191
    v_cvt_pk_bf16_f32 v128, v112, v113
    v_cvt_pk_bf16_f32 v129, v114, v115
    v_cvt_pk_bf16_f32 v130, v116, v117
    v_cvt_pk_bf16_f32 v131, v118, v119
    v_cvt_pk_bf16_f32 v132, v120, v121
    v_cvt_pk_bf16_f32 v133, v122, v123
    v_cvt_pk_bf16_f32 v134, v124, v125
    v_cvt_pk_bf16_f32 v135, v126, v127
    s_nop 0
    v_permlane32_swap_b32 v128, v130
    v_permlane32_swap_b32 v129, v131
    v_permlane32_swap_b32 v132, v134
    v_permlane32_swap_b32 v133, v135
    s_nop 0
    buffer_store_dwordx4 v[128:131], v0, s[4:7], s41 offen offset:0 sc1
    buffer_store_dwordx4 v[132:135], v0, s[4:7], s41 offen offset:1024 sc1
    s_add_u32 s41, s38, 37773312
    v_accvgpr_read_b32 v80, a192
    v_accvgpr_read_b32 v81, a193
    v_accvgpr_read_b32 v82, a194
    v_accvgpr_read_b32 v83, a195
    v_accvgpr_read_b32 v84, a196
    v_accvgpr_read_b32 v85, a197
    v_accvgpr_read_b32 v86, a198
    v_accvgpr_read_b32 v87, a199
    v_accvgpr_read_b32 v88, a200
    v_accvgpr_read_b32 v89, a201
    v_accvgpr_read_b32 v90, a202
    v_accvgpr_read_b32 v91, a203
    v_accvgpr_read_b32 v92, a204
    v_accvgpr_read_b32 v93, a205
    v_accvgpr_read_b32 v94, a206
    v_accvgpr_read_b32 v95, a207
    v_cvt_pk_bf16_f32 v96, v80, v81
    v_cvt_pk_bf16_f32 v97, v82, v83
    v_cvt_pk_bf16_f32 v98, v84, v85
    v_cvt_pk_bf16_f32 v99, v86, v87
    v_cvt_pk_bf16_f32 v100, v88, v89
    v_cvt_pk_bf16_f32 v101, v90, v91
    v_cvt_pk_bf16_f32 v102, v92, v93
    v_cvt_pk_bf16_f32 v103, v94, v95
    s_nop 0
    v_permlane32_swap_b32 v96, v98
    v_permlane32_swap_b32 v97, v99
    v_permlane32_swap_b32 v100, v102
    v_permlane32_swap_b32 v101, v103
    s_nop 0
    buffer_store_dwordx4 v[96:99], v0, s[4:7], s41 offen offset:0 sc1
    buffer_store_dwordx4 v[100:103], v0, s[4:7], s41 offen offset:1024 sc1
    s_add_u32 s41, s38, 37777408
    v_accvgpr_read_b32 v112, a208
    v_accvgpr_read_b32 v113, a209
    v_accvgpr_read_b32 v114, a210
    v_accvgpr_read_b32 v115, a211
    v_accvgpr_read_b32 v116, a212
    v_accvgpr_read_b32 v117, a213
    v_accvgpr_read_b32 v118, a214
    v_accvgpr_read_b32 v119, a215
    v_accvgpr_read_b32 v120, a216
    v_accvgpr_read_b32 v121, a217
    v_accvgpr_read_b32 v122, a218
    v_accvgpr_read_b32 v123, a219
    v_accvgpr_read_b32 v124, a220
    v_accvgpr_read_b32 v125, a221
    v_accvgpr_read_b32 v126, a222
    v_accvgpr_read_b32 v127, a223
    v_cvt_pk_bf16_f32 v128, v112, v113
    v_cvt_pk_bf16_f32 v129, v114, v115
    v_cvt_pk_bf16_f32 v130, v116, v117
    v_cvt_pk_bf16_f32 v131, v118, v119
    v_cvt_pk_bf16_f32 v132, v120, v121
    v_cvt_pk_bf16_f32 v133, v122, v123
    v_cvt_pk_bf16_f32 v134, v124, v125
    v_cvt_pk_bf16_f32 v135, v126, v127
    s_nop 0
    v_permlane32_swap_b32 v128, v130
    v_permlane32_swap_b32 v129, v131
    v_permlane32_swap_b32 v132, v134
    v_permlane32_swap_b32 v133, v135
    s_nop 0
    buffer_store_dwordx4 v[128:131], v0, s[4:7], s41 offen offset:0 sc1
    buffer_store_dwordx4 v[132:135], v0, s[4:7], s41 offen offset:1024 sc1
    s_add_u32 s41, s38, 38297600
    v_accvgpr_read_b32 v80, a224
    v_accvgpr_read_b32 v81, a225
    v_accvgpr_read_b32 v82, a226
    v_accvgpr_read_b32 v83, a227
    v_accvgpr_read_b32 v84, a228
    v_accvgpr_read_b32 v85, a229
    v_accvgpr_read_b32 v86, a230
    v_accvgpr_read_b32 v87, a231
    v_accvgpr_read_b32 v88, a232
    v_accvgpr_read_b32 v89, a233
    v_accvgpr_read_b32 v90, a234
    v_accvgpr_read_b32 v91, a235
    v_accvgpr_read_b32 v92, a236
    v_accvgpr_read_b32 v93, a237
    v_accvgpr_read_b32 v94, a238
    v_accvgpr_read_b32 v95, a239
    v_cvt_pk_bf16_f32 v96, v80, v81
    v_cvt_pk_bf16_f32 v97, v82, v83
    v_cvt_pk_bf16_f32 v98, v84, v85
    v_cvt_pk_bf16_f32 v99, v86, v87
    v_cvt_pk_bf16_f32 v100, v88, v89
    v_cvt_pk_bf16_f32 v101, v90, v91
    v_cvt_pk_bf16_f32 v102, v92, v93
    v_cvt_pk_bf16_f32 v103, v94, v95
    s_nop 0
    v_permlane32_swap_b32 v96, v98
    v_permlane32_swap_b32 v97, v99
    v_permlane32_swap_b32 v100, v102
    v_permlane32_swap_b32 v101, v103
    s_nop 0
    buffer_store_dwordx4 v[96:99], v0, s[4:7], s41 offen offset:0 sc1
    buffer_store_dwordx4 v[100:103], v0, s[4:7], s41 offen offset:1024 sc1
    s_add_u32 s41, s38, 38301696
    v_accvgpr_read_b32 v112, a240
    v_accvgpr_read_b32 v113, a241
    v_accvgpr_read_b32 v114, a242
    v_accvgpr_read_b32 v115, a243
    v_accvgpr_read_b32 v116, a244
    v_accvgpr_read_b32 v117, a245
    v_accvgpr_read_b32 v118, a246
    v_accvgpr_read_b32 v119, a247
    v_accvgpr_read_b32 v120, a248
    v_accvgpr_read_b32 v121, a249
    v_accvgpr_read_b32 v122, a250
    v_accvgpr_read_b32 v123, a251
    v_accvgpr_read_b32 v124, a252
    v_accvgpr_read_b32 v125, a253
    v_accvgpr_read_b32 v126, a254
    v_accvgpr_read_b32 v127, a255
    v_cvt_pk_bf16_f32 v128, v112, v113
    v_cvt_pk_bf16_f32 v129, v114, v115
    v_cvt_pk_bf16_f32 v130, v116, v117
    v_cvt_pk_bf16_f32 v131, v118, v119
    v_cvt_pk_bf16_f32 v132, v120, v121
    v_cvt_pk_bf16_f32 v133, v122, v123
    v_cvt_pk_bf16_f32 v134, v124, v125
    v_cvt_pk_bf16_f32 v135, v126, v127
    s_nop 0
    v_permlane32_swap_b32 v128, v130
    v_permlane32_swap_b32 v129, v131
    v_permlane32_swap_b32 v132, v134
    v_permlane32_swap_b32 v133, v135
    buffer_store_dwordx4 v[128:131], v0, s[4:7], s41 offen offset:0 sc1
    buffer_store_dwordx4 v[132:135], v0, s[4:7], s41 offen offset:1024 sc1
    s_lshl_b32 s40, s21, 8
    s_add_u32 s40, s40, s22
    s_lshl_b32 s40, s40, 2
    s_add_u32 s40, s40, 64553472
    s_waitcnt vmcnt(0)
    s_waitcnt vmcnt(0)
    s_barrier
    s_cmp_lg_u32 s17, 0
    s_cbranch_scc1 SF_69
    v_mov_b32 v250, 1
    buffer_store_dword v250, off, s[4:7], s40 sc1
SF_69:
    s_branch QG_end_68
QG_egu_67:
    v_mov_b32 v240, 0xc0135761
    v_mov_b32 v241, 0xc0135761
    v_mov_b32 v242, 0xbdd2d3e8
    v_mov_b32 v243, 0xbdd2d3e8
    v_mov_b32 v244, 1.0
    v_mov_b32 v245, 1.0
    s_lshl_b32 s38, s21, 3
    s_lshl_b32 s40, s35, 2
    s_add_u32 s38, s38, s40
    s_mul_i32 s38, s38, 576
    s_lshl_b32 s40, s22, 4
    s_add_u32 s38, s38, s40
    s_lshl_b32 s40, s36, 2
    s_add_u32 s38, s38, s40
    s_lshl_b32 s38, s38, 9
    s_nop 0
    s_add_u32 s41, s38, 67108864
    v_accvgpr_read_b32 v80, a0
    v_accvgpr_read_b32 v81, a1
    v_accvgpr_read_b32 v82, a2
    v_accvgpr_read_b32 v83, a3
    v_accvgpr_read_b32 v84, a4
    v_accvgpr_read_b32 v85, a5
    v_accvgpr_read_b32 v86, a6
    v_accvgpr_read_b32 v87, a7
    v_accvgpr_read_b32 v88, a8
    v_accvgpr_read_b32 v89, a9
    v_accvgpr_read_b32 v90, a10
    v_accvgpr_read_b32 v91, a11
    v_accvgpr_read_b32 v92, a12
    v_accvgpr_read_b32 v93, a13
    v_accvgpr_read_b32 v94, a14
    v_accvgpr_read_b32 v95, a15
    v_accvgpr_read_b32 v96, a32
    v_accvgpr_read_b32 v97, a33
    v_accvgpr_read_b32 v98, a34
    v_accvgpr_read_b32 v99, a35
    v_accvgpr_read_b32 v100, a36
    v_accvgpr_read_b32 v101, a37
    v_accvgpr_read_b32 v102, a38
    v_accvgpr_read_b32 v103, a39
    v_accvgpr_read_b32 v104, a40
    v_accvgpr_read_b32 v105, a41
    v_accvgpr_read_b32 v106, a42
    v_accvgpr_read_b32 v107, a43
    v_accvgpr_read_b32 v108, a44
    v_accvgpr_read_b32 v109, a45
    v_accvgpr_read_b32 v110, a46
    v_accvgpr_read_b32 v111, a47
    v_pk_mul_f32 v[112:113], v[80:81], v[80:81]
    v_pk_mul_f32 v[114:115], v[82:83], v[82:83]
    v_pk_mul_f32 v[116:117], v[84:85], v[84:85]
    v_pk_mul_f32 v[118:119], v[86:87], v[86:87]
    v_pk_mul_f32 v[120:121], v[88:89], v[88:89]
    v_pk_mul_f32 v[122:123], v[90:91], v[90:91]
    v_pk_mul_f32 v[124:125], v[92:93], v[92:93]
    v_pk_mul_f32 v[126:127], v[94:95], v[94:95]
    v_pk_fma_f32 v[112:113], v[112:113], v[242:243], v[240:241]
    v_pk_fma_f32 v[114:115], v[114:115], v[242:243], v[240:241]
    v_pk_fma_f32 v[116:117], v[116:117], v[242:243], v[240:241]
    v_pk_fma_f32 v[118:119], v[118:119], v[242:243], v[240:241]
    v_pk_fma_f32 v[120:121], v[120:121], v[242:243], v[240:241]
    v_pk_fma_f32 v[122:123], v[122:123], v[242:243], v[240:241]
    v_pk_fma_f32 v[124:125], v[124:125], v[242:243], v[240:241]
    v_pk_fma_f32 v[126:127], v[126:127], v[242:243], v[240:241]
    v_pk_mul_f32 v[112:113], v[112:113], v[80:81]
    v_pk_mul_f32 v[114:115], v[114:115], v[82:83]
    v_pk_mul_f32 v[116:117], v[116:117], v[84:85]
    v_pk_mul_f32 v[118:119], v[118:119], v[86:87]
    v_pk_mul_f32 v[120:121], v[120:121], v[88:89]
    v_pk_mul_f32 v[122:123], v[122:123], v[90:91]
    v_pk_mul_f32 v[124:125], v[124:125], v[92:93]
    v_pk_mul_f32 v[126:127], v[126:127], v[94:95]
    v_exp_f32 v112, v112
    v_exp_f32 v113, v113
    v_exp_f32 v114, v114
    v_exp_f32 v115, v115
    v_exp_f32 v116, v116
    v_exp_f32 v117, v117
    v_exp_f32 v118, v118
    v_exp_f32 v119, v119
    v_exp_f32 v120, v120
    v_exp_f32 v121, v121
    v_exp_f32 v122, v122
    v_exp_f32 v123, v123
    v_exp_f32 v124, v124
    v_exp_f32 v125, v125
    v_exp_f32 v126, v126
    v_exp_f32 v127, v127
    v_pk_mul_f32 v[80:81], v[80:81], v[96:97]
    v_pk_mul_f32 v[82:83], v[82:83], v[98:99]
    v_pk_mul_f32 v[84:85], v[84:85], v[100:101]
    v_pk_mul_f32 v[86:87], v[86:87], v[102:103]
    v_pk_mul_f32 v[88:89], v[88:89], v[104:105]
    v_pk_mul_f32 v[90:91], v[90:91], v[106:107]
    v_pk_mul_f32 v[92:93], v[92:93], v[108:109]
    v_pk_mul_f32 v[94:95], v[94:95], v[110:111]
    v_pk_add_f32 v[112:113], v[112:113], v[244:245]
    v_pk_add_f32 v[114:115], v[114:115], v[244:245]
    v_pk_add_f32 v[116:117], v[116:117], v[244:245]
    v_pk_add_f32 v[118:119], v[118:119], v[244:245]
    v_pk_add_f32 v[120:121], v[120:121], v[244:245]
    v_pk_add_f32 v[122:123], v[122:123], v[244:245]
    v_pk_add_f32 v[124:125], v[124:125], v[244:245]
    v_pk_add_f32 v[126:127], v[126:127], v[244:245]
    v_rcp_f32 v112, v112
    v_rcp_f32 v113, v113
    v_rcp_f32 v114, v114
    v_rcp_f32 v115, v115
    v_rcp_f32 v116, v116
    v_rcp_f32 v117, v117
    v_rcp_f32 v118, v118
    v_rcp_f32 v119, v119
    v_rcp_f32 v120, v120
    v_rcp_f32 v121, v121
    v_rcp_f32 v122, v122
    v_rcp_f32 v123, v123
    v_rcp_f32 v124, v124
    v_rcp_f32 v125, v125
    v_rcp_f32 v126, v126
    v_rcp_f32 v127, v127
    s_nop 0
    s_nop 0
    v_pk_mul_f32 v[80:81], v[80:81], v[112:113]
    v_pk_mul_f32 v[82:83], v[82:83], v[114:115]
    v_pk_mul_f32 v[84:85], v[84:85], v[116:117]
    v_pk_mul_f32 v[86:87], v[86:87], v[118:119]
    v_pk_mul_f32 v[88:89], v[88:89], v[120:121]
    v_pk_mul_f32 v[90:91], v[90:91], v[122:123]
    v_pk_mul_f32 v[92:93], v[92:93], v[124:125]
    v_pk_mul_f32 v[94:95], v[94:95], v[126:127]
    v_cvt_pk_bf16_f32 v128, v80, v81
    v_cvt_pk_bf16_f32 v129, v82, v83
    v_cvt_pk_bf16_f32 v130, v84, v85
    v_cvt_pk_bf16_f32 v131, v86, v87
    v_cvt_pk_bf16_f32 v132, v88, v89
    v_cvt_pk_bf16_f32 v133, v90, v91
    v_cvt_pk_bf16_f32 v134, v92, v93
    v_cvt_pk_bf16_f32 v135, v94, v95
    s_nop 0
    v_permlane32_swap_b32 v128, v130
    v_permlane32_swap_b32 v129, v131
    v_permlane32_swap_b32 v132, v134
    v_permlane32_swap_b32 v133, v135
    s_nop 0
    buffer_store_dwordx4 v[128:131], v0, s[4:7], s41 offen offset:0 sc1
    buffer_store_dwordx4 v[132:135], v0, s[4:7], s41 offen offset:1024 sc1
    s_add_u32 s41, s38, 67112960
    v_accvgpr_read_b32 v144, a16
    v_accvgpr_read_b32 v145, a17
    v_accvgpr_read_b32 v146, a18
    v_accvgpr_read_b32 v147, a19
    v_accvgpr_read_b32 v148, a20
    v_accvgpr_read_b32 v149, a21
    v_accvgpr_read_b32 v150, a22
    v_accvgpr_read_b32 v151, a23
    v_accvgpr_read_b32 v152, a24
    v_accvgpr_read_b32 v153, a25
    v_accvgpr_read_b32 v154, a26
    v_accvgpr_read_b32 v155, a27
    v_accvgpr_read_b32 v156, a28
    v_accvgpr_read_b32 v157, a29
    v_accvgpr_read_b32 v158, a30
    v_accvgpr_read_b32 v159, a31
    v_accvgpr_read_b32 v160, a48
    v_accvgpr_read_b32 v161, a49
    v_accvgpr_read_b32 v162, a50
    v_accvgpr_read_b32 v163, a51
    v_accvgpr_read_b32 v164, a52
    v_accvgpr_read_b32 v165, a53
    v_accvgpr_read_b32 v166, a54
    v_accvgpr_read_b32 v167, a55
    v_accvgpr_read_b32 v168, a56
    v_accvgpr_read_b32 v169, a57
    v_accvgpr_read_b32 v170, a58
    v_accvgpr_read_b32 v171, a59
    v_accvgpr_read_b32 v172, a60
    v_accvgpr_read_b32 v173, a61
    v_accvgpr_read_b32 v174, a62
    v_accvgpr_read_b32 v175, a63
    v_pk_mul_f32 v[176:177], v[144:145], v[144:145]
    v_pk_mul_f32 v[178:179], v[146:147], v[146:147]
    v_pk_mul_f32 v[180:181], v[148:149], v[148:149]
    v_pk_mul_f32 v[182:183], v[150:151], v[150:151]
    v_pk_mul_f32 v[184:185], v[152:153], v[152:153]
    v_pk_mul_f32 v[186:187], v[154:155], v[154:155]
    v_pk_mul_f32 v[188:189], v[156:157], v[156:157]
    v_pk_mul_f32 v[190:191], v[158:159], v[158:159]
    v_pk_fma_f32 v[176:177], v[176:177], v[242:243], v[240:241]
    v_pk_fma_f32 v[178:179], v[178:179], v[242:243], v[240:241]
    v_pk_fma_f32 v[180:181], v[180:181], v[242:243], v[240:241]
    v_pk_fma_f32 v[182:183], v[182:183], v[242:243], v[240:241]
    v_pk_fma_f32 v[184:185], v[184:185], v[242:243], v[240:241]
    v_pk_fma_f32 v[186:187], v[186:187], v[242:243], v[240:241]
    v_pk_fma_f32 v[188:189], v[188:189], v[242:243], v[240:241]
    v_pk_fma_f32 v[190:191], v[190:191], v[242:243], v[240:241]
    v_pk_mul_f32 v[176:177], v[176:177], v[144:145]
    v_pk_mul_f32 v[178:179], v[178:179], v[146:147]
    v_pk_mul_f32 v[180:181], v[180:181], v[148:149]
    v_pk_mul_f32 v[182:183], v[182:183], v[150:151]
    v_pk_mul_f32 v[184:185], v[184:185], v[152:153]
    v_pk_mul_f32 v[186:187], v[186:187], v[154:155]
    v_pk_mul_f32 v[188:189], v[188:189], v[156:157]
    v_pk_mul_f32 v[190:191], v[190:191], v[158:159]
    v_exp_f32 v176, v176
    v_exp_f32 v177, v177
    v_exp_f32 v178, v178
    v_exp_f32 v179, v179
    v_exp_f32 v180, v180
    v_exp_f32 v181, v181
    v_exp_f32 v182, v182
    v_exp_f32 v183, v183
    v_exp_f32 v184, v184
    v_exp_f32 v185, v185
    v_exp_f32 v186, v186
    v_exp_f32 v187, v187
    v_exp_f32 v188, v188
    v_exp_f32 v189, v189
    v_exp_f32 v190, v190
    v_exp_f32 v191, v191
    v_pk_mul_f32 v[144:145], v[144:145], v[160:161]
    v_pk_mul_f32 v[146:147], v[146:147], v[162:163]
    v_pk_mul_f32 v[148:149], v[148:149], v[164:165]
    v_pk_mul_f32 v[150:151], v[150:151], v[166:167]
    v_pk_mul_f32 v[152:153], v[152:153], v[168:169]
    v_pk_mul_f32 v[154:155], v[154:155], v[170:171]
    v_pk_mul_f32 v[156:157], v[156:157], v[172:173]
    v_pk_mul_f32 v[158:159], v[158:159], v[174:175]
    v_pk_add_f32 v[176:177], v[176:177], v[244:245]
    v_pk_add_f32 v[178:179], v[178:179], v[244:245]
    v_pk_add_f32 v[180:181], v[180:181], v[244:245]
    v_pk_add_f32 v[182:183], v[182:183], v[244:245]
    v_pk_add_f32 v[184:185], v[184:185], v[244:245]
    v_pk_add_f32 v[186:187], v[186:187], v[244:245]
    v_pk_add_f32 v[188:189], v[188:189], v[244:245]
    v_pk_add_f32 v[190:191], v[190:191], v[244:245]
    v_rcp_f32 v176, v176
    v_rcp_f32 v177, v177
    v_rcp_f32 v178, v178
    v_rcp_f32 v179, v179
    v_rcp_f32 v180, v180
    v_rcp_f32 v181, v181
    v_rcp_f32 v182, v182
    v_rcp_f32 v183, v183
    v_rcp_f32 v184, v184
    v_rcp_f32 v185, v185
    v_rcp_f32 v186, v186
    v_rcp_f32 v187, v187
    v_rcp_f32 v188, v188
    v_rcp_f32 v189, v189
    v_rcp_f32 v190, v190
    v_rcp_f32 v191, v191
    s_nop 0
    s_nop 0
    v_pk_mul_f32 v[144:145], v[144:145], v[176:177]
    v_pk_mul_f32 v[146:147], v[146:147], v[178:179]
    v_pk_mul_f32 v[148:149], v[148:149], v[180:181]
    v_pk_mul_f32 v[150:151], v[150:151], v[182:183]
    v_pk_mul_f32 v[152:153], v[152:153], v[184:185]
    v_pk_mul_f32 v[154:155], v[154:155], v[186:187]
    v_pk_mul_f32 v[156:157], v[156:157], v[188:189]
    v_pk_mul_f32 v[158:159], v[158:159], v[190:191]
    v_cvt_pk_bf16_f32 v192, v144, v145
    v_cvt_pk_bf16_f32 v193, v146, v147
    v_cvt_pk_bf16_f32 v194, v148, v149
    v_cvt_pk_bf16_f32 v195, v150, v151
    v_cvt_pk_bf16_f32 v196, v152, v153
    v_cvt_pk_bf16_f32 v197, v154, v155
    v_cvt_pk_bf16_f32 v198, v156, v157
    v_cvt_pk_bf16_f32 v199, v158, v159
    s_nop 0
    v_permlane32_swap_b32 v192, v194
    v_permlane32_swap_b32 v193, v195
    v_permlane32_swap_b32 v196, v198
    v_permlane32_swap_b32 v197, v199
    s_nop 0
    buffer_store_dwordx4 v[192:195], v0, s[4:7], s41 offen offset:0 sc1
    buffer_store_dwordx4 v[196:199], v0, s[4:7], s41 offen offset:1024 sc1
    s_add_u32 s41, s38, 67403776
    v_accvgpr_read_b32 v80, a64
    v_accvgpr_read_b32 v81, a65
    v_accvgpr_read_b32 v82, a66
    v_accvgpr_read_b32 v83, a67
    v_accvgpr_read_b32 v84, a68
    v_accvgpr_read_b32 v85, a69
    v_accvgpr_read_b32 v86, a70
    v_accvgpr_read_b32 v87, a71
    v_accvgpr_read_b32 v88, a72
    v_accvgpr_read_b32 v89, a73
    v_accvgpr_read_b32 v90, a74
    v_accvgpr_read_b32 v91, a75
    v_accvgpr_read_b32 v92, a76
    v_accvgpr_read_b32 v93, a77
    v_accvgpr_read_b32 v94, a78
    v_accvgpr_read_b32 v95, a79
    v_accvgpr_read_b32 v96, a96
    v_accvgpr_read_b32 v97, a97
    v_accvgpr_read_b32 v98, a98
    v_accvgpr_read_b32 v99, a99
    v_accvgpr_read_b32 v100, a100
    v_accvgpr_read_b32 v101, a101
    v_accvgpr_read_b32 v102, a102
    v_accvgpr_read_b32 v103, a103
    v_accvgpr_read_b32 v104, a104
    v_accvgpr_read_b32 v105, a105
    v_accvgpr_read_b32 v106, a106
    v_accvgpr_read_b32 v107, a107
    v_accvgpr_read_b32 v108, a108
    v_accvgpr_read_b32 v109, a109
    v_accvgpr_read_b32 v110, a110
    v_accvgpr_read_b32 v111, a111
    v_pk_mul_f32 v[112:113], v[80:81], v[80:81]
    v_pk_mul_f32 v[114:115], v[82:83], v[82:83]
    v_pk_mul_f32 v[116:117], v[84:85], v[84:85]
    v_pk_mul_f32 v[118:119], v[86:87], v[86:87]
    v_pk_mul_f32 v[120:121], v[88:89], v[88:89]
    v_pk_mul_f32 v[122:123], v[90:91], v[90:91]
    v_pk_mul_f32 v[124:125], v[92:93], v[92:93]
    v_pk_mul_f32 v[126:127], v[94:95], v[94:95]
    v_pk_fma_f32 v[112:113], v[112:113], v[242:243], v[240:241]
    v_pk_fma_f32 v[114:115], v[114:115], v[242:243], v[240:241]
    v_pk_fma_f32 v[116:117], v[116:117], v[242:243], v[240:241]
    v_pk_fma_f32 v[118:119], v[118:119], v[242:243], v[240:241]
    v_pk_fma_f32 v[120:121], v[120:121], v[242:243], v[240:241]
    v_pk_fma_f32 v[122:123], v[122:123], v[242:243], v[240:241]
    v_pk_fma_f32 v[124:125], v[124:125], v[242:243], v[240:241]
    v_pk_fma_f32 v[126:127], v[126:127], v[242:243], v[240:241]
    v_pk_mul_f32 v[112:113], v[112:113], v[80:81]
    v_pk_mul_f32 v[114:115], v[114:115], v[82:83]
    v_pk_mul_f32 v[116:117], v[116:117], v[84:85]
    v_pk_mul_f32 v[118:119], v[118:119], v[86:87]
    v_pk_mul_f32 v[120:121], v[120:121], v[88:89]
    v_pk_mul_f32 v[122:123], v[122:123], v[90:91]
    v_pk_mul_f32 v[124:125], v[124:125], v[92:93]
    v_pk_mul_f32 v[126:127], v[126:127], v[94:95]
    v_exp_f32 v112, v112
    v_exp_f32 v113, v113
    v_exp_f32 v114, v114
    v_exp_f32 v115, v115
    v_exp_f32 v116, v116
    v_exp_f32 v117, v117
    v_exp_f32 v118, v118
    v_exp_f32 v119, v119
    v_exp_f32 v120, v120
    v_exp_f32 v121, v121
    v_exp_f32 v122, v122
    v_exp_f32 v123, v123
    v_exp_f32 v124, v124
    v_exp_f32 v125, v125
    v_exp_f32 v126, v126
    v_exp_f32 v127, v127
    v_pk_mul_f32 v[80:81], v[80:81], v[96:97]
    v_pk_mul_f32 v[82:83], v[82:83], v[98:99]
    v_pk_mul_f32 v[84:85], v[84:85], v[100:101]
    v_pk_mul_f32 v[86:87], v[86:87], v[102:103]
    v_pk_mul_f32 v[88:89], v[88:89], v[104:105]
    v_pk_mul_f32 v[90:91], v[90:91], v[106:107]
    v_pk_mul_f32 v[92:93], v[92:93], v[108:109]
    v_pk_mul_f32 v[94:95], v[94:95], v[110:111]
    v_pk_add_f32 v[112:113], v[112:113], v[244:245]
    v_pk_add_f32 v[114:115], v[114:115], v[244:245]
    v_pk_add_f32 v[116:117], v[116:117], v[244:245]
    v_pk_add_f32 v[118:119], v[118:119], v[244:245]
    v_pk_add_f32 v[120:121], v[120:121], v[244:245]
    v_pk_add_f32 v[122:123], v[122:123], v[244:245]
    v_pk_add_f32 v[124:125], v[124:125], v[244:245]
    v_pk_add_f32 v[126:127], v[126:127], v[244:245]
    v_rcp_f32 v112, v112
    v_rcp_f32 v113, v113
    v_rcp_f32 v114, v114
    v_rcp_f32 v115, v115
    v_rcp_f32 v116, v116
    v_rcp_f32 v117, v117
    v_rcp_f32 v118, v118
    v_rcp_f32 v119, v119
    v_rcp_f32 v120, v120
    v_rcp_f32 v121, v121
    v_rcp_f32 v122, v122
    v_rcp_f32 v123, v123
    v_rcp_f32 v124, v124
    v_rcp_f32 v125, v125
    v_rcp_f32 v126, v126
    v_rcp_f32 v127, v127
    s_nop 0
    s_nop 0
    v_pk_mul_f32 v[80:81], v[80:81], v[112:113]
    v_pk_mul_f32 v[82:83], v[82:83], v[114:115]
    v_pk_mul_f32 v[84:85], v[84:85], v[116:117]
    v_pk_mul_f32 v[86:87], v[86:87], v[118:119]
    v_pk_mul_f32 v[88:89], v[88:89], v[120:121]
    v_pk_mul_f32 v[90:91], v[90:91], v[122:123]
    v_pk_mul_f32 v[92:93], v[92:93], v[124:125]
    v_pk_mul_f32 v[94:95], v[94:95], v[126:127]
    v_cvt_pk_bf16_f32 v128, v80, v81
    v_cvt_pk_bf16_f32 v129, v82, v83
    v_cvt_pk_bf16_f32 v130, v84, v85
    v_cvt_pk_bf16_f32 v131, v86, v87
    v_cvt_pk_bf16_f32 v132, v88, v89
    v_cvt_pk_bf16_f32 v133, v90, v91
    v_cvt_pk_bf16_f32 v134, v92, v93
    v_cvt_pk_bf16_f32 v135, v94, v95
    s_nop 0
    v_permlane32_swap_b32 v128, v130
    v_permlane32_swap_b32 v129, v131
    v_permlane32_swap_b32 v132, v134
    v_permlane32_swap_b32 v133, v135
    s_nop 0
    buffer_store_dwordx4 v[128:131], v0, s[4:7], s41 offen offset:0 sc1
    buffer_store_dwordx4 v[132:135], v0, s[4:7], s41 offen offset:1024 sc1
    s_add_u32 s41, s38, 67407872
    v_accvgpr_read_b32 v144, a80
    v_accvgpr_read_b32 v145, a81
    v_accvgpr_read_b32 v146, a82
    v_accvgpr_read_b32 v147, a83
    v_accvgpr_read_b32 v148, a84
    v_accvgpr_read_b32 v149, a85
    v_accvgpr_read_b32 v150, a86
    v_accvgpr_read_b32 v151, a87
    v_accvgpr_read_b32 v152, a88
    v_accvgpr_read_b32 v153, a89
    v_accvgpr_read_b32 v154, a90
    v_accvgpr_read_b32 v155, a91
    v_accvgpr_read_b32 v156, a92
    v_accvgpr_read_b32 v157, a93
    v_accvgpr_read_b32 v158, a94
    v_accvgpr_read_b32 v159, a95
    v_accvgpr_read_b32 v160, a112
    v_accvgpr_read_b32 v161, a113
    v_accvgpr_read_b32 v162, a114
    v_accvgpr_read_b32 v163, a115
    v_accvgpr_read_b32 v164, a116
    v_accvgpr_read_b32 v165, a117
    v_accvgpr_read_b32 v166, a118
    v_accvgpr_read_b32 v167, a119
    v_accvgpr_read_b32 v168, a120
    v_accvgpr_read_b32 v169, a121
    v_accvgpr_read_b32 v170, a122
    v_accvgpr_read_b32 v171, a123
    v_accvgpr_read_b32 v172, a124
    v_accvgpr_read_b32 v173, a125
    v_accvgpr_read_b32 v174, a126
    v_accvgpr_read_b32 v175, a127
    v_pk_mul_f32 v[176:177], v[144:145], v[144:145]
    v_pk_mul_f32 v[178:179], v[146:147], v[146:147]
    v_pk_mul_f32 v[180:181], v[148:149], v[148:149]
    v_pk_mul_f32 v[182:183], v[150:151], v[150:151]
    v_pk_mul_f32 v[184:185], v[152:153], v[152:153]
    v_pk_mul_f32 v[186:187], v[154:155], v[154:155]
    v_pk_mul_f32 v[188:189], v[156:157], v[156:157]
    v_pk_mul_f32 v[190:191], v[158:159], v[158:159]
    v_pk_fma_f32 v[176:177], v[176:177], v[242:243], v[240:241]
    v_pk_fma_f32 v[178:179], v[178:179], v[242:243], v[240:241]
    v_pk_fma_f32 v[180:181], v[180:181], v[242:243], v[240:241]
    v_pk_fma_f32 v[182:183], v[182:183], v[242:243], v[240:241]
    v_pk_fma_f32 v[184:185], v[184:185], v[242:243], v[240:241]
    v_pk_fma_f32 v[186:187], v[186:187], v[242:243], v[240:241]
    v_pk_fma_f32 v[188:189], v[188:189], v[242:243], v[240:241]
    v_pk_fma_f32 v[190:191], v[190:191], v[242:243], v[240:241]
    v_pk_mul_f32 v[176:177], v[176:177], v[144:145]
    v_pk_mul_f32 v[178:179], v[178:179], v[146:147]
    v_pk_mul_f32 v[180:181], v[180:181], v[148:149]
    v_pk_mul_f32 v[182:183], v[182:183], v[150:151]
    v_pk_mul_f32 v[184:185], v[184:185], v[152:153]
    v_pk_mul_f32 v[186:187], v[186:187], v[154:155]
    v_pk_mul_f32 v[188:189], v[188:189], v[156:157]
    v_pk_mul_f32 v[190:191], v[190:191], v[158:159]
    v_exp_f32 v176, v176
    v_exp_f32 v177, v177
    v_exp_f32 v178, v178
    v_exp_f32 v179, v179
    v_exp_f32 v180, v180
    v_exp_f32 v181, v181
    v_exp_f32 v182, v182
    v_exp_f32 v183, v183
    v_exp_f32 v184, v184
    v_exp_f32 v185, v185
    v_exp_f32 v186, v186
    v_exp_f32 v187, v187
    v_exp_f32 v188, v188
    v_exp_f32 v189, v189
    v_exp_f32 v190, v190
    v_exp_f32 v191, v191
    v_pk_mul_f32 v[144:145], v[144:145], v[160:161]
    v_pk_mul_f32 v[146:147], v[146:147], v[162:163]
    v_pk_mul_f32 v[148:149], v[148:149], v[164:165]
    v_pk_mul_f32 v[150:151], v[150:151], v[166:167]
    v_pk_mul_f32 v[152:153], v[152:153], v[168:169]
    v_pk_mul_f32 v[154:155], v[154:155], v[170:171]
    v_pk_mul_f32 v[156:157], v[156:157], v[172:173]
    v_pk_mul_f32 v[158:159], v[158:159], v[174:175]
    v_pk_add_f32 v[176:177], v[176:177], v[244:245]
    v_pk_add_f32 v[178:179], v[178:179], v[244:245]
    v_pk_add_f32 v[180:181], v[180:181], v[244:245]
    v_pk_add_f32 v[182:183], v[182:183], v[244:245]
    v_pk_add_f32 v[184:185], v[184:185], v[244:245]
    v_pk_add_f32 v[186:187], v[186:187], v[244:245]
    v_pk_add_f32 v[188:189], v[188:189], v[244:245]
    v_pk_add_f32 v[190:191], v[190:191], v[244:245]
    v_rcp_f32 v176, v176
    v_rcp_f32 v177, v177
    v_rcp_f32 v178, v178
    v_rcp_f32 v179, v179
    v_rcp_f32 v180, v180
    v_rcp_f32 v181, v181
    v_rcp_f32 v182, v182
    v_rcp_f32 v183, v183
    v_rcp_f32 v184, v184
    v_rcp_f32 v185, v185
    v_rcp_f32 v186, v186
    v_rcp_f32 v187, v187
    v_rcp_f32 v188, v188
    v_rcp_f32 v189, v189
    v_rcp_f32 v190, v190
    v_rcp_f32 v191, v191
    s_nop 0
    s_nop 0
    v_pk_mul_f32 v[144:145], v[144:145], v[176:177]
    v_pk_mul_f32 v[146:147], v[146:147], v[178:179]
    v_pk_mul_f32 v[148:149], v[148:149], v[180:181]
    v_pk_mul_f32 v[150:151], v[150:151], v[182:183]
    v_pk_mul_f32 v[152:153], v[152:153], v[184:185]
    v_pk_mul_f32 v[154:155], v[154:155], v[186:187]
    v_pk_mul_f32 v[156:157], v[156:157], v[188:189]
    v_pk_mul_f32 v[158:159], v[158:159], v[190:191]
    v_cvt_pk_bf16_f32 v192, v144, v145
    v_cvt_pk_bf16_f32 v193, v146, v147
    v_cvt_pk_bf16_f32 v194, v148, v149
    v_cvt_pk_bf16_f32 v195, v150, v151
    v_cvt_pk_bf16_f32 v196, v152, v153
    v_cvt_pk_bf16_f32 v197, v154, v155
    v_cvt_pk_bf16_f32 v198, v156, v157
    v_cvt_pk_bf16_f32 v199, v158, v159
    s_nop 0
    v_permlane32_swap_b32 v192, v194
    v_permlane32_swap_b32 v193, v195
    v_permlane32_swap_b32 v196, v198
    v_permlane32_swap_b32 v197, v199
    s_nop 0
    buffer_store_dwordx4 v[192:195], v0, s[4:7], s41 offen offset:0 sc1
    buffer_store_dwordx4 v[196:199], v0, s[4:7], s41 offen offset:1024 sc1
    s_add_u32 s41, s38, 67698688
    v_accvgpr_read_b32 v80, a128
    v_accvgpr_read_b32 v81, a129
    v_accvgpr_read_b32 v82, a130
    v_accvgpr_read_b32 v83, a131
    v_accvgpr_read_b32 v84, a132
    v_accvgpr_read_b32 v85, a133
    v_accvgpr_read_b32 v86, a134
    v_accvgpr_read_b32 v87, a135
    v_accvgpr_read_b32 v88, a136
    v_accvgpr_read_b32 v89, a137
    v_accvgpr_read_b32 v90, a138
    v_accvgpr_read_b32 v91, a139
    v_accvgpr_read_b32 v92, a140
    v_accvgpr_read_b32 v93, a141
    v_accvgpr_read_b32 v94, a142
    v_accvgpr_read_b32 v95, a143
    v_accvgpr_read_b32 v96, a160
    v_accvgpr_read_b32 v97, a161
    v_accvgpr_read_b32 v98, a162
    v_accvgpr_read_b32 v99, a163
    v_accvgpr_read_b32 v100, a164
    v_accvgpr_read_b32 v101, a165
    v_accvgpr_read_b32 v102, a166
    v_accvgpr_read_b32 v103, a167
    v_accvgpr_read_b32 v104, a168
    v_accvgpr_read_b32 v105, a169
    v_accvgpr_read_b32 v106, a170
    v_accvgpr_read_b32 v107, a171
    v_accvgpr_read_b32 v108, a172
    v_accvgpr_read_b32 v109, a173
    v_accvgpr_read_b32 v110, a174
    v_accvgpr_read_b32 v111, a175
    v_pk_mul_f32 v[112:113], v[80:81], v[80:81]
    v_pk_mul_f32 v[114:115], v[82:83], v[82:83]
    v_pk_mul_f32 v[116:117], v[84:85], v[84:85]
    v_pk_mul_f32 v[118:119], v[86:87], v[86:87]
    v_pk_mul_f32 v[120:121], v[88:89], v[88:89]
    v_pk_mul_f32 v[122:123], v[90:91], v[90:91]
    v_pk_mul_f32 v[124:125], v[92:93], v[92:93]
    v_pk_mul_f32 v[126:127], v[94:95], v[94:95]
    v_pk_fma_f32 v[112:113], v[112:113], v[242:243], v[240:241]
    v_pk_fma_f32 v[114:115], v[114:115], v[242:243], v[240:241]
    v_pk_fma_f32 v[116:117], v[116:117], v[242:243], v[240:241]
    v_pk_fma_f32 v[118:119], v[118:119], v[242:243], v[240:241]
    v_pk_fma_f32 v[120:121], v[120:121], v[242:243], v[240:241]
    v_pk_fma_f32 v[122:123], v[122:123], v[242:243], v[240:241]
    v_pk_fma_f32 v[124:125], v[124:125], v[242:243], v[240:241]
    v_pk_fma_f32 v[126:127], v[126:127], v[242:243], v[240:241]
    v_pk_mul_f32 v[112:113], v[112:113], v[80:81]
    v_pk_mul_f32 v[114:115], v[114:115], v[82:83]
    v_pk_mul_f32 v[116:117], v[116:117], v[84:85]
    v_pk_mul_f32 v[118:119], v[118:119], v[86:87]
    v_pk_mul_f32 v[120:121], v[120:121], v[88:89]
    v_pk_mul_f32 v[122:123], v[122:123], v[90:91]
    v_pk_mul_f32 v[124:125], v[124:125], v[92:93]
    v_pk_mul_f32 v[126:127], v[126:127], v[94:95]
    v_exp_f32 v112, v112
    v_exp_f32 v113, v113
    v_exp_f32 v114, v114
    v_exp_f32 v115, v115
    v_exp_f32 v116, v116
    v_exp_f32 v117, v117
    v_exp_f32 v118, v118
    v_exp_f32 v119, v119
    v_exp_f32 v120, v120
    v_exp_f32 v121, v121
    v_exp_f32 v122, v122
    v_exp_f32 v123, v123
    v_exp_f32 v124, v124
    v_exp_f32 v125, v125
    v_exp_f32 v126, v126
    v_exp_f32 v127, v127
    v_pk_mul_f32 v[80:81], v[80:81], v[96:97]
    v_pk_mul_f32 v[82:83], v[82:83], v[98:99]
    v_pk_mul_f32 v[84:85], v[84:85], v[100:101]
    v_pk_mul_f32 v[86:87], v[86:87], v[102:103]
    v_pk_mul_f32 v[88:89], v[88:89], v[104:105]
    v_pk_mul_f32 v[90:91], v[90:91], v[106:107]
    v_pk_mul_f32 v[92:93], v[92:93], v[108:109]
    v_pk_mul_f32 v[94:95], v[94:95], v[110:111]
    v_pk_add_f32 v[112:113], v[112:113], v[244:245]
    v_pk_add_f32 v[114:115], v[114:115], v[244:245]
    v_pk_add_f32 v[116:117], v[116:117], v[244:245]
    v_pk_add_f32 v[118:119], v[118:119], v[244:245]
    v_pk_add_f32 v[120:121], v[120:121], v[244:245]
    v_pk_add_f32 v[122:123], v[122:123], v[244:245]
    v_pk_add_f32 v[124:125], v[124:125], v[244:245]
    v_pk_add_f32 v[126:127], v[126:127], v[244:245]
    v_rcp_f32 v112, v112
    v_rcp_f32 v113, v113
    v_rcp_f32 v114, v114
    v_rcp_f32 v115, v115
    v_rcp_f32 v116, v116
    v_rcp_f32 v117, v117
    v_rcp_f32 v118, v118
    v_rcp_f32 v119, v119
    v_rcp_f32 v120, v120
    v_rcp_f32 v121, v121
    v_rcp_f32 v122, v122
    v_rcp_f32 v123, v123
    v_rcp_f32 v124, v124
    v_rcp_f32 v125, v125
    v_rcp_f32 v126, v126
    v_rcp_f32 v127, v127
    s_nop 0
    s_nop 0
    v_pk_mul_f32 v[80:81], v[80:81], v[112:113]
    v_pk_mul_f32 v[82:83], v[82:83], v[114:115]
    v_pk_mul_f32 v[84:85], v[84:85], v[116:117]
    v_pk_mul_f32 v[86:87], v[86:87], v[118:119]
    v_pk_mul_f32 v[88:89], v[88:89], v[120:121]
    v_pk_mul_f32 v[90:91], v[90:91], v[122:123]
    v_pk_mul_f32 v[92:93], v[92:93], v[124:125]
    v_pk_mul_f32 v[94:95], v[94:95], v[126:127]
    v_cvt_pk_bf16_f32 v128, v80, v81
    v_cvt_pk_bf16_f32 v129, v82, v83
    v_cvt_pk_bf16_f32 v130, v84, v85
    v_cvt_pk_bf16_f32 v131, v86, v87
    v_cvt_pk_bf16_f32 v132, v88, v89
    v_cvt_pk_bf16_f32 v133, v90, v91
    v_cvt_pk_bf16_f32 v134, v92, v93
    v_cvt_pk_bf16_f32 v135, v94, v95
    s_nop 0
    v_permlane32_swap_b32 v128, v130
    v_permlane32_swap_b32 v129, v131
    v_permlane32_swap_b32 v132, v134
    v_permlane32_swap_b32 v133, v135
    s_nop 0
    buffer_store_dwordx4 v[128:131], v0, s[4:7], s41 offen offset:0 sc1
    buffer_store_dwordx4 v[132:135], v0, s[4:7], s41 offen offset:1024 sc1
    s_add_u32 s41, s38, 67702784
    v_accvgpr_read_b32 v144, a144
    v_accvgpr_read_b32 v145, a145
    v_accvgpr_read_b32 v146, a146
    v_accvgpr_read_b32 v147, a147
    v_accvgpr_read_b32 v148, a148
    v_accvgpr_read_b32 v149, a149
    v_accvgpr_read_b32 v150, a150
    v_accvgpr_read_b32 v151, a151
    v_accvgpr_read_b32 v152, a152
    v_accvgpr_read_b32 v153, a153
    v_accvgpr_read_b32 v154, a154
    v_accvgpr_read_b32 v155, a155
    v_accvgpr_read_b32 v156, a156
    v_accvgpr_read_b32 v157, a157
    v_accvgpr_read_b32 v158, a158
    v_accvgpr_read_b32 v159, a159
    v_accvgpr_read_b32 v160, a176
    v_accvgpr_read_b32 v161, a177
    v_accvgpr_read_b32 v162, a178
    v_accvgpr_read_b32 v163, a179
    v_accvgpr_read_b32 v164, a180
    v_accvgpr_read_b32 v165, a181
    v_accvgpr_read_b32 v166, a182
    v_accvgpr_read_b32 v167, a183
    v_accvgpr_read_b32 v168, a184
    v_accvgpr_read_b32 v169, a185
    v_accvgpr_read_b32 v170, a186
    v_accvgpr_read_b32 v171, a187
    v_accvgpr_read_b32 v172, a188
    v_accvgpr_read_b32 v173, a189
    v_accvgpr_read_b32 v174, a190
    v_accvgpr_read_b32 v175, a191
    v_pk_mul_f32 v[176:177], v[144:145], v[144:145]
    v_pk_mul_f32 v[178:179], v[146:147], v[146:147]
    v_pk_mul_f32 v[180:181], v[148:149], v[148:149]
    v_pk_mul_f32 v[182:183], v[150:151], v[150:151]
    v_pk_mul_f32 v[184:185], v[152:153], v[152:153]
    v_pk_mul_f32 v[186:187], v[154:155], v[154:155]
    v_pk_mul_f32 v[188:189], v[156:157], v[156:157]
    v_pk_mul_f32 v[190:191], v[158:159], v[158:159]
    v_pk_fma_f32 v[176:177], v[176:177], v[242:243], v[240:241]
    v_pk_fma_f32 v[178:179], v[178:179], v[242:243], v[240:241]
    v_pk_fma_f32 v[180:181], v[180:181], v[242:243], v[240:241]
    v_pk_fma_f32 v[182:183], v[182:183], v[242:243], v[240:241]
    v_pk_fma_f32 v[184:185], v[184:185], v[242:243], v[240:241]
    v_pk_fma_f32 v[186:187], v[186:187], v[242:243], v[240:241]
    v_pk_fma_f32 v[188:189], v[188:189], v[242:243], v[240:241]
    v_pk_fma_f32 v[190:191], v[190:191], v[242:243], v[240:241]
    v_pk_mul_f32 v[176:177], v[176:177], v[144:145]
    v_pk_mul_f32 v[178:179], v[178:179], v[146:147]
    v_pk_mul_f32 v[180:181], v[180:181], v[148:149]
    v_pk_mul_f32 v[182:183], v[182:183], v[150:151]
    v_pk_mul_f32 v[184:185], v[184:185], v[152:153]
    v_pk_mul_f32 v[186:187], v[186:187], v[154:155]
    v_pk_mul_f32 v[188:189], v[188:189], v[156:157]
    v_pk_mul_f32 v[190:191], v[190:191], v[158:159]
    v_exp_f32 v176, v176
    v_exp_f32 v177, v177
    v_exp_f32 v178, v178
    v_exp_f32 v179, v179
    v_exp_f32 v180, v180
    v_exp_f32 v181, v181
    v_exp_f32 v182, v182
    v_exp_f32 v183, v183
    v_exp_f32 v184, v184
    v_exp_f32 v185, v185
    v_exp_f32 v186, v186
    v_exp_f32 v187, v187
    v_exp_f32 v188, v188
    v_exp_f32 v189, v189
    v_exp_f32 v190, v190
    v_exp_f32 v191, v191
    v_pk_mul_f32 v[144:145], v[144:145], v[160:161]
    v_pk_mul_f32 v[146:147], v[146:147], v[162:163]
    v_pk_mul_f32 v[148:149], v[148:149], v[164:165]
    v_pk_mul_f32 v[150:151], v[150:151], v[166:167]
    v_pk_mul_f32 v[152:153], v[152:153], v[168:169]
    v_pk_mul_f32 v[154:155], v[154:155], v[170:171]
    v_pk_mul_f32 v[156:157], v[156:157], v[172:173]
    v_pk_mul_f32 v[158:159], v[158:159], v[174:175]
    v_pk_add_f32 v[176:177], v[176:177], v[244:245]
    v_pk_add_f32 v[178:179], v[178:179], v[244:245]
    v_pk_add_f32 v[180:181], v[180:181], v[244:245]
    v_pk_add_f32 v[182:183], v[182:183], v[244:245]
    v_pk_add_f32 v[184:185], v[184:185], v[244:245]
    v_pk_add_f32 v[186:187], v[186:187], v[244:245]
    v_pk_add_f32 v[188:189], v[188:189], v[244:245]
    v_pk_add_f32 v[190:191], v[190:191], v[244:245]
    v_rcp_f32 v176, v176
    v_rcp_f32 v177, v177
    v_rcp_f32 v178, v178
    v_rcp_f32 v179, v179
    v_rcp_f32 v180, v180
    v_rcp_f32 v181, v181
    v_rcp_f32 v182, v182
    v_rcp_f32 v183, v183
    v_rcp_f32 v184, v184
    v_rcp_f32 v185, v185
    v_rcp_f32 v186, v186
    v_rcp_f32 v187, v187
    v_rcp_f32 v188, v188
    v_rcp_f32 v189, v189
    v_rcp_f32 v190, v190
    v_rcp_f32 v191, v191
    s_nop 0
    s_nop 0
    v_pk_mul_f32 v[144:145], v[144:145], v[176:177]
    v_pk_mul_f32 v[146:147], v[146:147], v[178:179]
    v_pk_mul_f32 v[148:149], v[148:149], v[180:181]
    v_pk_mul_f32 v[150:151], v[150:151], v[182:183]
    v_pk_mul_f32 v[152:153], v[152:153], v[184:185]
    v_pk_mul_f32 v[154:155], v[154:155], v[186:187]
    v_pk_mul_f32 v[156:157], v[156:157], v[188:189]
    v_pk_mul_f32 v[158:159], v[158:159], v[190:191]
    v_cvt_pk_bf16_f32 v192, v144, v145
    v_cvt_pk_bf16_f32 v193, v146, v147
    v_cvt_pk_bf16_f32 v194, v148, v149
    v_cvt_pk_bf16_f32 v195, v150, v151
    v_cvt_pk_bf16_f32 v196, v152, v153
    v_cvt_pk_bf16_f32 v197, v154, v155
    v_cvt_pk_bf16_f32 v198, v156, v157
    v_cvt_pk_bf16_f32 v199, v158, v159
    s_nop 0
    v_permlane32_swap_b32 v192, v194
    v_permlane32_swap_b32 v193, v195
    v_permlane32_swap_b32 v196, v198
    v_permlane32_swap_b32 v197, v199
    s_nop 0
    buffer_store_dwordx4 v[192:195], v0, s[4:7], s41 offen offset:0 sc1
    buffer_store_dwordx4 v[196:199], v0, s[4:7], s41 offen offset:1024 sc1
    s_add_u32 s41, s38, 67993600
    v_accvgpr_read_b32 v80, a192
    v_accvgpr_read_b32 v81, a193
    v_accvgpr_read_b32 v82, a194
    v_accvgpr_read_b32 v83, a195
    v_accvgpr_read_b32 v84, a196
    v_accvgpr_read_b32 v85, a197
    v_accvgpr_read_b32 v86, a198
    v_accvgpr_read_b32 v87, a199
    v_accvgpr_read_b32 v88, a200
    v_accvgpr_read_b32 v89, a201
    v_accvgpr_read_b32 v90, a202
    v_accvgpr_read_b32 v91, a203
    v_accvgpr_read_b32 v92, a204
    v_accvgpr_read_b32 v93, a205
    v_accvgpr_read_b32 v94, a206
    v_accvgpr_read_b32 v95, a207
    v_accvgpr_read_b32 v96, a224
    v_accvgpr_read_b32 v97, a225
    v_accvgpr_read_b32 v98, a226
    v_accvgpr_read_b32 v99, a227
    v_accvgpr_read_b32 v100, a228
    v_accvgpr_read_b32 v101, a229
    v_accvgpr_read_b32 v102, a230
    v_accvgpr_read_b32 v103, a231
    v_accvgpr_read_b32 v104, a232
    v_accvgpr_read_b32 v105, a233
    v_accvgpr_read_b32 v106, a234
    v_accvgpr_read_b32 v107, a235
    v_accvgpr_read_b32 v108, a236
    v_accvgpr_read_b32 v109, a237
    v_accvgpr_read_b32 v110, a238
    v_accvgpr_read_b32 v111, a239
    v_pk_mul_f32 v[112:113], v[80:81], v[80:81]
    v_pk_mul_f32 v[114:115], v[82:83], v[82:83]
    v_pk_mul_f32 v[116:117], v[84:85], v[84:85]
    v_pk_mul_f32 v[118:119], v[86:87], v[86:87]
    v_pk_mul_f32 v[120:121], v[88:89], v[88:89]
    v_pk_mul_f32 v[122:123], v[90:91], v[90:91]
    v_pk_mul_f32 v[124:125], v[92:93], v[92:93]
    v_pk_mul_f32 v[126:127], v[94:95], v[94:95]
    v_pk_fma_f32 v[112:113], v[112:113], v[242:243], v[240:241]
    v_pk_fma_f32 v[114:115], v[114:115], v[242:243], v[240:241]
    v_pk_fma_f32 v[116:117], v[116:117], v[242:243], v[240:241]
    v_pk_fma_f32 v[118:119], v[118:119], v[242:243], v[240:241]
    v_pk_fma_f32 v[120:121], v[120:121], v[242:243], v[240:241]
    v_pk_fma_f32 v[122:123], v[122:123], v[242:243], v[240:241]
    v_pk_fma_f32 v[124:125], v[124:125], v[242:243], v[240:241]
    v_pk_fma_f32 v[126:127], v[126:127], v[242:243], v[240:241]
    v_pk_mul_f32 v[112:113], v[112:113], v[80:81]
    v_pk_mul_f32 v[114:115], v[114:115], v[82:83]
    v_pk_mul_f32 v[116:117], v[116:117], v[84:85]
    v_pk_mul_f32 v[118:119], v[118:119], v[86:87]
    v_pk_mul_f32 v[120:121], v[120:121], v[88:89]
    v_pk_mul_f32 v[122:123], v[122:123], v[90:91]
    v_pk_mul_f32 v[124:125], v[124:125], v[92:93]
    v_pk_mul_f32 v[126:127], v[126:127], v[94:95]
    v_exp_f32 v112, v112
    v_exp_f32 v113, v113
    v_exp_f32 v114, v114
    v_exp_f32 v115, v115
    v_exp_f32 v116, v116
    v_exp_f32 v117, v117
    v_exp_f32 v118, v118
    v_exp_f32 v119, v119
    v_exp_f32 v120, v120
    v_exp_f32 v121, v121
    v_exp_f32 v122, v122
    v_exp_f32 v123, v123
    v_exp_f32 v124, v124
    v_exp_f32 v125, v125
    v_exp_f32 v126, v126
    v_exp_f32 v127, v127
    v_pk_mul_f32 v[80:81], v[80:81], v[96:97]
    v_pk_mul_f32 v[82:83], v[82:83], v[98:99]
    v_pk_mul_f32 v[84:85], v[84:85], v[100:101]
    v_pk_mul_f32 v[86:87], v[86:87], v[102:103]
    v_pk_mul_f32 v[88:89], v[88:89], v[104:105]
    v_pk_mul_f32 v[90:91], v[90:91], v[106:107]
    v_pk_mul_f32 v[92:93], v[92:93], v[108:109]
    v_pk_mul_f32 v[94:95], v[94:95], v[110:111]
    v_pk_add_f32 v[112:113], v[112:113], v[244:245]
    v_pk_add_f32 v[114:115], v[114:115], v[244:245]
    v_pk_add_f32 v[116:117], v[116:117], v[244:245]
    v_pk_add_f32 v[118:119], v[118:119], v[244:245]
    v_pk_add_f32 v[120:121], v[120:121], v[244:245]
    v_pk_add_f32 v[122:123], v[122:123], v[244:245]
    v_pk_add_f32 v[124:125], v[124:125], v[244:245]
    v_pk_add_f32 v[126:127], v[126:127], v[244:245]
    v_rcp_f32 v112, v112
    v_rcp_f32 v113, v113
    v_rcp_f32 v114, v114
    v_rcp_f32 v115, v115
    v_rcp_f32 v116, v116
    v_rcp_f32 v117, v117
    v_rcp_f32 v118, v118
    v_rcp_f32 v119, v119
    v_rcp_f32 v120, v120
    v_rcp_f32 v121, v121
    v_rcp_f32 v122, v122
    v_rcp_f32 v123, v123
    v_rcp_f32 v124, v124
    v_rcp_f32 v125, v125
    v_rcp_f32 v126, v126
    v_rcp_f32 v127, v127
    s_nop 0
    s_nop 0
    v_pk_mul_f32 v[80:81], v[80:81], v[112:113]
    v_pk_mul_f32 v[82:83], v[82:83], v[114:115]
    v_pk_mul_f32 v[84:85], v[84:85], v[116:117]
    v_pk_mul_f32 v[86:87], v[86:87], v[118:119]
    v_pk_mul_f32 v[88:89], v[88:89], v[120:121]
    v_pk_mul_f32 v[90:91], v[90:91], v[122:123]
    v_pk_mul_f32 v[92:93], v[92:93], v[124:125]
    v_pk_mul_f32 v[94:95], v[94:95], v[126:127]
    v_cvt_pk_bf16_f32 v128, v80, v81
    v_cvt_pk_bf16_f32 v129, v82, v83
    v_cvt_pk_bf16_f32 v130, v84, v85
    v_cvt_pk_bf16_f32 v131, v86, v87
    v_cvt_pk_bf16_f32 v132, v88, v89
    v_cvt_pk_bf16_f32 v133, v90, v91
    v_cvt_pk_bf16_f32 v134, v92, v93
    v_cvt_pk_bf16_f32 v135, v94, v95
    s_nop 0
    v_permlane32_swap_b32 v128, v130
    v_permlane32_swap_b32 v129, v131
    v_permlane32_swap_b32 v132, v134
    v_permlane32_swap_b32 v133, v135
    s_nop 0
    buffer_store_dwordx4 v[128:131], v0, s[4:7], s41 offen offset:0 sc1
    buffer_store_dwordx4 v[132:135], v0, s[4:7], s41 offen offset:1024 sc1
    s_add_u32 s41, s38, 67997696
    v_accvgpr_read_b32 v144, a208
    v_accvgpr_read_b32 v145, a209
    v_accvgpr_read_b32 v146, a210
    v_accvgpr_read_b32 v147, a211
    v_accvgpr_read_b32 v148, a212
    v_accvgpr_read_b32 v149, a213
    v_accvgpr_read_b32 v150, a214
    v_accvgpr_read_b32 v151, a215
    v_accvgpr_read_b32 v152, a216
    v_accvgpr_read_b32 v153, a217
    v_accvgpr_read_b32 v154, a218
    v_accvgpr_read_b32 v155, a219
    v_accvgpr_read_b32 v156, a220
    v_accvgpr_read_b32 v157, a221
    v_accvgpr_read_b32 v158, a222
    v_accvgpr_read_b32 v159, a223
    v_accvgpr_read_b32 v160, a240
    v_accvgpr_read_b32 v161, a241
    v_accvgpr_read_b32 v162, a242
    v_accvgpr_read_b32 v163, a243
    v_accvgpr_read_b32 v164, a244
    v_accvgpr_read_b32 v165, a245
    v_accvgpr_read_b32 v166, a246
    v_accvgpr_read_b32 v167, a247
    v_accvgpr_read_b32 v168, a248
    v_accvgpr_read_b32 v169, a249
    v_accvgpr_read_b32 v170, a250
    v_accvgpr_read_b32 v171, a251
    v_accvgpr_read_b32 v172, a252
    v_accvgpr_read_b32 v173, a253
    v_accvgpr_read_b32 v174, a254
    v_accvgpr_read_b32 v175, a255
    v_pk_mul_f32 v[176:177], v[144:145], v[144:145]
    v_pk_mul_f32 v[178:179], v[146:147], v[146:147]
    v_pk_mul_f32 v[180:181], v[148:149], v[148:149]
    v_pk_mul_f32 v[182:183], v[150:151], v[150:151]
    v_pk_mul_f32 v[184:185], v[152:153], v[152:153]
    v_pk_mul_f32 v[186:187], v[154:155], v[154:155]
    v_pk_mul_f32 v[188:189], v[156:157], v[156:157]
    v_pk_mul_f32 v[190:191], v[158:159], v[158:159]
    v_pk_fma_f32 v[176:177], v[176:177], v[242:243], v[240:241]
    v_pk_fma_f32 v[178:179], v[178:179], v[242:243], v[240:241]
    v_pk_fma_f32 v[180:181], v[180:181], v[242:243], v[240:241]
    v_pk_fma_f32 v[182:183], v[182:183], v[242:243], v[240:241]
    v_pk_fma_f32 v[184:185], v[184:185], v[242:243], v[240:241]
    v_pk_fma_f32 v[186:187], v[186:187], v[242:243], v[240:241]
    v_pk_fma_f32 v[188:189], v[188:189], v[242:243], v[240:241]
    v_pk_fma_f32 v[190:191], v[190:191], v[242:243], v[240:241]
    v_pk_mul_f32 v[176:177], v[176:177], v[144:145]
    v_pk_mul_f32 v[178:179], v[178:179], v[146:147]
    v_pk_mul_f32 v[180:181], v[180:181], v[148:149]
    v_pk_mul_f32 v[182:183], v[182:183], v[150:151]
    v_pk_mul_f32 v[184:185], v[184:185], v[152:153]
    v_pk_mul_f32 v[186:187], v[186:187], v[154:155]
    v_pk_mul_f32 v[188:189], v[188:189], v[156:157]
    v_pk_mul_f32 v[190:191], v[190:191], v[158:159]
    v_exp_f32 v176, v176
    v_exp_f32 v177, v177
    v_exp_f32 v178, v178
    v_exp_f32 v179, v179
    v_exp_f32 v180, v180
    v_exp_f32 v181, v181
    v_exp_f32 v182, v182
    v_exp_f32 v183, v183
    v_exp_f32 v184, v184
    v_exp_f32 v185, v185
    v_exp_f32 v186, v186
    v_exp_f32 v187, v187
    v_exp_f32 v188, v188
    v_exp_f32 v189, v189
    v_exp_f32 v190, v190
    v_exp_f32 v191, v191
    v_pk_mul_f32 v[144:145], v[144:145], v[160:161]
    v_pk_mul_f32 v[146:147], v[146:147], v[162:163]
    v_pk_mul_f32 v[148:149], v[148:149], v[164:165]
    v_pk_mul_f32 v[150:151], v[150:151], v[166:167]
    v_pk_mul_f32 v[152:153], v[152:153], v[168:169]
    v_pk_mul_f32 v[154:155], v[154:155], v[170:171]
    v_pk_mul_f32 v[156:157], v[156:157], v[172:173]
    v_pk_mul_f32 v[158:159], v[158:159], v[174:175]
    v_pk_add_f32 v[176:177], v[176:177], v[244:245]
    v_pk_add_f32 v[178:179], v[178:179], v[244:245]
    v_pk_add_f32 v[180:181], v[180:181], v[244:245]
    v_pk_add_f32 v[182:183], v[182:183], v[244:245]
    v_pk_add_f32 v[184:185], v[184:185], v[244:245]
    v_pk_add_f32 v[186:187], v[186:187], v[244:245]
    v_pk_add_f32 v[188:189], v[188:189], v[244:245]
    v_pk_add_f32 v[190:191], v[190:191], v[244:245]
    v_rcp_f32 v176, v176
    v_rcp_f32 v177, v177
    v_rcp_f32 v178, v178
    v_rcp_f32 v179, v179
    v_rcp_f32 v180, v180
    v_rcp_f32 v181, v181
    v_rcp_f32 v182, v182
    v_rcp_f32 v183, v183
    v_rcp_f32 v184, v184
    v_rcp_f32 v185, v185
    v_rcp_f32 v186, v186
    v_rcp_f32 v187, v187
    v_rcp_f32 v188, v188
    v_rcp_f32 v189, v189
    v_rcp_f32 v190, v190
    v_rcp_f32 v191, v191
    s_nop 0
    s_nop 0
    v_pk_mul_f32 v[144:145], v[144:145], v[176:177]
    v_pk_mul_f32 v[146:147], v[146:147], v[178:179]
    v_pk_mul_f32 v[148:149], v[148:149], v[180:181]
    v_pk_mul_f32 v[150:151], v[150:151], v[182:183]
    v_pk_mul_f32 v[152:153], v[152:153], v[184:185]
    v_pk_mul_f32 v[154:155], v[154:155], v[186:187]
    v_pk_mul_f32 v[156:157], v[156:157], v[188:189]
    v_pk_mul_f32 v[158:159], v[158:159], v[190:191]
    v_cvt_pk_bf16_f32 v192, v144, v145
    v_cvt_pk_bf16_f32 v193, v146, v147
    v_cvt_pk_bf16_f32 v194, v148, v149
    v_cvt_pk_bf16_f32 v195, v150, v151
    v_cvt_pk_bf16_f32 v196, v152, v153
    v_cvt_pk_bf16_f32 v197, v154, v155
    v_cvt_pk_bf16_f32 v198, v156, v157
    v_cvt_pk_bf16_f32 v199, v158, v159
    s_nop 0
    v_permlane32_swap_b32 v192, v194
    v_permlane32_swap_b32 v193, v195
    v_permlane32_swap_b32 v196, v198
    v_permlane32_swap_b32 v197, v199
    buffer_store_dwordx4 v[192:195], v0, s[4:7], s41 offen offset:0 sc1
    buffer_store_dwordx4 v[196:199], v0, s[4:7], s41 offen offset:1024 sc1
    s_lshl_b32 s40, s21, 8
    s_add_u32 s40, s40, s22
    s_lshl_b32 s40, s40, 2
    s_add_u32 s40, s40, 64553216
    s_waitcnt vmcnt(0)
    s_waitcnt vmcnt(0)
    s_barrier
    s_cmp_lg_u32 s17, 0
    s_cbranch_scc1 SF_70
    v_mov_b32 v250, 1
    buffer_store_dword v250, off, s[4:7], s40 sc1
SF_70:
QG_end_68:
    s_branch NEXT
DO_DN:
    s_mul_i32 s47, s22, 2731
    s_lshr_b32 s47, s47, 16
    s_mul_i32 s40, s47, 24
    s_sub_u32 s22, s22, s40
    s_mul_i32 s21, s22, 43
    s_lshr_b32 s21, s21, 7
    s_mul_i32 s40, s21, 3
    s_sub_u32 s46, s22, s40
    s_load_dwordx2 s[12:13], s[0:1], 80
    s_waitcnt lgkmcnt(0)
    s_nop 0
    s_and_b32 s13, s13, 0xffff
    s_mov_b32 s14, 5308416
    s_mov_b32 s15, 0x00020000
    s_mov_b32 s26, 1152
    s_mov_b32 s24, 294912
    s_mul_i32 s23, s21, 2359296
    s_mul_i32 s40, s47, 36864
    s_add_u32 s23, s23, s40
    s_add_u32 s23, s23, 67108864
    s_mul_i32 s30, s47, 663552
    s_mul_i32 s40, s46, 384
    s_add_u32 s30, s30, s40
    s_add_u32 s31, s30, 128
    s_add_u32 s32, s30, 256
    v_mbcnt_lo_u32_b32 v8, -1, 0
    v_mbcnt_hi_u32_b32 v8, -1, v8
    s_lshr_b32 s35, s17, 1
    s_and_b32 s36, s17, 1
    v_lshlrev_b32_e64 v0, 4, v8
    s_mul_i32 s40, s35, 16384
    v_add_u32 v1, s40, v0
    v_lshrrev_b32 v9, 5, v8
    v_bfe_u32 v10, v8, 2, 2
    v_lshl_add_u32 v9, v9, 3, v10
    v_lshlrev_b32 v2, 7, v9
    v_lshrrev_b32 v10, 1, v10
    v_xor_b32_e64 v10, s36, v10
    v_lshl_add_u32 v2, v10, 6, v2
    v_bfe_u32 v10, v8, 4, 1
    v_lshl_add_u32 v2, v10, 5, v2
    v_and_b32_e64 v11, 3, v8
    v_lshl_add_u32 v2, v11, 3, v2
    v_add_u32 v2, 32768, v2
    v_lshrrev_b32_e64 v9, 3, v8
    v_mul_lo_u32 v3, v9, s26
    v_bfe_u32 v9, v8, 4, 1
    v_lshlrev_b32 v9, 2, v9
    v_and_b32 v11, 7, v8
    v_xor_b32_e64 v9, v9, v11
    v_lshl_add_u32 v3, v9, 4, v3
    v_lshlrev_b32 v4, 10, v10
    v_and_b32 v11, 15, v8
    v_lshl_add_u32 v4, v11, 4, v4
    v_lshrrev_b32_e64 v9, 5, v8
    v_lshl_add_u32 v4, v9, 8, v4
    s_bitcmp1_b32 s98, s21
    s_cbranch_scc1 LNW_71
    s_lshl_b32 s40, s21, 2
    s_add_u32 s40, s40, 128
    s_cmp_lg_u32 s17, 0
    s_cbranch_scc1 WCok_73
    v_mov_b32 v250, s40
WC_72:
    buffer_load_dword v251, v250, s[8:11], 0 offen sc1
    s_waitcnt vmcnt(0)
    v_and_b32 v251, -1, v251
    v_cmp_le_u32 vcc, 8, v251
    s_cbranch_vccnz WCok_73
    s_sleep 10
    s_sub_u32 s19, s19, 1
    s_cbranch_scc0 WC_72
    s_mov_b32 s19, 0
WCok_73:
    s_barrier
    s_bitset1_b32 s98, s21
LNW_71:
    s_mul_i32 s41, s47, 9
    s_lshr_b32 s41, s41, 1
    s_lshl_b32 s42, s21, 8
    s_add_u32 s42, s42, s41
    s_lshl_b32 s42, s42, 2
    s_add_u32 s42, s42, 64553216
    s_cmp_lg_u32 s17, 0
    s_cbranch_scc1 WFok_75
    v_mbcnt_lo_u32_b32 v250, -1, 0
    v_mbcnt_hi_u32_b32 v250, -1, v250
    v_min_u32 v250, 4, v250
    v_mul_u32_u24_e64 v250, 4, v250
WF_74:
    buffer_load_dword v251, v250, s[4:7], s42 offen sc1
    s_waitcnt vmcnt(0)
    v_cmp_eq_u32 vcc, 0, v251
    s_cbranch_vccz WFok_75
    s_sleep 16
    s_sub_u32 s19, s19, 1
    s_cbranch_scc0 WF_74
    s_mov_b32 s19, 0
WFok_75:
    s_barrier
    s_lshl_b32 s40, s17, 1
    s_mul_i32 s40, s40, s24
    s_add_u32 s34, s23, s40
    s_and_b32 s40, s17, 0
    s_lshl_b32 s40, s40, 11
    s_add_u32 s34, s34, s40
    s_lshl_b32 s40, s17, 3
    s_mul_i32 s25, s40, s26
    s_mov_b32 s28, 0
    s_lshl_b32 s44, s17, 13
    s_add_u32 s44, s44, s28
    s_lshl_b32 s45, s17, 10
    s_add_u32 s45, s45, s28
    s_add_u32 s45, s45, 32768
    s_lshl_b32 s42, s26, 5
    s_add_u32 m0, s44, 0
    s_mov_b32 s40, s34
    buffer_load_dwordx4 v0, s[4:7], s40 offen lds
    buffer_load_dwordx4 v0, s[4:7], s40 offen offset:1024 lds
    buffer_load_dwordx4 v0, s[4:7], s40 offen offset:2048 lds
    buffer_load_dwordx4 v0, s[4:7], s40 offen offset:3072 lds
    s_add_u32 m0, s44, 4096
    s_add_u32 s40, s34, s24
    buffer_load_dwordx4 v0, s[4:7], s40 offen lds
    buffer_load_dwordx4 v0, s[4:7], s40 offen offset:1024 lds
    buffer_load_dwordx4 v0, s[4:7], s40 offen offset:2048 lds
    buffer_load_dwordx4 v0, s[4:7], s40 offen offset:3072 lds
    s_add_u32 m0, s45, 0
    s_add_u32 s41, s25, s30
    buffer_load_dwordx4 v3, s[12:15], s41 offen lds
    s_add_u32 m0, s45, 4096
    s_add_u32 s41, s41, s42
    buffer_load_dwordx4 v3, s[12:15], s41 offen lds
    s_add_u32 m0, s45, 8192
    s_add_u32 s41, s25, s31
    buffer_load_dwordx4 v3, s[12:15], s41 offen lds
    s_add_u32 m0, s45, 12288
    s_add_u32 s41, s41, s42
    buffer_load_dwordx4 v3, s[12:15], s41 offen lds
    s_add_u32 m0, s45, 16384
    s_add_u32 s41, s25, s32
    buffer_load_dwordx4 v3, s[12:15], s41 offen lds
    s_add_u32 m0, s45, 20480
    s_add_u32 s41, s41, s42
    buffer_load_dwordx4 v3, s[12:15], s41 offen lds
    s_add_u32 s34, s34, 4096
    s_lshl_b32 s43, s26, 6
    s_add_u32 s25, s25, s43
    s_xor_b32 s28, s28, 65536
    s_lshl_b32 s44, s17, 13
    s_add_u32 s44, s44, s28
    s_lshl_b32 s45, s17, 10
    s_add_u32 s45, s45, s28
    s_add_u32 s45, s45, 32768
    s_lshl_b32 s42, s26, 5
    s_add_u32 m0, s44, 0
    s_mov_b32 s40, s34
    s_nop 0
    buffer_load_dwordx4 v0, s[4:7], s40 offen lds
    buffer_load_dwordx4 v0, s[4:7], s40 offen offset:1024 lds
    buffer_load_dwordx4 v0, s[4:7], s40 offen offset:2048 lds
    buffer_load_dwordx4 v0, s[4:7], s40 offen offset:3072 lds
    s_add_u32 m0, s44, 4096
    s_add_u32 s40, s34, s24
    buffer_load_dwordx4 v0, s[4:7], s40 offen lds
    buffer_load_dwordx4 v0, s[4:7], s40 offen offset:1024 lds
    buffer_load_dwordx4 v0, s[4:7], s40 offen offset:2048 lds
    buffer_load_dwordx4 v0, s[4:7], s40 offen offset:3072 lds
    s_add_u32 m0, s45, 0
    s_add_u32 s41, s25, s30
    buffer_load_dwordx4 v3, s[12:15], s41 offen lds
    s_add_u32 m0, s45, 4096
    s_add_u32 s41, s41, s42
    buffer_load_dwordx4 v3, s[12:15], s41 offen lds
    s_add_u32 m0, s45, 8192
    s_add_u32 s41, s25, s31
    buffer_load_dwordx4 v3, s[12:15], s41 offen lds
    s_add_u32 m0, s45, 12288
    s_add_u32 s41, s41, s42
    buffer_load_dwordx4 v3, s[12:15], s41 offen lds
    s_add_u32 m0, s45, 16384
    s_add_u32 s41, s25, s32
    buffer_load_dwordx4 v3, s[12:15], s41 offen lds
    s_add_u32 m0, s45, 20480
    s_add_u32 s41, s41, s42
    buffer_load_dwordx4 v3, s[12:15], s41 offen lds
    s_add_u32 s34, s34, 4096
    s_lshl_b32 s43, s26, 6
    s_add_u32 s25, s25, s43
    s_xor_b32 s28, s28, 65536
    v_accvgpr_write_b32 a0, 0
    v_accvgpr_write_b32 a1, 0
    v_accvgpr_write_b32 a2, 0
    v_accvgpr_write_b32 a3, 0
    v_accvgpr_write_b32 a4, 0
    v_accvgpr_write_b32 a5, 0
    v_accvgpr_write_b32 a6, 0
    v_accvgpr_write_b32 a7, 0
    v_accvgpr_write_b32 a8, 0
    v_accvgpr_write_b32 a9, 0
    v_accvgpr_write_b32 a10, 0
    v_accvgpr_write_b32 a11, 0
    v_accvgpr_write_b32 a12, 0
    v_accvgpr_write_b32 a13, 0
    v_accvgpr_write_b32 a14, 0
    v_accvgpr_write_b32 a15, 0
    v_accvgpr_write_b32 a16, 0
    v_accvgpr_write_b32 a17, 0
    v_accvgpr_write_b32 a18, 0
    v_accvgpr_write_b32 a19, 0
    v_accvgpr_write_b32 a20, 0
    v_accvgpr_write_b32 a21, 0
    v_accvgpr_write_b32 a22, 0
    v_accvgpr_write_b32 a23, 0
    v_accvgpr_write_b32 a24, 0
    v_accvgpr_write_b32 a25, 0
    v_accvgpr_write_b32 a26, 0
    v_accvgpr_write_b32 a27, 0
    v_accvgpr_write_b32 a28, 0
    v_accvgpr_write_b32 a29, 0
    v_accvgpr_write_b32 a30, 0
    v_accvgpr_write_b32 a31, 0
    v_accvgpr_write_b32 a32, 0
    v_accvgpr_write_b32 a33, 0
    v_accvgpr_write_b32 a34, 0
    v_accvgpr_write_b32 a35, 0
    v_accvgpr_write_b32 a36, 0
    v_accvgpr_write_b32 a37, 0
    v_accvgpr_write_b32 a38, 0
    v_accvgpr_write_b32 a39, 0
    v_accvgpr_write_b32 a40, 0
    v_accvgpr_write_b32 a41, 0
    v_accvgpr_write_b32 a42, 0
    v_accvgpr_write_b32 a43, 0
    v_accvgpr_write_b32 a44, 0
    v_accvgpr_write_b32 a45, 0
    v_accvgpr_write_b32 a46, 0
    v_accvgpr_write_b32 a47, 0
    v_accvgpr_write_b32 a48, 0
    v_accvgpr_write_b32 a49, 0
    v_accvgpr_write_b32 a50, 0
    v_accvgpr_write_b32 a51, 0
    v_accvgpr_write_b32 a52, 0
    v_accvgpr_write_b32 a53, 0
    v_accvgpr_write_b32 a54, 0
    v_accvgpr_write_b32 a55, 0
    v_accvgpr_write_b32 a56, 0
    v_accvgpr_write_b32 a57, 0
    v_accvgpr_write_b32 a58, 0
    v_accvgpr_write_b32 a59, 0
    v_accvgpr_write_b32 a60, 0
    v_accvgpr_write_b32 a61, 0
    v_accvgpr_write_b32 a62, 0
    v_accvgpr_write_b32 a63, 0
    v_accvgpr_write_b32 a64, 0
    v_accvgpr_write_b32 a65, 0
    v_accvgpr_write_b32 a66, 0
    v_accvgpr_write_b32 a67, 0
    v_accvgpr_write_b32 a68, 0
    v_accvgpr_write_b32 a69, 0
    v_accvgpr_write_b32 a70, 0
    v_accvgpr_write_b32 a71, 0
    v_accvgpr_write_b32 a72, 0
    v_accvgpr_write_b32 a73, 0
    v_accvgpr_write_b32 a74, 0
    v_accvgpr_write_b32 a75, 0
    v_accvgpr_write_b32 a76, 0
    v_accvgpr_write_b32 a77, 0
    v_accvgpr_write_b32 a78, 0
    v_accvgpr_write_b32 a79, 0
    v_accvgpr_write_b32 a80, 0
    v_accvgpr_write_b32 a81, 0
    v_accvgpr_write_b32 a82, 0
    v_accvgpr_write_b32 a83, 0
    v_accvgpr_write_b32 a84, 0
    v_accvgpr_write_b32 a85, 0
    v_accvgpr_write_b32 a86, 0
    v_accvgpr_write_b32 a87, 0
    v_accvgpr_write_b32 a88, 0
    v_accvgpr_write_b32 a89, 0
    v_accvgpr_write_b32 a90, 0
    v_accvgpr_write_b32 a91, 0
    v_accvgpr_write_b32 a92, 0
    v_accvgpr_write_b32 a93, 0
    v_accvgpr_write_b32 a94, 0
    v_accvgpr_write_b32 a95, 0
    v_accvgpr_write_b32 a96, 0
    v_accvgpr_write_b32 a97, 0
    v_accvgpr_write_b32 a98, 0
    v_accvgpr_write_b32 a99, 0
    v_accvgpr_write_b32 a100, 0
    v_accvgpr_write_b32 a101, 0
    v_accvgpr_write_b32 a102, 0
    v_accvgpr_write_b32 a103, 0
    v_accvgpr_write_b32 a104, 0
    v_accvgpr_write_b32 a105, 0
    v_accvgpr_write_b32 a106, 0
    v_accvgpr_write_b32 a107, 0
    v_accvgpr_write_b32 a108, 0
    v_accvgpr_write_b32 a109, 0
    v_accvgpr_write_b32 a110, 0
    v_accvgpr_write_b32 a111, 0
    v_accvgpr_write_b32 a112, 0
    v_accvgpr_write_b32 a113, 0
    v_accvgpr_write_b32 a114, 0
    v_accvgpr_write_b32 a115, 0
    v_accvgpr_write_b32 a116, 0
    v_accvgpr_write_b32 a117, 0
    v_accvgpr_write_b32 a118, 0
    v_accvgpr_write_b32 a119, 0
    v_accvgpr_write_b32 a120, 0
    v_accvgpr_write_b32 a121, 0
    v_accvgpr_write_b32 a122, 0
    v_accvgpr_write_b32 a123, 0
    v_accvgpr_write_b32 a124, 0
    v_accvgpr_write_b32 a125, 0
    v_accvgpr_write_b32 a126, 0
    v_accvgpr_write_b32 a127, 0
    v_accvgpr_write_b32 a128, 0
    v_accvgpr_write_b32 a129, 0
    v_accvgpr_write_b32 a130, 0
    v_accvgpr_write_b32 a131, 0
    v_accvgpr_write_b32 a132, 0
    v_accvgpr_write_b32 a133, 0
    v_accvgpr_write_b32 a134, 0
    v_accvgpr_write_b32 a135, 0
    v_accvgpr_write_b32 a136, 0
    v_accvgpr_write_b32 a137, 0
    v_accvgpr_write_b32 a138, 0
    v_accvgpr_write_b32 a139, 0
    v_accvgpr_write_b32 a140, 0
    v_accvgpr_write_b32 a141, 0
    v_accvgpr_write_b32 a142, 0
    v_accvgpr_write_b32 a143, 0
    v_accvgpr_write_b32 a144, 0
    v_accvgpr_write_b32 a145, 0
    v_accvgpr_write_b32 a146, 0
    v_accvgpr_write_b32 a147, 0
    v_accvgpr_write_b32 a148, 0
    v_accvgpr_write_b32 a149, 0
    v_accvgpr_write_b32 a150, 0
    v_accvgpr_write_b32 a151, 0
    v_accvgpr_write_b32 a152, 0
    v_accvgpr_write_b32 a153, 0
    v_accvgpr_write_b32 a154, 0
    v_accvgpr_write_b32 a155, 0
    v_accvgpr_write_b32 a156, 0
    v_accvgpr_write_b32 a157, 0
    v_accvgpr_write_b32 a158, 0
    v_accvgpr_write_b32 a159, 0
    v_accvgpr_write_b32 a160, 0
    v_accvgpr_write_b32 a161, 0
    v_accvgpr_write_b32 a162, 0
    v_accvgpr_write_b32 a163, 0
    v_accvgpr_write_b32 a164, 0
    v_accvgpr_write_b32 a165, 0
    v_accvgpr_write_b32 a166, 0
    v_accvgpr_write_b32 a167, 0
    v_accvgpr_write_b32 a168, 0
    v_accvgpr_write_b32 a169, 0
    v_accvgpr_write_b32 a170, 0
    v_accvgpr_write_b32 a171, 0
    v_accvgpr_write_b32 a172, 0
    v_accvgpr_write_b32 a173, 0
    v_accvgpr_write_b32 a174, 0
    v_accvgpr_write_b32 a175, 0
    v_accvgpr_write_b32 a176, 0
    v_accvgpr_write_b32 a177, 0
    v_accvgpr_write_b32 a178, 0
    v_accvgpr_write_b32 a179, 0
    v_accvgpr_write_b32 a180, 0
    v_accvgpr_write_b32 a181, 0
    v_accvgpr_write_b32 a182, 0
    v_accvgpr_write_b32 a183, 0
    v_accvgpr_write_b32 a184, 0
    v_accvgpr_write_b32 a185, 0
    v_accvgpr_write_b32 a186, 0
    v_accvgpr_write_b32 a187, 0
    v_accvgpr_write_b32 a188, 0
    v_accvgpr_write_b32 a189, 0
    v_accvgpr_write_b32 a190, 0
    v_accvgpr_write_b32 a191, 0
    s_waitcnt vmcnt(14)
    s_barrier
    ds_read_b128 v[16:19], v1 offset:0
    ds_read_b64_tr_b16 v[32:33], v2 offset:0
    ds_read_b64_tr_b16 v[34:35], v2 offset:512
    ds_read_b64_tr_b16 v[36:37], v2 offset:8192
    ds_read_b64_tr_b16 v[38:39], v2 offset:8704
    ds_read_b64_tr_b16 v[40:41], v2 offset:16384
    ds_read_b64_tr_b16 v[42:43], v2 offset:16896
    ds_read_b128 v[20:23], v1 offset:4096
    ds_read_b128 v[24:27], v1 offset:8192
    ds_read_b128 v[28:31], v1 offset:12288
    s_mov_b32 s27, 0
DN_LOOP:
    s_waitcnt lgkmcnt(0)
    v_mfma_f32_32x32x16_bf16 a[0:15], v[32:35], v[16:19], a[0:15]
    ds_read_b128 v[48:51], v1 offset:1024
    v_mfma_f32_32x32x16_bf16 a[16:31], v[36:39], v[16:19], a[16:31]
    ds_read_b64_tr_b16 v[64:65], v2 offset:2048
    v_mfma_f32_32x32x16_bf16 a[32:47], v[40:43], v[16:19], a[32:47]
    ds_read_b64_tr_b16 v[66:67], v2 offset:2560
    v_mfma_f32_32x32x16_bf16 a[48:63], v[32:35], v[20:23], a[48:63]
    ds_read_b64_tr_b16 v[68:69], v2 offset:10240
    v_mfma_f32_32x32x16_bf16 a[64:79], v[36:39], v[20:23], a[64:79]
    ds_read_b64_tr_b16 v[70:71], v2 offset:10752
    v_mfma_f32_32x32x16_bf16 a[80:95], v[40:43], v[20:23], a[80:95]
    ds_read_b64_tr_b16 v[72:73], v2 offset:18432
    v_mfma_f32_32x32x16_bf16 a[96:111], v[32:35], v[24:27], a[96:111]
    ds_read_b64_tr_b16 v[74:75], v2 offset:18944
    v_mfma_f32_32x32x16_bf16 a[112:127], v[36:39], v[24:27], a[112:127]
    ds_read_b128 v[52:55], v1 offset:5120
    v_mfma_f32_32x32x16_bf16 a[128:143], v[40:43], v[24:27], a[128:143]
    ds_read_b128 v[56:59], v1 offset:9216
    v_mfma_f32_32x32x16_bf16 a[144:159], v[32:35], v[28:31], a[144:159]
    ds_read_b128 v[60:63], v1 offset:13312
    v_mfma_f32_32x32x16_bf16 a[160:175], v[36:39], v[28:31], a[160:175]
    v_mfma_f32_32x32x16_bf16 a[176:191], v[40:43], v[28:31], a[176:191]
    s_waitcnt lgkmcnt(0)
    v_mfma_f32_32x32x16_bf16 a[0:15], v[64:67], v[48:51], a[0:15]
    ds_read_b128 v[16:19], v1 offset:2048
    v_mfma_f32_32x32x16_bf16 a[16:31], v[68:71], v[48:51], a[16:31]
    ds_read_b64_tr_b16 v[32:33], v2 offset:4096
    v_mfma_f32_32x32x16_bf16 a[32:47], v[72:75], v[48:51], a[32:47]
    ds_read_b64_tr_b16 v[34:35], v2 offset:4608
    v_mfma_f32_32x32x16_bf16 a[48:63], v[64:67], v[52:55], a[48:63]
    ds_read_b64_tr_b16 v[36:37], v2 offset:12288
    v_mfma_f32_32x32x16_bf16 a[64:79], v[68:71], v[52:55], a[64:79]
    ds_read_b64_tr_b16 v[38:39], v2 offset:12800
    v_mfma_f32_32x32x16_bf16 a[80:95], v[72:75], v[52:55], a[80:95]
    ds_read_b64_tr_b16 v[40:41], v2 offset:20480
    v_mfma_f32_32x32x16_bf16 a[96:111], v[64:67], v[56:59], a[96:111]
    ds_read_b64_tr_b16 v[42:43], v2 offset:20992
    v_mfma_f32_32x32x16_bf16 a[112:127], v[68:71], v[56:59], a[112:127]
    ds_read_b128 v[20:23], v1 offset:6144
    v_mfma_f32_32x32x16_bf16 a[128:143], v[72:75], v[56:59], a[128:143]
    ds_read_b128 v[24:27], v1 offset:10240
    v_mfma_f32_32x32x16_bf16 a[144:159], v[64:67], v[60:63], a[144:159]
    ds_read_b128 v[28:31], v1 offset:14336
    v_mfma_f32_32x32x16_bf16 a[160:175], v[68:71], v[60:63], a[160:175]
    v_mfma_f32_32x32x16_bf16 a[176:191], v[72:75], v[60:63], a[176:191]
    s_waitcnt lgkmcnt(0)
    v_mfma_f32_32x32x16_bf16 a[0:15], v[32:35], v[16:19], a[0:15]
    ds_read_b128 v[48:51], v1 offset:3072
    v_mfma_f32_32x32x16_bf16 a[16:31], v[36:39], v[16:19], a[16:31]
    ds_read_b64_tr_b16 v[64:65], v2 offset:6144
    v_mfma_f32_32x32x16_bf16 a[32:47], v[40:43], v[16:19], a[32:47]
    ds_read_b64_tr_b16 v[66:67], v2 offset:6656
    v_mfma_f32_32x32x16_bf16 a[48:63], v[32:35], v[20:23], a[48:63]
    ds_read_b64_tr_b16 v[68:69], v2 offset:14336
    v_mfma_f32_32x32x16_bf16 a[64:79], v[36:39], v[20:23], a[64:79]
    ds_read_b64_tr_b16 v[70:71], v2 offset:14848
    v_mfma_f32_32x32x16_bf16 a[80:95], v[40:43], v[20:23], a[80:95]
    ds_read_b64_tr_b16 v[72:73], v2 offset:22528
    v_mfma_f32_32x32x16_bf16 a[96:111], v[32:35], v[24:27], a[96:111]
    ds_read_b64_tr_b16 v[74:75], v2 offset:23040
    v_mfma_f32_32x32x16_bf16 a[112:127], v[36:39], v[24:27], a[112:127]
    ds_read_b128 v[52:55], v1 offset:7168
    v_mfma_f32_32x32x16_bf16 a[128:143], v[40:43], v[24:27], a[128:143]
    ds_read_b128 v[56:59], v1 offset:11264
    v_mfma_f32_32x32x16_bf16 a[144:159], v[32:35], v[28:31], a[144:159]
    ds_read_b128 v[60:63], v1 offset:15360
    v_mfma_f32_32x32x16_bf16 a[160:175], v[36:39], v[28:31], a[160:175]
    v_mfma_f32_32x32x16_bf16 a[176:191], v[40:43], v[28:31], a[176:191]
    s_waitcnt vmcnt(0) lgkmcnt(0)
    s_barrier
    v_xor_b32 v1, 65536, v1
    v_xor_b32 v2, 65536, v2
    s_cmp_ge_u32 s27, 7
    s_cbranch_scc1 DN_NODMA
    s_lshl_b32 s44, s17, 13
    s_add_u32 s44, s44, s28
    s_lshl_b32 s45, s17, 10
    s_add_u32 s45, s45, s28
    s_add_u32 s45, s45, 32768
    s_lshl_b32 s42, s26, 5
    v_mfma_f32_32x32x16_bf16 a[0:15], v[64:67], v[48:51], a[0:15]
    ds_read_b128 v[16:19], v1 offset:0
    s_add_u32 m0, s44, 0
    s_mov_b32 s40, s34
    buffer_load_dwordx4 v0, s[4:7], s40 offen lds
    v_mfma_f32_32x32x16_bf16 a[16:31], v[68:71], v[48:51], a[16:31]
    ds_read_b64_tr_b16 v[32:33], v2 offset:0
    buffer_load_dwordx4 v0, s[4:7], s40 offen offset:1024 lds
    v_mfma_f32_32x32x16_bf16 a[32:47], v[72:75], v[48:51], a[32:47]
    ds_read_b64_tr_b16 v[34:35], v2 offset:512
    buffer_load_dwordx4 v0, s[4:7], s40 offen offset:2048 lds
    v_mfma_f32_32x32x16_bf16 a[48:63], v[64:67], v[52:55], a[48:63]
    ds_read_b64_tr_b16 v[36:37], v2 offset:8192
    buffer_load_dwordx4 v0, s[4:7], s40 offen offset:3072 lds
    v_mfma_f32_32x32x16_bf16 a[64:79], v[68:71], v[52:55], a[64:79]
    ds_read_b64_tr_b16 v[38:39], v2 offset:8704
    s_add_u32 m0, s44, 4096
    s_add_u32 s40, s34, s24
    buffer_load_dwordx4 v0, s[4:7], s40 offen lds
    v_mfma_f32_32x32x16_bf16 a[80:95], v[72:75], v[52:55], a[80:95]
    ds_read_b64_tr_b16 v[40:41], v2 offset:16384
    buffer_load_dwordx4 v0, s[4:7], s40 offen offset:1024 lds
    v_mfma_f32_32x32x16_bf16 a[96:111], v[64:67], v[56:59], a[96:111]
    ds_read_b64_tr_b16 v[42:43], v2 offset:16896
    buffer_load_dwordx4 v0, s[4:7], s40 offen offset:2048 lds
    v_mfma_f32_32x32x16_bf16 a[112:127], v[68:71], v[56:59], a[112:127]
    ds_read_b128 v[20:23], v1 offset:4096
    buffer_load_dwordx4 v0, s[4:7], s40 offen offset:3072 lds
    v_mfma_f32_32x32x16_bf16 a[128:143], v[72:75], v[56:59], a[128:143]
    ds_read_b128 v[24:27], v1 offset:8192
    s_add_u32 m0, s45, 0
    s_add_u32 s41, s25, s30
    buffer_load_dwordx4 v3, s[12:15], s41 offen lds
    v_mfma_f32_32x32x16_bf16 a[144:159], v[64:67], v[60:63], a[144:159]
    ds_read_b128 v[28:31], v1 offset:12288
    s_add_u32 m0, s45, 4096
    s_add_u32 s41, s41, s42
    buffer_load_dwordx4 v3, s[12:15], s41 offen lds
    v_mfma_f32_32x32x16_bf16 a[160:175], v[68:71], v[60:63], a[160:175]
    s_add_u32 m0, s45, 8192
    s_add_u32 s41, s25, s31
    buffer_load_dwordx4 v3, s[12:15], s41 offen lds
    v_mfma_f32_32x32x16_bf16 a[176:191], v[72:75], v[60:63], a[176:191]
    s_add_u32 m0, s45, 12288
    s_add_u32 s41, s41, s42
    buffer_load_dwordx4 v3, s[12:15], s41 offen lds
    s_add_u32 m0, s45, 16384
    s_add_u32 s41, s25, s32
    buffer_load_dwordx4 v3, s[12:15], s41 offen lds
    s_add_u32 m0, s45, 20480
    s_add_u32 s41, s41, s42
    buffer_load_dwordx4 v3, s[12:15], s41 offen lds
    s_add_u32 s34, s34, 4096
    s_lshl_b32 s43, s26, 6
    s_add_u32 s25, s25, s43
    s_xor_b32 s28, s28, 65536
    s_add_u32 s27, s27, 1
    s_branch DN_LOOP
DN_NODMA:
    s_cmp_ge_u32 s27, 8
    s_cbranch_scc1 DN_FIN
    v_mfma_f32_32x32x16_bf16 a[0:15], v[64:67], v[48:51], a[0:15]
    ds_read_b128 v[16:19], v1 offset:0
    v_mfma_f32_32x32x16_bf16 a[16:31], v[68:71], v[48:51], a[16:31]
    ds_read_b64_tr_b16 v[32:33], v2 offset:0
    v_mfma_f32_32x32x16_bf16 a[32:47], v[72:75], v[48:51], a[32:47]
    ds_read_b64_tr_b16 v[34:35], v2 offset:512
    v_mfma_f32_32x32x16_bf16 a[48:63], v[64:67], v[52:55], a[48:63]
    ds_read_b64_tr_b16 v[36:37], v2 offset:8192
    v_mfma_f32_32x32x16_bf16 a[64:79], v[68:71], v[52:55], a[64:79]
    ds_read_b64_tr_b16 v[38:39], v2 offset:8704
    v_mfma_f32_32x32x16_bf16 a[80:95], v[72:75], v[52:55], a[80:95]
    ds_read_b64_tr_b16 v[40:41], v2 offset:16384
    v_mfma_f32_32x32x16_bf16 a[96:111], v[64:67], v[56:59], a[96:111]
    ds_read_b64_tr_b16 v[42:43], v2 offset:16896
    v_mfma_f32_32x32x16_bf16 a[112:127], v[68:71], v[56:59], a[112:127]
    ds_read_b128 v[20:23], v1 offset:4096
    v_mfma_f32_32x32x16_bf16 a[128:143], v[72:75], v[56:59], a[128:143]
    ds_read_b128 v[24:27], v1 offset:8192
    v_mfma_f32_32x32x16_bf16 a[144:159], v[64:67], v[60:63], a[144:159]
    ds_read_b128 v[28:31], v1 offset:12288
    v_mfma_f32_32x32x16_bf16 a[160:175], v[68:71], v[60:63], a[160:175]
    v_mfma_f32_32x32x16_bf16 a[176:191], v[72:75], v[60:63], a[176:191]
    s_add_u32 s27, s27, 1
    s_branch DN_LOOP
DN_FIN:
    v_mfma_f32_32x32x16_bf16 a[0:15], v[64:67], v[48:51], a[0:15]
    v_mfma_f32_32x32x16_bf16 a[16:31], v[68:71], v[48:51], a[16:31]
    v_mfma_f32_32x32x16_bf16 a[32:47], v[72:75], v[48:51], a[32:47]
    v_mfma_f32_32x32x16_bf16 a[48:63], v[64:67], v[52:55], a[48:63]
    v_mfma_f32_32x32x16_bf16 a[64:79], v[68:71], v[52:55], a[64:79]
    v_mfma_f32_32x32x16_bf16 a[80:95], v[72:75], v[52:55], a[80:95]
    v_mfma_f32_32x32x16_bf16 a[96:111], v[64:67], v[56:59], a[96:111]
    v_mfma_f32_32x32x16_bf16 a[112:127], v[68:71], v[56:59], a[112:127]
    v_mfma_f32_32x32x16_bf16 a[128:143], v[72:75], v[56:59], a[128:143]
    v_mfma_f32_32x32x16_bf16 a[144:159], v[64:67], v[60:63], a[144:159]
    v_mfma_f32_32x32x16_bf16 a[160:175], v[68:71], v[60:63], a[160:175]
    v_mfma_f32_32x32x16_bf16 a[176:191], v[72:75], v[60:63], a[176:191]
    s_nop 15
    s_lshl_b32 s38, s47, 6
    s_lshl_b32 s40, s21, 3
    s_add_u32 s38, s38, s40
    s_lshl_b32 s40, s35, 2
    s_add_u32 s38, s38, s40
    s_mul_i32 s38, s38, 18
    s_mul_i32 s40, s46, 6
    s_add_u32 s38, s38, s40
    s_add_u32 s38, s38, s36
    s_lshl_b32 s38, s38, 12
    s_add_u32 s41, s38, 88080384
    buffer_store_dwordx4 a[0:3], v0, s[4:7], s41 offen offset:0 sc1
    buffer_store_dwordx4 a[4:7], v0, s[4:7], s41 offen offset:1024 sc1
    buffer_store_dwordx4 a[8:11], v0, s[4:7], s41 offen offset:2048 sc1
    buffer_store_dwordx4 a[12:15], v0, s[4:7], s41 offen offset:3072 sc1
    s_add_u32 s41, s38, 88088576
    buffer_store_dwordx4 a[16:19], v0, s[4:7], s41 offen offset:0 sc1
    buffer_store_dwordx4 a[20:23], v0, s[4:7], s41 offen offset:1024 sc1
    buffer_store_dwordx4 a[24:27], v0, s[4:7], s41 offen offset:2048 sc1
    buffer_store_dwordx4 a[28:31], v0, s[4:7], s41 offen offset:3072 sc1
    s_add_u32 s41, s38, 88096768
    buffer_store_dwordx4 a[32:35], v0, s[4:7], s41 offen offset:0 sc1
    buffer_store_dwordx4 a[36:39], v0, s[4:7], s41 offen offset:1024 sc1
    buffer_store_dwordx4 a[40:43], v0, s[4:7], s41 offen offset:2048 sc1
    buffer_store_dwordx4 a[44:47], v0, s[4:7], s41 offen offset:3072 sc1
    s_add_u32 s41, s38, 88154112
    buffer_store_dwordx4 a[48:51], v0, s[4:7], s41 offen offset:0 sc1
    buffer_store_dwordx4 a[52:55], v0, s[4:7], s41 offen offset:1024 sc1
    buffer_store_dwordx4 a[56:59], v0, s[4:7], s41 offen offset:2048 sc1
    buffer_store_dwordx4 a[60:63], v0, s[4:7], s41 offen offset:3072 sc1
    s_add_u32 s41, s38, 88162304
    buffer_store_dwordx4 a[64:67], v0, s[4:7], s41 offen offset:0 sc1
    buffer_store_dwordx4 a[68:71], v0, s[4:7], s41 offen offset:1024 sc1
    buffer_store_dwordx4 a[72:75], v0, s[4:7], s41 offen offset:2048 sc1
    buffer_store_dwordx4 a[76:79], v0, s[4:7], s41 offen offset:3072 sc1
    s_add_u32 s41, s38, 88170496
    buffer_store_dwordx4 a[80:83], v0, s[4:7], s41 offen offset:0 sc1
    buffer_store_dwordx4 a[84:87], v0, s[4:7], s41 offen offset:1024 sc1
    buffer_store_dwordx4 a[88:91], v0, s[4:7], s41 offen offset:2048 sc1
    buffer_store_dwordx4 a[92:95], v0, s[4:7], s41 offen offset:3072 sc1
    s_add_u32 s41, s38, 88227840
    buffer_store_dwordx4 a[96:99], v0, s[4:7], s41 offen offset:0 sc1
    buffer_store_dwordx4 a[100:103], v0, s[4:7], s41 offen offset:1024 sc1
    buffer_store_dwordx4 a[104:107], v0, s[4:7], s41 offen offset:2048 sc1
    buffer_store_dwordx4 a[108:111], v0, s[4:7], s41 offen offset:3072 sc1
    s_add_u32 s41, s38, 88236032
    buffer_store_dwordx4 a[112:115], v0, s[4:7], s41 offen offset:0 sc1
    buffer_store_dwordx4 a[116:119], v0, s[4:7], s41 offen offset:1024 sc1
    buffer_store_dwordx4 a[120:123], v0, s[4:7], s41 offen offset:2048 sc1
    buffer_store_dwordx4 a[124:127], v0, s[4:7], s41 offen offset:3072 sc1
    s_add_u32 s41, s38, 88244224
    buffer_store_dwordx4 a[128:131], v0, s[4:7], s41 offen offset:0 sc1
    buffer_store_dwordx4 a[132:135], v0, s[4:7], s41 offen offset:1024 sc1
    buffer_store_dwordx4 a[136:139], v0, s[4:7], s41 offen offset:2048 sc1
    buffer_store_dwordx4 a[140:143], v0, s[4:7], s41 offen offset:3072 sc1
    s_add_u32 s41, s38, 88301568
    buffer_store_dwordx4 a[144:147], v0, s[4:7], s41 offen offset:0 sc1
    buffer_store_dwordx4 a[148:151], v0, s[4:7], s41 offen offset:1024 sc1
    buffer_store_dwordx4 a[152:155], v0, s[4:7], s41 offen offset:2048 sc1
    buffer_store_dwordx4 a[156:159], v0, s[4:7], s41 offen offset:3072 sc1
    s_add_u32 s41, s38, 88309760
    buffer_store_dwordx4 a[160:163], v0, s[4:7], s41 offen offset:0 sc1
    buffer_store_dwordx4 a[164:167], v0, s[4:7], s41 offen offset:1024 sc1
    buffer_store_dwordx4 a[168:171], v0, s[4:7], s41 offen offset:2048 sc1
    buffer_store_dwordx4 a[172:175], v0, s[4:7], s41 offen offset:3072 sc1
    s_add_u32 s41, s38, 88317952
    buffer_store_dwordx4 a[176:179], v0, s[4:7], s41 offen offset:0 sc1
    buffer_store_dwordx4 a[180:183], v0, s[4:7], s41 offen offset:1024 sc1
    buffer_store_dwordx4 a[184:187], v0, s[4:7], s41 offen offset:2048 sc1
    buffer_store_dwordx4 a[188:191], v0, s[4:7], s41 offen offset:3072 sc1
    s_lshl_b32 s41, s46, 3
    s_add_u32 s41, s41, s47
    s_lshl_b32 s40, s21, 8
    s_add_u32 s40, s40, s41
    s_lshl_b32 s40, s40, 2
    s_add_u32 s40, s40, 64553728
    s_waitcnt vmcnt(0)
    s_waitcnt vmcnt(0)
    s_barrier
    s_cmp_lg_u32 s17, 0
    s_cbranch_scc1 SF_76
    v_mov_b32_e64 v250, 1
    buffer_store_dword v250, off, s[4:7], s40 sc1
SF_76:
    s_branch NEXT
EXIT2:
EXIT:
    s_endpgm
CODE_END:

.section .rodata,"a"
.p2align 6
.amdhsa_kernel parallel_sum__memory_aug_recurrent_mem_tr__glu_gated_geglu__prompt_kernel
  .amdhsa_next_free_vgpr 512
  .amdhsa_next_free_sgpr 102
  .amdhsa_accum_offset 256
  .amdhsa_group_segment_fixed_size 0
  .amdhsa_kernarg_size 112
  .amdhsa_user_sgpr_count 2
  .amdhsa_user_sgpr_kernarg_segment_ptr 1
  .amdhsa_system_sgpr_workgroup_id_x 1
.end_amdhsa_kernel
```
